```python
import torch

def _softmax(x, axis=-1):
    return torch.softmax(x, dim=axis)

def _gelu(x):
    return torch.nn.functional.gelu(x, approximate='tanh')

def _silu(x):
    return torch.nn.functional.silu(x)

def _sigmoid(x):
    return torch.sigmoid(x)

def _layernorm(x, axis=-1, eps=1e-05):
    m = x.mean(dim=axis, keepdim=True)
    v = x.var(dim=axis, keepdim=True, unbiased=False)
    return (x - m) / torch.sqrt(v + eps)

def _scatter_add(tgt, idx, src, axis=0):
    return tgt.clone().index_add_(axis, idx, src)

def _segment_sum(src, seg, n):
    out = torch.zeros((n,) + src.shape[1:], dtype=src.dtype)
    return out.index_add_(0, seg, src)

def _pad(x, pw):
    flat = tuple((v for pair in reversed(pw) for v in pair))
    return torch.nn.functional.pad(x, flat)
kernel_name = 'gated_mix__spectral_fnet__mixer_gmlp__prompt'

def setup_inputs():

    _w = lambda a: (lambda t: t.to(torch.bfloat16) if t.is_floating_point() else t)(torch.as_tensor(a))

    def _A_setup():
        B, S, D = (1, 2048, 1024)
        ns = torch.arange(S)[:, None] * torch.arange(S)[None, :]
        nd = torch.arange(D)[:, None] * torch.arange(D)[None, :]
        Ws_re = torch.cos(-2.0 * torch.pi * ns / S).to(float)
        Ws_im = torch.sin(-2.0 * torch.pi * ns / S).to(float)
        Wd_re = torch.cos(-2.0 * torch.pi * nd / D).to(float)
        Wd_im = torch.sin(-2.0 * torch.pi * nd / D).to(float)
        return {'x': _w((lambda *s: torch.randn(*s, dtype=torch.bfloat16) * 0.05)(B, S, D)), 'dft_seq_re': _w(Ws_re), 'dft_seq_im': _w(Ws_im), 'dft_hid_re': _w(Wd_re), 'dft_hid_im': _w(Wd_im)}
    _A_in = _A_setup()

    def _B_setup():
        B, S, D, F = (1, 2048, 1024, 3584)
        Fh = F // 2
        return {'x': _w((lambda *s: torch.randn(*s, dtype=torch.bfloat16) * 0.05)(B, S, D)), 'w_in': _w((lambda *s: torch.randn(*s, dtype=torch.bfloat16) * 0.8)(D, 2 * Fh)), 'w_sp': _w(0.01 * (lambda *s: torch.randn(*s, dtype=torch.bfloat16) * 0.8)(S, S)), 'b_sp': _w(1.0 + 0.01 * (lambda *s: torch.randn(*s, dtype=torch.bfloat16) * 0.8)(S)), 'w_out': _w((lambda *s: torch.randn(*s, dtype=torch.bfloat16) * 0.8)(Fh, D))}
    _B_in = _B_setup()
    return {'A_x': _A_in['x'], 'A_dft_seq_re': _A_in['dft_seq_re'], 'A_dft_seq_im': _A_in['dft_seq_im'], 'A_dft_hid_re': _A_in['dft_hid_re'], 'A_dft_hid_im': _A_in['dft_hid_im'], 'B_x': _B_in['x'], 'B_w_in': _B_in['w_in'], 'B_w_sp': _B_in['w_sp'], 'B_b_sp': _B_in['b_sp'], 'B_w_out': _B_in['w_out'], 'gate_w': _w((lambda *s: torch.randn(*s, dtype=torch.bfloat16) * 0.05)(1024) * 16.0)}

def reference(A_x, A_dft_seq_re, A_dft_seq_im, A_dft_hid_re, A_dft_hid_im, B_x, B_w_in, B_w_sp, B_b_sp, B_w_out, gate_w):

    def _A_ref(x, dft_seq_re, dft_seq_im, dft_hid_re, dft_hid_im):
        a = torch.einsum('bsd,ed->bse', x, dft_hid_re)
        b = torch.einsum('bsd,ed->bse', x, dft_hid_im)
        y = torch.einsum('ts,bse->bte', dft_seq_re, a) - torch.einsum('ts,bse->bte', dft_seq_im, b)
        return y

    def _B_ref(x, w_in, w_sp, b_sp, w_out):
        B, S, D = x.shape
        F = w_in.shape[-1]
        Fh = F // 2
        z = _gelu(torch.einsum('bsd,df->bsf', x, w_in))
        z1 = z[..., :Fh].clone()
        z2 = _layernorm(z[..., Fh:], axis=-1)
        g = torch.einsum('ts,bsf->btf', w_sp, z2) + b_sp[None, :, None]
        return torch.einsum('bsf,fd->bsd', z1 * g, w_out)
    x = A_x
    g = _sigmoid((x * gate_w).sum(-1, keepdims=True))
    a = _A_ref(x, A_dft_seq_re, A_dft_seq_im, A_dft_hid_re, A_dft_hid_im)
    b = _B_ref(x, B_w_in, B_w_sp, B_b_sp, B_w_out)
    return g * a + (1 - g) * b
```

```asm
; @launch grid=(256,1,1) block=(512,1,1) lds=155712
.amdgcn_target "amdgcn-amd-amdhsa--gfx950"
.text
.globl gated_mix__spectral_fnet__mixer_gmlp__prompt_kernel
.p2align 8
.type gated_mix__spectral_fnet__mixer_gmlp__prompt_kernel,@function
gated_mix__spectral_fnet__mixer_gmlp__prompt_kernel:
  s_cmp_ge_u32 s2, 256
  s_cbranch_scc1 L_end
  s_load_dwordx16 s[64:79], s[0:1], 0
  s_load_dwordx8 s[80:87], s[0:1], 64
  s_load_dwordx4 s[88:91], s[0:1], 96
  v_lshrrev_b32 v1, 6, v0
  s_and_b32 s3, s2, 7
  v_readfirstlane_b32 s5, v1
  s_lshr_b32 s4, s2, 3
  v_and_b32 v0, 63, v0
  s_and_b32 s26, s5, 3
  s_lshr_b32 s27, s26, 1
  s_and_b32 s28, s26, 1
  s_cmp_ge_u32 s4, 28
  s_cbranch_scc1 L_side0
  s_mul_i32 s24, s4, 37
  s_lshr_b32 s24, s24, 8
  s_mul_i32 s25, s24, 7
  s_sub_u32 s25, s4, s25
  s_lshr_b32 s37, s3, 1
  s_lshl_b32 s37, s37, 2
  s_add_u32 s24, s24, s37
  s_and_b32 s37, s3, 1
  s_mul_i32 s37, s37, 7
  s_add_u32 s25, s25, s37
  s_lshl_b32 s40, s24, 18
  s_lshl_b32 s37, s26, 5
  v_lshrrev_b32 v10, 3, v0
  v_and_b32 v11, 7, v0
  v_lshrrev_b32 v12, 4, v0
  v_xor_b32 v11, v11, v12
  v_lshlrev_b32 v11, 4, v11
  v_lshrrev_b32 v12, 2, v10
  v_lshlrev_b32 v12, 3, v12
  v_and_b32 v13, 3, v10
  v_add_u32 v12, v12, v13
  v_add_u32 v12, 0, v12
  v_add_u32 v12, s37, v12
  v_lshlrev_b32 v12, 11, v12
  v_add_u32 v12, s40, v12
  v_add_u32 v12, v12, v11
  v_subrev_u32 v96, 0, v12
  v_lshrrev_b32 v12, 2, v10
  v_lshlrev_b32 v12, 3, v12
  v_and_b32 v13, 3, v10
  v_add_u32 v12, v12, v13
  v_add_u32 v12, 16, v12
  v_add_u32 v12, s37, v12
  v_lshlrev_b32 v12, 11, v12
  v_add_u32 v12, s40, v12
  v_xor_b32 v13, 64, v11
  v_add_u32 v12, v12, v13
  v_subrev_u32 v97, 1024, v12
  v_lshrrev_b32 v12, 2, v10
  v_lshlrev_b32 v12, 3, v12
  v_and_b32 v13, 3, v10
  v_add_u32 v12, v12, v13
  v_add_u32 v12, 4, v12
  v_add_u32 v12, s37, v12
  v_lshlrev_b32 v12, 11, v12
  v_add_u32 v12, s40, v12
  v_add_u32 v12, v12, v11
  v_subrev_u32 v98, 2048, v12
  v_lshrrev_b32 v12, 2, v10
  v_lshlrev_b32 v12, 3, v12
  v_and_b32 v13, 3, v10
  v_add_u32 v12, v12, v13
  v_add_u32 v12, 20, v12
  v_add_u32 v12, s37, v12
  v_lshlrev_b32 v12, 11, v12
  v_add_u32 v12, s40, v12
  v_xor_b32 v13, 64, v11
  v_add_u32 v12, v12, v13
  v_subrev_u32 v99, 3072, v12
  v_lshrrev_b32 v10, 4, v0
  v_and_b32 v12, 15, v0
  s_lshl_b32 s37, s26, 4
  v_add_u32 v13, s37, v10
  v_mul_u32_u24 v13, 7168, v13
  s_lshl_b32 s37, s25, 8
  v_add_u32 v11, s37, v13
  v_lshlrev_b32 v10, 1, v10
  v_xor_b32 v12, v12, v10
  v_xor_b32 v14, 0, v12
  v_lshlrev_b32 v14, 4, v14
  v_add_u32 v14, v14, v11
  v_add_u32 v100, 0, v14
  v_xor_b32 v14, 0, v12
  v_lshlrev_b32 v14, 4, v14
  v_add_u32 v14, v14, v11
  v_add_u32 v101, 27648, v14
  v_xor_b32 v14, 8, v12
  v_lshlrev_b32 v14, 4, v14
  v_add_u32 v14, v14, v11
  v_add_u32 v102, 55296, v14
  v_xor_b32 v14, 8, v12
  v_lshlrev_b32 v14, 4, v14
  v_add_u32 v14, v14, v11
  v_add_u32 v103, 82944, v14
  s_lshl_b32 s31, s26, 12
  s_movk_i32 s43, 3584
  s_lshl_b32 s32, s3, 1
  s_waitcnt lgkmcnt(0)
  s_mov_b32 s20, s64
  s_mov_b32 s21, s65
  s_mov_b32 s22, 0x400000
  s_mov_b32 s23, 0x20000
  s_mov_b32 s52, s76
  s_mov_b32 s53, s77
  s_mov_b32 s54, 0x700000
  s_mov_b32 s55, 0x20000
  s_cmp_lt_u32 s5, 4
  s_cbranch_scc1 L_A0
  s_lshl_b32 s33, s32, 7
  s_add_u32 m0, s31, 0
  s_mul_i32 s34, s32, 458752
  buffer_load_dwordx4 v96, s[20:23], s33 offen offset:0 lds
  buffer_load_dwordx4 v97, s[20:23], s33 offen offset:1024 lds
  buffer_load_dwordx4 v98, s[20:23], s33 offen offset:2048 lds
  buffer_load_dwordx4 v99, s[20:23], s33 offen offset:3072 lds
  s_add_u32 m0, s31, 16384
  s_add_u32 s34, s34, s43
  buffer_load_dwordx4 v100, s[52:55], s34 offen offset:0 lds
  buffer_load_dwordx4 v101, s[52:55], s34 offen offset:1024 lds
  buffer_load_dwordx4 v102, s[52:55], s34 offen offset:2048 lds
  buffer_load_dwordx4 v103, s[52:55], s34 offen offset:3072 lds
  s_add_u32 s32, s32, 1
  s_and_b32 s32, s32, 15
  s_lshl_b32 s33, s32, 7
  s_add_u32 m0, s31, 32768
  s_mul_i32 s34, s32, 458752
  buffer_load_dwordx4 v96, s[20:23], s33 offen offset:0 lds
  buffer_load_dwordx4 v97, s[20:23], s33 offen offset:1024 lds
  buffer_load_dwordx4 v98, s[20:23], s33 offen offset:2048 lds
  buffer_load_dwordx4 v99, s[20:23], s33 offen offset:3072 lds
  s_add_u32 m0, s31, 49152
  s_add_u32 s34, s34, s43
  buffer_load_dwordx4 v100, s[52:55], s34 offen offset:0 lds
  buffer_load_dwordx4 v101, s[52:55], s34 offen offset:1024 lds
  buffer_load_dwordx4 v102, s[52:55], s34 offen offset:2048 lds
  buffer_load_dwordx4 v103, s[52:55], s34 offen offset:3072 lds
  s_add_u32 s32, s32, 1
  s_and_b32 s32, s32, 15
L_A0:
  s_mov_b32 s16, s90
  s_mov_b32 s17, s91
  s_mov_b32 s18, 0x4000000
  s_mov_b32 s19, 0x20000
  s_or_b32 s37, s2, s5
  s_cmp_lg_u32 s37, 0
  s_cbranch_scc1 L_nopub
  s_memrealtime s[56:57]
  s_mov_b32 s44, s88
  s_mov_b32 s45, s89
  s_mov_b32 s46, 0x100
  s_mov_b32 s47, 0x20000
  v_mov_b32 v4, 0
  s_waitcnt lgkmcnt(0)
  s_or_b32 s56, s56, 1
  v_mov_b32 v2, s56
  v_mov_b32 v3, s57
  s_mov_b64 exec, 1
  buffer_store_dwordx2 v[2:3], v4, s[44:47], 0 offen sc1
  s_mov_b64 exec, -1
L_nopub:
  v_and_b32 v14, 15, v0
  v_lshrrev_b32 v15, 4, v0
  v_lshrrev_b32 v16, 1, v14
  v_xor_b32 v15, v15, v16
  v_lshlrev_b32 v15, 4, v15
  v_lshl_add_u32 v12, v14, 7, v15
  v_xor_b32 v13, 64, v12
  s_lshl_b32 s37, s27, 13
  v_add_u32 v2, s37, v12
  v_add_u32 v3, s37, v13
  v_lshrrev_b32 v15, 4, v0
  v_bfe_u32 v16, v0, 2, 2
  v_lshl_add_u32 v17, v15, 3, v16
  v_lshlrev_b32 v17, 8, v17
  v_and_b32 v18, 3, v0
  v_lshl_add_u32 v17, v18, 3, v17
  v_and_b32 v18, 1, v15
  v_lshl_add_u32 v16, v18, 2, v16
  s_lshl_b32 s37, s28, 2
  v_xor_b32 v16, s37, v16
  v_xor_b32 v18, 0, v16
  v_lshl_add_u32 v4, v18, 5, v17
  v_xor_b32 v18, 1, v16
  v_lshl_add_u32 v5, v18, 5, v17
  v_xor_b32 v18, 2, v16
  v_lshl_add_u32 v6, v18, 5, v17
  v_xor_b32 v18, 3, v16
  v_lshl_add_u32 v7, v18, 5, v17
  v_add_u32 v20, 0x10000, v2
  v_add_u32 v21, 0x10000, v3
  v_add_u32 v22, 0x10000, v4
  v_add_u32 v23, 0x10000, v5
  v_add_u32 v24, 0x10000, v6
  v_add_u32 v25, 0x10000, v7
  v_bfe_u32 v11, v0, 2, 2
  v_lshlrev_b32 v11, 3, v11
  v_and_b32 v16, 3, v0
  v_add_u32 v11, v11, v16
  v_lshlrev_b32 v109, 4, v0
  s_getpc_b64 s[58:59]
L_pc:
  s_add_u32 s94, s58, L_gelu-L_pc
  s_addc_u32 s95, s59, 0
  s_add_u32 s96, s58, L_b4m-L_pc
  s_addc_u32 s97, s59, 0
  s_add_u32 s58, s58, L_b4-L_pc
  s_addc_u32 s59, s59, 0
  s_mov_b64 vcc, 0
  s_cmp_lt_u32 s5, 4
  s_cbranch_scc1 L_A
  s_mov_b32 s8, s78
  s_mov_b32 s9, s79
  s_mov_b32 s10, 0x800000
  s_mov_b32 s11, 0x20000
  s_lshl_b32 s40, s24, 19
  s_lshl_b32 s37, s26, 5
  v_lshrrev_b32 v8, 3, v0
  v_and_b32 v9, 7, v0
  v_lshrrev_b32 v10, 4, v0
  v_xor_b32 v9, v9, v10
  v_lshlrev_b32 v9, 4, v9
  v_lshrrev_b32 v10, 2, v8
  v_lshlrev_b32 v10, 3, v10
  v_and_b32 v16, 3, v8
  v_add_u32 v10, v10, v16
  v_add_u32 v10, 0, v10
  v_add_u32 v10, s37, v10
  v_lshlrev_b32 v10, 12, v10
  v_add_u32 v10, s40, v10
  v_add_u32 v10, v10, v9
  v_subrev_u32 v105, 0, v10
  v_lshrrev_b32 v10, 2, v8
  v_lshlrev_b32 v10, 3, v10
  v_and_b32 v16, 3, v8
  v_add_u32 v10, v10, v16
  v_add_u32 v10, 16, v10
  v_add_u32 v10, s37, v10
  v_lshlrev_b32 v10, 12, v10
  v_add_u32 v10, s40, v10
  v_xor_b32 v16, 64, v9
  v_add_u32 v10, v10, v16
  v_subrev_u32 v106, 1024, v10
  v_lshrrev_b32 v10, 2, v8
  v_lshlrev_b32 v10, 3, v10
  v_and_b32 v16, 3, v8
  v_add_u32 v10, v10, v16
  v_add_u32 v10, 4, v10
  v_add_u32 v10, s37, v10
  v_lshlrev_b32 v10, 12, v10
  v_add_u32 v10, s40, v10
  v_add_u32 v10, v10, v9
  v_subrev_u32 v107, 2048, v10
  v_lshrrev_b32 v10, 2, v8
  v_lshlrev_b32 v10, 3, v10
  v_and_b32 v16, 3, v8
  v_add_u32 v10, v10, v16
  v_add_u32 v10, 20, v10
  v_add_u32 v10, s37, v10
  v_lshlrev_b32 v10, 12, v10
  v_add_u32 v10, s40, v10
  v_xor_b32 v16, 64, v9
  v_add_u32 v10, v10, v16
  v_subrev_u32 v108, 3072, v10
  v_lshlrev_b32 v104, 4, v0
  v_add_u32 v104, s31, v104
  s_lshl_b32 s13, s25, 19
  s_add_u32 s13, s13, 8388608
  s_lshl_b32 s12, s3, 9
  s_mov_b32 s41, s12
  s_mul_i32 s29, s3, 28
  s_add_u32 s29, s29, s4
  s_lshl_b32 s29, s29, 2
  s_add_u32 s29, s29, s26
  s_mov_b32 s48, s78
  s_mov_b32 s49, s79
  s_mov_b32 s50, 0x800000
  s_mov_b32 s51, 0x20000
  s_mul_i32 s29, s29, 5
  s_waitcnt vmcnt(8)
  s_barrier
  s_lshl_b32 s42, s25, 10
  s_add_u32 s42, s42, 31981568
  s_lshl_b32 s33, s32, 7
  s_add_u32 m0, s31, 65536
  s_mul_i32 s34, s32, 458752
  buffer_load_dwordx4 v96, s[20:23], s33 offen offset:0 lds
  buffer_load_dwordx4 v97, s[20:23], s33 offen offset:1024 lds
  buffer_load_dwordx4 v98, s[20:23], s33 offen offset:2048 lds
  buffer_load_dwordx4 v99, s[20:23], s33 offen offset:3072 lds
  s_add_u32 m0, s31, 81920
  s_add_u32 s34, s34, s43
  buffer_load_dwordx4 v100, s[52:55], s34 offen offset:0 lds
  buffer_load_dwordx4 v101, s[52:55], s34 offen offset:1024 lds
  buffer_load_dwordx4 v102, s[52:55], s34 offen offset:2048 lds
  buffer_load_dwordx4 v103, s[52:55], s34 offen offset:3072 lds
  s_add_u32 s32, s32, 1
  s_and_b32 s32, s32, 15
  s_lshl_b32 s33, s32, 7
  s_add_u32 m0, s31, 98304
  s_mul_i32 s34, s32, 458752
  buffer_load_dwordx4 v96, s[20:23], s33 offen offset:0 lds
  buffer_load_dwordx4 v97, s[20:23], s33 offen offset:1024 lds
  buffer_load_dwordx4 v98, s[20:23], s33 offen offset:2048 lds
  buffer_load_dwordx4 v99, s[20:23], s33 offen offset:3072 lds
  s_add_u32 m0, s31, 114688
  s_add_u32 s34, s34, s43
  buffer_load_dwordx4 v100, s[52:55], s34 offen offset:0 lds
  buffer_load_dwordx4 v101, s[52:55], s34 offen offset:1024 lds
  buffer_load_dwordx4 v102, s[52:55], s34 offen offset:2048 lds
  buffer_load_dwordx4 v103, s[52:55], s34 offen offset:3072 lds
  s_add_u32 s32, s32, 1
  s_and_b32 s32, s32, 15
  s_waitcnt vmcnt(16)
  s_barrier
  s_lshl_b32 s33, s32, 7
  s_add_u32 m0, s31, 0
  s_mul_i32 s34, s32, 458752
  buffer_load_dwordx4 v96, s[20:23], s33 offen offset:0 lds
  buffer_load_dwordx4 v97, s[20:23], s33 offen offset:1024 lds
  buffer_load_dwordx4 v98, s[20:23], s33 offen offset:2048 lds
  buffer_load_dwordx4 v99, s[20:23], s33 offen offset:3072 lds
  s_add_u32 m0, s31, 16384
  s_add_u32 s34, s34, s43
  buffer_load_dwordx4 v100, s[52:55], s34 offen offset:0 lds
  buffer_load_dwordx4 v101, s[52:55], s34 offen offset:1024 lds
  buffer_load_dwordx4 v102, s[52:55], s34 offen offset:2048 lds
  buffer_load_dwordx4 v103, s[52:55], s34 offen offset:3072 lds
  s_add_u32 s32, s32, 1
  s_and_b32 s32, s32, 15
  s_mov_b32 s35, 2
L1_ld_1:
  s_waitcnt vmcnt(16)
  s_barrier
  s_lshl_b32 s33, s32, 7
  s_add_u32 m0, s31, 32768
  s_mul_i32 s34, s32, 458752
  buffer_load_dwordx4 v96, s[20:23], s33 offen offset:0 lds
  buffer_load_dwordx4 v97, s[20:23], s33 offen offset:1024 lds
  buffer_load_dwordx4 v98, s[20:23], s33 offen offset:2048 lds
  buffer_load_dwordx4 v99, s[20:23], s33 offen offset:3072 lds
  s_add_u32 m0, s31, 49152
  s_add_u32 s34, s34, s43
  buffer_load_dwordx4 v100, s[52:55], s34 offen offset:0 lds
  buffer_load_dwordx4 v101, s[52:55], s34 offen offset:1024 lds
  buffer_load_dwordx4 v102, s[52:55], s34 offen offset:2048 lds
  buffer_load_dwordx4 v103, s[52:55], s34 offen offset:3072 lds
  s_add_u32 s32, s32, 1
  s_and_b32 s32, s32, 15
  s_waitcnt vmcnt(16)
  s_barrier
  s_lshl_b32 s33, s32, 7
  s_add_u32 m0, s31, 65536
  s_mul_i32 s34, s32, 458752
  buffer_load_dwordx4 v96, s[20:23], s33 offen offset:0 lds
  buffer_load_dwordx4 v97, s[20:23], s33 offen offset:1024 lds
  buffer_load_dwordx4 v98, s[20:23], s33 offen offset:2048 lds
  buffer_load_dwordx4 v99, s[20:23], s33 offen offset:3072 lds
  s_add_u32 m0, s31, 81920
  s_add_u32 s34, s34, s43
  buffer_load_dwordx4 v100, s[52:55], s34 offen offset:0 lds
  buffer_load_dwordx4 v101, s[52:55], s34 offen offset:1024 lds
  buffer_load_dwordx4 v102, s[52:55], s34 offen offset:2048 lds
  buffer_load_dwordx4 v103, s[52:55], s34 offen offset:3072 lds
  s_add_u32 s32, s32, 1
  s_and_b32 s32, s32, 15
  s_waitcnt vmcnt(16)
  s_barrier
  s_lshl_b32 s33, s32, 7
  s_add_u32 m0, s31, 98304
  s_mul_i32 s34, s32, 458752
  buffer_load_dwordx4 v96, s[20:23], s33 offen offset:0 lds
  buffer_load_dwordx4 v97, s[20:23], s33 offen offset:1024 lds
  buffer_load_dwordx4 v98, s[20:23], s33 offen offset:2048 lds
  buffer_load_dwordx4 v99, s[20:23], s33 offen offset:3072 lds
  s_add_u32 m0, s31, 114688
  s_add_u32 s34, s34, s43
  buffer_load_dwordx4 v100, s[52:55], s34 offen offset:0 lds
  buffer_load_dwordx4 v101, s[52:55], s34 offen offset:1024 lds
  buffer_load_dwordx4 v102, s[52:55], s34 offen offset:2048 lds
  buffer_load_dwordx4 v103, s[52:55], s34 offen offset:3072 lds
  s_add_u32 s32, s32, 1
  s_and_b32 s32, s32, 15
  s_waitcnt vmcnt(16)
  s_barrier
  s_lshl_b32 s33, s32, 7
  s_add_u32 m0, s31, 0
  s_mul_i32 s34, s32, 458752
  buffer_load_dwordx4 v96, s[20:23], s33 offen offset:0 lds
  buffer_load_dwordx4 v97, s[20:23], s33 offen offset:1024 lds
  buffer_load_dwordx4 v98, s[20:23], s33 offen offset:2048 lds
  buffer_load_dwordx4 v99, s[20:23], s33 offen offset:3072 lds
  s_add_u32 m0, s31, 16384
  s_add_u32 s34, s34, s43
  buffer_load_dwordx4 v100, s[52:55], s34 offen offset:0 lds
  buffer_load_dwordx4 v101, s[52:55], s34 offen offset:1024 lds
  buffer_load_dwordx4 v102, s[52:55], s34 offen offset:2048 lds
  buffer_load_dwordx4 v103, s[52:55], s34 offen offset:3072 lds
  s_add_u32 s32, s32, 1
  s_and_b32 s32, s32, 15
  s_sub_u32 s35, s35, 1
  s_cmp_lg_u32 s35, 0
  s_cbranch_scc1 L1_ld_1
  s_waitcnt vmcnt(16)
  s_barrier
  s_lshl_b32 s33, s32, 7
  s_add_u32 m0, s31, 32768
  s_mul_i32 s34, s32, 458752
  buffer_load_dwordx4 v96, s[20:23], s33 offen offset:0 lds
  buffer_load_dwordx4 v97, s[20:23], s33 offen offset:1024 lds
  buffer_load_dwordx4 v98, s[20:23], s33 offen offset:2048 lds
  buffer_load_dwordx4 v99, s[20:23], s33 offen offset:3072 lds
  s_add_u32 m0, s31, 49152
  s_add_u32 s34, s34, s43
  buffer_load_dwordx4 v100, s[52:55], s34 offen offset:0 lds
  buffer_load_dwordx4 v101, s[52:55], s34 offen offset:1024 lds
  buffer_load_dwordx4 v102, s[52:55], s34 offen offset:2048 lds
  buffer_load_dwordx4 v103, s[52:55], s34 offen offset:3072 lds
  s_add_u32 s32, s32, 1
  s_and_b32 s32, s32, 15
  s_waitcnt vmcnt(16)
  s_barrier
  s_lshl_b32 s33, s32, 7
  s_add_u32 m0, s31, 65536
  s_mul_i32 s34, s32, 458752
  buffer_load_dwordx4 v96, s[20:23], s33 offen offset:0 lds
  buffer_load_dwordx4 v97, s[20:23], s33 offen offset:1024 lds
  buffer_load_dwordx4 v98, s[20:23], s33 offen offset:2048 lds
  buffer_load_dwordx4 v99, s[20:23], s33 offen offset:3072 lds
  s_add_u32 m0, s31, 81920
  s_add_u32 s34, s34, s43
  buffer_load_dwordx4 v100, s[52:55], s34 offen offset:0 lds
  buffer_load_dwordx4 v101, s[52:55], s34 offen offset:1024 lds
  buffer_load_dwordx4 v102, s[52:55], s34 offen offset:2048 lds
  buffer_load_dwordx4 v103, s[52:55], s34 offen offset:3072 lds
  s_add_u32 s32, s32, 1
  s_and_b32 s32, s32, 15
  s_waitcnt vmcnt(16)
  s_barrier
  s_lshl_b32 s33, s32, 7
  s_add_u32 m0, s31, 98304
  s_mul_i32 s34, s32, 458752
  buffer_load_dwordx4 v96, s[20:23], s33 offen offset:0 lds
  buffer_load_dwordx4 v97, s[20:23], s33 offen offset:1024 lds
  buffer_load_dwordx4 v98, s[20:23], s33 offen offset:2048 lds
  buffer_load_dwordx4 v99, s[20:23], s33 offen offset:3072 lds
  s_add_u32 m0, s31, 114688
  s_add_u32 s34, s34, s43
  buffer_load_dwordx4 v100, s[52:55], s34 offen offset:0 lds
  buffer_load_dwordx4 v101, s[52:55], s34 offen offset:1024 lds
  buffer_load_dwordx4 v102, s[52:55], s34 offen offset:2048 lds
  buffer_load_dwordx4 v103, s[52:55], s34 offen offset:3072 lds
  s_add_u32 s32, s32, 1
  s_and_b32 s32, s32, 15
  s_waitcnt vmcnt(16)
  s_barrier
  s_mov_b32 s43, 0
  s_lshl_b32 s33, s32, 7
  s_add_u32 m0, s31, 0
  s_mul_i32 s34, s32, 458752
  buffer_load_dwordx4 v96, s[20:23], s33 offen offset:0 lds
  buffer_load_dwordx4 v97, s[20:23], s33 offen offset:1024 lds
  buffer_load_dwordx4 v98, s[20:23], s33 offen offset:2048 lds
  buffer_load_dwordx4 v99, s[20:23], s33 offen offset:3072 lds
  s_add_u32 m0, s31, 16384
  s_add_u32 s34, s34, s43
  buffer_load_dwordx4 v100, s[52:55], s34 offen offset:0 lds
  buffer_load_dwordx4 v101, s[52:55], s34 offen offset:1024 lds
  buffer_load_dwordx4 v102, s[52:55], s34 offen offset:2048 lds
  buffer_load_dwordx4 v103, s[52:55], s34 offen offset:3072 lds
  s_add_u32 s32, s32, 1
  s_and_b32 s32, s32, 15
  s_waitcnt vmcnt(16)
  s_barrier
  s_lshl_b32 s33, s32, 7
  s_add_u32 m0, s31, 32768
  s_mul_i32 s34, s32, 458752
  buffer_load_dwordx4 v96, s[20:23], s33 offen offset:0 lds
  buffer_load_dwordx4 v97, s[20:23], s33 offen offset:1024 lds
  buffer_load_dwordx4 v98, s[20:23], s33 offen offset:2048 lds
  buffer_load_dwordx4 v99, s[20:23], s33 offen offset:3072 lds
  s_add_u32 m0, s31, 49152
  s_add_u32 s34, s34, s43
  buffer_load_dwordx4 v100, s[52:55], s34 offen offset:0 lds
  buffer_load_dwordx4 v101, s[52:55], s34 offen offset:1024 lds
  buffer_load_dwordx4 v102, s[52:55], s34 offen offset:2048 lds
  buffer_load_dwordx4 v103, s[52:55], s34 offen offset:3072 lds
  s_add_u32 s32, s32, 1
  s_and_b32 s32, s32, 15
  s_waitcnt vmcnt(16)
  s_barrier
  s_lshl_b32 s33, s32, 7
  s_add_u32 m0, s31, 65536
  s_mul_i32 s34, s32, 458752
  buffer_load_dwordx4 v96, s[20:23], s33 offen offset:0 lds
  buffer_load_dwordx4 v97, s[20:23], s33 offen offset:1024 lds
  buffer_load_dwordx4 v98, s[20:23], s33 offen offset:2048 lds
  buffer_load_dwordx4 v99, s[20:23], s33 offen offset:3072 lds
  s_add_u32 m0, s31, 81920
  s_add_u32 s34, s34, s43
  buffer_load_dwordx4 v100, s[52:55], s34 offen offset:0 lds
  buffer_load_dwordx4 v101, s[52:55], s34 offen offset:1024 lds
  buffer_load_dwordx4 v102, s[52:55], s34 offen offset:2048 lds
  buffer_load_dwordx4 v103, s[52:55], s34 offen offset:3072 lds
  s_add_u32 s32, s32, 1
  s_and_b32 s32, s32, 15
  s_waitcnt vmcnt(16)
  s_barrier
  s_lshl_b32 s33, s32, 7
  s_add_u32 m0, s31, 98304
  s_mul_i32 s34, s32, 458752
  buffer_load_dwordx4 v96, s[20:23], s33 offen offset:0 lds
  buffer_load_dwordx4 v97, s[20:23], s33 offen offset:1024 lds
  buffer_load_dwordx4 v98, s[20:23], s33 offen offset:2048 lds
  buffer_load_dwordx4 v99, s[20:23], s33 offen offset:3072 lds
  s_add_u32 m0, s31, 114688
  s_add_u32 s34, s34, s43
  buffer_load_dwordx4 v100, s[52:55], s34 offen offset:0 lds
  buffer_load_dwordx4 v101, s[52:55], s34 offen offset:1024 lds
  buffer_load_dwordx4 v102, s[52:55], s34 offen offset:2048 lds
  buffer_load_dwordx4 v103, s[52:55], s34 offen offset:3072 lds
  s_add_u32 s32, s32, 1
  s_and_b32 s32, s32, 15
  s_lshr_b32 s37, s29, 10
  s_and_b32 s40, s29, 1
  s_add_u32 s37, s37, s40
  s_add_u32 s37, s37, 0
  s_and_b32 s37, s37, 3
  s_lshl_b32 s37, s37, 10
  s_lshr_b32 s40, s29, 1
  s_lshl_b32 s40, s40, 12
  s_add_u32 s37, s37, s40
  s_add_u32 s29, s29, 1
  buffer_load_dwordx4 v[120:123], v109, s[48:51], s37 offen
  s_lshr_b32 s37, s29, 10
  s_and_b32 s40, s29, 1
  s_add_u32 s37, s37, s40
  s_add_u32 s37, s37, 0
  s_and_b32 s37, s37, 3
  s_lshl_b32 s37, s37, 10
  s_lshr_b32 s40, s29, 1
  s_lshl_b32 s40, s40, 12
  s_add_u32 s37, s37, s40
  s_add_u32 s29, s29, 1
  buffer_load_dwordx4 v[120:123], v109, s[48:51], s37 offen
  s_lshr_b32 s37, s29, 10
  s_and_b32 s40, s29, 1
  s_add_u32 s37, s37, s40
  s_add_u32 s37, s37, 0
  s_and_b32 s37, s37, 3
  s_lshl_b32 s37, s37, 10
  s_lshr_b32 s40, s29, 1
  s_lshl_b32 s40, s40, 12
  s_add_u32 s37, s37, s40
  s_add_u32 s29, s29, 1
  buffer_load_dwordx4 v[120:123], v109, s[48:51], s37 offen
  s_lshr_b32 s37, s29, 10
  s_and_b32 s40, s29, 1
  s_add_u32 s37, s37, s40
  s_add_u32 s37, s37, 0
  s_and_b32 s37, s37, 3
  s_lshl_b32 s37, s37, 10
  s_lshr_b32 s40, s29, 1
  s_lshl_b32 s40, s40, 12
  s_add_u32 s37, s37, s40
  s_add_u32 s29, s29, 1
  buffer_load_dwordx4 v[120:123], v109, s[48:51], s37 offen
  s_lshr_b32 s37, s29, 10
  s_and_b32 s40, s29, 1
  s_add_u32 s37, s37, s40
  s_add_u32 s37, s37, 0
  s_and_b32 s37, s37, 3
  s_lshl_b32 s37, s37, 10
  s_lshr_b32 s40, s29, 1
  s_lshl_b32 s40, s40, 12
  s_add_u32 s37, s37, s40
  s_add_u32 s29, s29, 1
  buffer_load_dwordx4 v[120:123], v109, s[48:51], s37 offen
  s_waitcnt vmcnt(21)
  s_barrier
  s_lshl_b32 s33, s32, 7
  s_add_u32 m0, s31, 0
  s_mul_i32 s34, s32, 458752
  buffer_load_dwordx4 v96, s[20:23], s33 offen offset:0 lds
  buffer_load_dwordx4 v97, s[20:23], s33 offen offset:1024 lds
  buffer_load_dwordx4 v98, s[20:23], s33 offen offset:2048 lds
  buffer_load_dwordx4 v99, s[20:23], s33 offen offset:3072 lds
  s_add_u32 m0, s31, 16384
  s_add_u32 s34, s34, s43
  buffer_load_dwordx4 v100, s[52:55], s34 offen offset:0 lds
  buffer_load_dwordx4 v101, s[52:55], s34 offen offset:1024 lds
  buffer_load_dwordx4 v102, s[52:55], s34 offen offset:2048 lds
  buffer_load_dwordx4 v103, s[52:55], s34 offen offset:3072 lds
  s_add_u32 s32, s32, 1
  s_and_b32 s32, s32, 15
  s_waitcnt vmcnt(21)
  s_barrier
  s_lshl_b32 s33, s32, 7
  s_add_u32 m0, s31, 32768
  s_mul_i32 s34, s32, 458752
  buffer_load_dwordx4 v96, s[20:23], s33 offen offset:0 lds
  buffer_load_dwordx4 v97, s[20:23], s33 offen offset:1024 lds
  buffer_load_dwordx4 v98, s[20:23], s33 offen offset:2048 lds
  buffer_load_dwordx4 v99, s[20:23], s33 offen offset:3072 lds
  s_add_u32 m0, s31, 49152
  s_add_u32 s34, s34, s43
  buffer_load_dwordx4 v100, s[52:55], s34 offen offset:0 lds
  buffer_load_dwordx4 v101, s[52:55], s34 offen offset:1024 lds
  buffer_load_dwordx4 v102, s[52:55], s34 offen offset:2048 lds
  buffer_load_dwordx4 v103, s[52:55], s34 offen offset:3072 lds
  s_add_u32 s32, s32, 1
  s_and_b32 s32, s32, 15
  s_waitcnt vmcnt(21)
  s_barrier
  s_lshl_b32 s33, s32, 7
  s_add_u32 m0, s31, 65536
  s_mul_i32 s34, s32, 458752
  buffer_load_dwordx4 v96, s[20:23], s33 offen offset:0 lds
  buffer_load_dwordx4 v97, s[20:23], s33 offen offset:1024 lds
  buffer_load_dwordx4 v98, s[20:23], s33 offen offset:2048 lds
  buffer_load_dwordx4 v99, s[20:23], s33 offen offset:3072 lds
  s_add_u32 m0, s31, 81920
  s_add_u32 s34, s34, s43
  buffer_load_dwordx4 v100, s[52:55], s34 offen offset:0 lds
  buffer_load_dwordx4 v101, s[52:55], s34 offen offset:1024 lds
  buffer_load_dwordx4 v102, s[52:55], s34 offen offset:2048 lds
  buffer_load_dwordx4 v103, s[52:55], s34 offen offset:3072 lds
  s_add_u32 s32, s32, 1
  s_and_b32 s32, s32, 15
  s_waitcnt vmcnt(16)
  s_barrier
  s_lshl_b32 s33, s32, 7
  s_add_u32 m0, s31, 98304
  s_mul_i32 s34, s32, 458752
  buffer_load_dwordx4 v96, s[20:23], s33 offen offset:0 lds
  buffer_load_dwordx4 v97, s[20:23], s33 offen offset:1024 lds
  buffer_load_dwordx4 v98, s[20:23], s33 offen offset:2048 lds
  buffer_load_dwordx4 v99, s[20:23], s33 offen offset:3072 lds
  s_add_u32 m0, s31, 114688
  s_add_u32 s34, s34, s43
  buffer_load_dwordx4 v100, s[52:55], s34 offen offset:0 lds
  buffer_load_dwordx4 v101, s[52:55], s34 offen offset:1024 lds
  buffer_load_dwordx4 v102, s[52:55], s34 offen offset:2048 lds
  buffer_load_dwordx4 v103, s[52:55], s34 offen offset:3072 lds
  s_add_u32 s32, s32, 1
  s_and_b32 s32, s32, 15
  s_waitcnt vmcnt(16)
  s_barrier
  s_mov_b32 s44, s88
  s_mov_b32 s45, s89
  s_mov_b32 s46, 0x100
  s_mov_b32 s47, 0x20000
  v_mov_b32 v30, 0
  buffer_load_dwordx2 v[28:29], v30, s[44:47], 0 offen sc1
  s_lshl_b32 s33, s32, 7
  s_add_u32 m0, s31, 0
  s_mul_i32 s34, s32, 458752
  buffer_load_dwordx4 v96, s[20:23], s33 offen offset:0 lds
  buffer_load_dwordx4 v97, s[20:23], s33 offen offset:1024 lds
  buffer_load_dwordx4 v98, s[20:23], s33 offen offset:2048 lds
  buffer_load_dwordx4 v99, s[20:23], s33 offen offset:3072 lds
  s_add_u32 m0, s31, 16384
  s_add_u32 s34, s34, s43
  buffer_load_dwordx4 v100, s[52:55], s34 offen offset:0 lds
  buffer_load_dwordx4 v101, s[52:55], s34 offen offset:1024 lds
  buffer_load_dwordx4 v102, s[52:55], s34 offen offset:2048 lds
  buffer_load_dwordx4 v103, s[52:55], s34 offen offset:3072 lds
  s_add_u32 s32, s32, 1
  s_and_b32 s32, s32, 15
  s_waitcnt vmcnt(17)
  s_barrier
  s_lshl_b32 s33, s32, 7
  s_add_u32 m0, s31, 32768
  s_mul_i32 s34, s32, 458752
  buffer_load_dwordx4 v96, s[20:23], s33 offen offset:0 lds
  buffer_load_dwordx4 v97, s[20:23], s33 offen offset:1024 lds
  buffer_load_dwordx4 v98, s[20:23], s33 offen offset:2048 lds
  buffer_load_dwordx4 v99, s[20:23], s33 offen offset:3072 lds
  s_add_u32 m0, s31, 49152
  s_add_u32 s34, s34, s43
  buffer_load_dwordx4 v100, s[52:55], s34 offen offset:0 lds
  buffer_load_dwordx4 v101, s[52:55], s34 offen offset:1024 lds
  buffer_load_dwordx4 v102, s[52:55], s34 offen offset:2048 lds
  buffer_load_dwordx4 v103, s[52:55], s34 offen offset:3072 lds
  s_add_u32 s32, s32, 1
  s_and_b32 s32, s32, 15
  s_waitcnt vmcnt(17)
  s_barrier
  s_lshl_b32 s33, s32, 7
  s_add_u32 m0, s31, 65536
  s_mul_i32 s34, s32, 458752
  buffer_load_dwordx4 v96, s[20:23], s33 offen offset:0 lds
  buffer_load_dwordx4 v97, s[20:23], s33 offen offset:1024 lds
  buffer_load_dwordx4 v98, s[20:23], s33 offen offset:2048 lds
  buffer_load_dwordx4 v99, s[20:23], s33 offen offset:3072 lds
  s_add_u32 m0, s31, 81920
  s_add_u32 s34, s34, s43
  buffer_load_dwordx4 v100, s[52:55], s34 offen offset:0 lds
  buffer_load_dwordx4 v101, s[52:55], s34 offen offset:1024 lds
  buffer_load_dwordx4 v102, s[52:55], s34 offen offset:2048 lds
  buffer_load_dwordx4 v103, s[52:55], s34 offen offset:3072 lds
  s_add_u32 s32, s32, 1
  s_and_b32 s32, s32, 15
  s_waitcnt vmcnt(16)
  s_barrier
  s_lshl_b32 s33, s32, 7
  s_add_u32 m0, s31, 98304
  s_mul_i32 s34, s32, 458752
  buffer_load_dwordx4 v96, s[20:23], s33 offen offset:0 lds
  buffer_load_dwordx4 v97, s[20:23], s33 offen offset:1024 lds
  buffer_load_dwordx4 v98, s[20:23], s33 offen offset:2048 lds
  buffer_load_dwordx4 v99, s[20:23], s33 offen offset:3072 lds
  s_add_u32 m0, s31, 114688
  s_add_u32 s34, s34, s43
  buffer_load_dwordx4 v100, s[52:55], s34 offen offset:0 lds
  buffer_load_dwordx4 v101, s[52:55], s34 offen offset:1024 lds
  buffer_load_dwordx4 v102, s[52:55], s34 offen offset:2048 lds
  buffer_load_dwordx4 v103, s[52:55], s34 offen offset:3072 lds
  s_add_u32 s32, s32, 1
  s_and_b32 s32, s32, 15
  s_waitcnt vmcnt(16)
  s_barrier
  s_lshl_b32 s33, s32, 7
  s_add_u32 m0, s31, 0
  s_mul_i32 s34, s32, 458752
  buffer_load_dwordx4 v96, s[20:23], s33 offen offset:0 lds
  buffer_load_dwordx4 v97, s[20:23], s33 offen offset:1024 lds
  buffer_load_dwordx4 v98, s[20:23], s33 offen offset:2048 lds
  buffer_load_dwordx4 v99, s[20:23], s33 offen offset:3072 lds
  s_add_u32 m0, s31, 16384
  s_add_u32 s34, s34, s43
  buffer_load_dwordx4 v100, s[52:55], s34 offen offset:0 lds
  buffer_load_dwordx4 v101, s[52:55], s34 offen offset:1024 lds
  buffer_load_dwordx4 v102, s[52:55], s34 offen offset:2048 lds
  buffer_load_dwordx4 v103, s[52:55], s34 offen offset:3072 lds
  s_add_u32 s32, s32, 1
  s_and_b32 s32, s32, 15
  s_waitcnt vmcnt(16)
  s_barrier
  s_lshl_b32 s33, s32, 7
  s_add_u32 m0, s31, 32768
  s_mul_i32 s34, s32, 458752
  buffer_load_dwordx4 v96, s[20:23], s33 offen offset:0 lds
  buffer_load_dwordx4 v97, s[20:23], s33 offen offset:1024 lds
  buffer_load_dwordx4 v98, s[20:23], s33 offen offset:2048 lds
  buffer_load_dwordx4 v99, s[20:23], s33 offen offset:3072 lds
  s_add_u32 m0, s31, 49152
  s_add_u32 s34, s34, s43
  buffer_load_dwordx4 v100, s[52:55], s34 offen offset:0 lds
  buffer_load_dwordx4 v101, s[52:55], s34 offen offset:1024 lds
  buffer_load_dwordx4 v102, s[52:55], s34 offen offset:2048 lds
  buffer_load_dwordx4 v103, s[52:55], s34 offen offset:3072 lds
  s_add_u32 s32, s32, 1
  s_and_b32 s32, s32, 15
  s_waitcnt vmcnt(16)
  s_barrier
  s_lshl_b32 s33, s32, 7
  s_add_u32 m0, s31, 65536
  s_mul_i32 s34, s32, 458752
  buffer_load_dwordx4 v96, s[20:23], s33 offen offset:0 lds
  buffer_load_dwordx4 v97, s[20:23], s33 offen offset:1024 lds
  buffer_load_dwordx4 v98, s[20:23], s33 offen offset:2048 lds
  buffer_load_dwordx4 v99, s[20:23], s33 offen offset:3072 lds
  s_add_u32 m0, s31, 81920
  s_add_u32 s34, s34, s43
  buffer_load_dwordx4 v100, s[52:55], s34 offen offset:0 lds
  buffer_load_dwordx4 v101, s[52:55], s34 offen offset:1024 lds
  buffer_load_dwordx4 v102, s[52:55], s34 offen offset:2048 lds
  buffer_load_dwordx4 v103, s[52:55], s34 offen offset:3072 lds
  s_add_u32 s32, s32, 1
  s_and_b32 s32, s32, 15
  s_waitcnt vmcnt(16)
  s_barrier
  v_readfirstlane_b32 s92, v28
  v_readfirstlane_b32 s93, v29
  v_and_b32 v26, 15, v0
  v_min_u32 v26, 15, v26
  v_lshlrev_b32 v26, 6, v26
  s_mov_b32 exec_hi, 0
  s_mov_b32 exec_lo, 0xffff
  buffer_load_dwordx2 v[24:25], v26, s[16:19], s42 offen sc1
  s_mov_b64 exec, -1
  s_lshl_b32 s33, s32, 7
  s_add_u32 m0, s31, 98304
  s_mul_i32 s34, s32, 458752
  buffer_load_dwordx4 v96, s[20:23], s33 offen offset:0 lds
  buffer_load_dwordx4 v97, s[20:23], s33 offen offset:1024 lds
  buffer_load_dwordx4 v98, s[20:23], s33 offen offset:2048 lds
  buffer_load_dwordx4 v99, s[20:23], s33 offen offset:3072 lds
  s_add_u32 m0, s31, 114688
  s_add_u32 s34, s34, s43
  buffer_load_dwordx4 v100, s[52:55], s34 offen offset:0 lds
  buffer_load_dwordx4 v101, s[52:55], s34 offen offset:1024 lds
  buffer_load_dwordx4 v102, s[52:55], s34 offen offset:2048 lds
  buffer_load_dwordx4 v103, s[52:55], s34 offen offset:3072 lds
  s_add_u32 s32, s32, 1
  s_and_b32 s32, s32, 15
  s_waitcnt vmcnt(17)
  s_barrier
  s_add_u32 m0, s31, 0
  s_nop 0
  buffer_load_dwordx4 v105, s[8:11], s41 offen offset:0 lds
  buffer_load_dwordx4 v106, s[8:11], s41 offen offset:1024 lds
  buffer_load_dwordx4 v107, s[8:11], s41 offen offset:2048 lds
  buffer_load_dwordx4 v108, s[8:11], s41 offen offset:3072 lds
  s_add_u32 s41, s41, 128
  s_and_b32 s41, s41, 4095
  s_waitcnt vmcnt(12)
  v_cmp_eq_u64 vcc, s[92:93], v[24:25]
  s_and_b32 s36, vcc_lo, 0xffff
  s_cmp_lg_u32 s92, 0
  s_cselect_b32 s36, s36, 0
  s_cmp_eq_u32 s36, 0xffff
  s_cbranch_scc0 L_late
  s_lshl_b32 s14, s12, 7
  s_add_u32 m0, s31, 16384
  s_add_u32 s14, s14, s13
  buffer_load_dwordx4 v104, s[16:19], s14 offen offset:0 sc1 lds
  buffer_load_dwordx4 v104, s[16:19], s14 offen offset:1024 sc1 lds
  buffer_load_dwordx4 v104, s[16:19], s14 offen offset:2048 sc1 lds
  buffer_load_dwordx4 v104, s[16:19], s14 offen offset:3072 sc1 lds
  s_add_u32 s12, s12, 128
  s_and_b32 s12, s12, 4095
  s_barrier
  s_add_u32 m0, s31, 32768
  s_nop 0
  buffer_load_dwordx4 v105, s[8:11], s41 offen offset:0 lds
  buffer_load_dwordx4 v106, s[8:11], s41 offen offset:1024 lds
  buffer_load_dwordx4 v107, s[8:11], s41 offen offset:2048 lds
  buffer_load_dwordx4 v108, s[8:11], s41 offen offset:3072 lds
  s_add_u32 s41, s41, 128
  s_and_b32 s41, s41, 4095
  s_lshl_b32 s14, s12, 7
  s_add_u32 m0, s31, 49152
  s_add_u32 s14, s14, s13
  buffer_load_dwordx4 v104, s[16:19], s14 offen offset:0 sc1 lds
  buffer_load_dwordx4 v104, s[16:19], s14 offen offset:1024 sc1 lds
  buffer_load_dwordx4 v104, s[16:19], s14 offen offset:2048 sc1 lds
  buffer_load_dwordx4 v104, s[16:19], s14 offen offset:3072 sc1 lds
  s_add_u32 s12, s12, 128
  s_and_b32 s12, s12, 4095
  s_waitcnt vmcnt(16)
  s_barrier
  s_add_u32 m0, s31, 65536
  s_nop 0
  buffer_load_dwordx4 v105, s[8:11], s41 offen offset:0 lds
  buffer_load_dwordx4 v106, s[8:11], s41 offen offset:1024 lds
  buffer_load_dwordx4 v107, s[8:11], s41 offen offset:2048 lds
  buffer_load_dwordx4 v108, s[8:11], s41 offen offset:3072 lds
  s_add_u32 s41, s41, 128
  s_and_b32 s41, s41, 4095
  s_lshl_b32 s14, s12, 7
  s_add_u32 m0, s31, 81920
  s_add_u32 s14, s14, s13
  buffer_load_dwordx4 v104, s[16:19], s14 offen offset:0 sc1 lds
  buffer_load_dwordx4 v104, s[16:19], s14 offen offset:1024 sc1 lds
  buffer_load_dwordx4 v104, s[16:19], s14 offen offset:2048 sc1 lds
  buffer_load_dwordx4 v104, s[16:19], s14 offen offset:3072 sc1 lds
  s_add_u32 s12, s12, 128
  s_and_b32 s12, s12, 4095
  s_barrier
  s_add_u32 m0, s31, 98304
  s_nop 0
  buffer_load_dwordx4 v105, s[8:11], s41 offen offset:0 lds
  buffer_load_dwordx4 v106, s[8:11], s41 offen offset:1024 lds
  buffer_load_dwordx4 v107, s[8:11], s41 offen offset:2048 lds
  buffer_load_dwordx4 v108, s[8:11], s41 offen offset:3072 lds
  s_add_u32 s41, s41, 128
  s_and_b32 s41, s41, 4095
  s_lshl_b32 s14, s12, 7
  s_add_u32 m0, s31, 114688
  s_add_u32 s14, s14, s13
  buffer_load_dwordx4 v104, s[16:19], s14 offen offset:0 sc1 lds
  buffer_load_dwordx4 v104, s[16:19], s14 offen offset:1024 sc1 lds
  buffer_load_dwordx4 v104, s[16:19], s14 offen offset:2048 sc1 lds
  buffer_load_dwordx4 v104, s[16:19], s14 offen offset:3072 sc1 lds
  s_add_u32 s12, s12, 128
  s_and_b32 s12, s12, 4095
  s_waitcnt vmcnt(24)
  s_barrier
  s_waitcnt vmcnt(16)
  s_barrier
  s_lshl_b32 s14, s12, 7
  s_add_u32 m0, s31, 16384
  s_add_u32 s14, s14, s13
  buffer_load_dwordx4 v104, s[16:19], s14 offen offset:0 sc1 lds
  buffer_load_dwordx4 v104, s[16:19], s14 offen offset:1024 sc1 lds
  buffer_load_dwordx4 v104, s[16:19], s14 offen offset:2048 sc1 lds
  buffer_load_dwordx4 v104, s[16:19], s14 offen offset:3072 sc1 lds
  s_add_u32 m0, s31, 0
  s_nop 0
  buffer_load_dwordx4 v105, s[8:11], s12 offen offset:0 lds
  buffer_load_dwordx4 v106, s[8:11], s12 offen offset:1024 lds
  buffer_load_dwordx4 v107, s[8:11], s12 offen offset:2048 lds
  buffer_load_dwordx4 v108, s[8:11], s12 offen offset:3072 lds
  s_add_u32 s12, s12, 128
  s_and_b32 s12, s12, 4095
  s_waitcnt vmcnt(16)
  s_barrier
  s_lshl_b32 s14, s12, 7
  s_add_u32 m0, s31, 49152
  s_add_u32 s14, s14, s13
  buffer_load_dwordx4 v104, s[16:19], s14 offen offset:0 sc1 lds
  buffer_load_dwordx4 v104, s[16:19], s14 offen offset:1024 sc1 lds
  buffer_load_dwordx4 v104, s[16:19], s14 offen offset:2048 sc1 lds
  buffer_load_dwordx4 v104, s[16:19], s14 offen offset:3072 sc1 lds
  s_add_u32 m0, s31, 32768
  s_nop 0
  buffer_load_dwordx4 v105, s[8:11], s12 offen offset:0 lds
  buffer_load_dwordx4 v106, s[8:11], s12 offen offset:1024 lds
  buffer_load_dwordx4 v107, s[8:11], s12 offen offset:2048 lds
  buffer_load_dwordx4 v108, s[8:11], s12 offen offset:3072 lds
  s_add_u32 s12, s12, 128
  s_and_b32 s12, s12, 4095
  s_branch L_p3go
L_late:
  s_barrier
  s_add_u32 m0, s31, 32768
  s_nop 0
  buffer_load_dwordx4 v105, s[8:11], s41 offen offset:0 lds
  buffer_load_dwordx4 v106, s[8:11], s41 offen offset:1024 lds
  buffer_load_dwordx4 v107, s[8:11], s41 offen offset:2048 lds
  buffer_load_dwordx4 v108, s[8:11], s41 offen offset:3072 lds
  s_add_u32 s41, s41, 128
  s_and_b32 s41, s41, 4095
  s_waitcnt vmcnt(8)
  s_barrier
  s_add_u32 m0, s31, 65536
  s_nop 0
  buffer_load_dwordx4 v105, s[8:11], s41 offen offset:0 lds
  buffer_load_dwordx4 v106, s[8:11], s41 offen offset:1024 lds
  buffer_load_dwordx4 v107, s[8:11], s41 offen offset:2048 lds
  buffer_load_dwordx4 v108, s[8:11], s41 offen offset:3072 lds
  s_add_u32 s41, s41, 128
  s_and_b32 s41, s41, 4095
  s_barrier
  s_add_u32 m0, s31, 98304
  s_nop 0
  buffer_load_dwordx4 v105, s[8:11], s41 offen offset:0 lds
  buffer_load_dwordx4 v106, s[8:11], s41 offen offset:1024 lds
  buffer_load_dwordx4 v107, s[8:11], s41 offen offset:2048 lds
  buffer_load_dwordx4 v108, s[8:11], s41 offen offset:3072 lds
  s_add_u32 s41, s41, 128
  s_and_b32 s41, s41, 4095
  s_mov_b32 s44, s88
  s_mov_b32 s45, s89
  s_mov_b32 s46, 0x100
  s_mov_b32 s47, 0x20000
  s_mov_b32 s56, 0
  v_mov_b32 v26, 0
L1_nn_2:
  buffer_load_dwordx2 v[24:25], v26, s[44:47], 0 offen sc1
L1_nn_2_c:
  s_waitcnt vmcnt(0)
  v_readfirstlane_b32 s92, v24
  v_readfirstlane_b32 s93, v25
  s_add_u32 s56, s56, 1
  s_cmp_lg_u32 s92, 0
  s_cbranch_scc1 L1_nd_3
  s_cmp_lt_u32 s56, 100000
  s_cbranch_scc1 L1_nn_2
L1_nd_3:
  s_mov_b32 s56, 0
L1_pf_4:
  v_and_b32 v26, 15, v0
  v_min_u32 v26, 15, v26
  v_lshlrev_b32 v26, 6, v26
  s_mov_b32 exec_hi, 0
  s_mov_b32 exec_lo, 0xffff
  buffer_load_dwordx2 v[24:25], v26, s[16:19], s42 offen sc1
  s_mov_b64 exec, -1
L1_pf_4_c:
  s_waitcnt vmcnt(0)
  v_cmp_eq_u64 vcc, s[92:93], v[24:25]
  s_and_b32 s36, vcc_lo, 0xffff
  s_cmp_eq_u32 s36, 0xffff
  s_cbranch_scc1 L1_pd_5
  s_sleep 2
  s_add_u32 s56, s56, 1
  s_cmp_lt_u32 s56, 100000
  s_cbranch_scc1 L1_pf_4
L1_pd_5:
  s_lshl_b32 s14, s12, 7
  s_add_u32 m0, s31, 16384
  s_add_u32 s14, s14, s13
  buffer_load_dwordx4 v104, s[16:19], s14 offen offset:0 sc1 lds
  buffer_load_dwordx4 v104, s[16:19], s14 offen offset:1024 sc1 lds
  buffer_load_dwordx4 v104, s[16:19], s14 offen offset:2048 sc1 lds
  buffer_load_dwordx4 v104, s[16:19], s14 offen offset:3072 sc1 lds
  s_add_u32 s12, s12, 128
  s_and_b32 s12, s12, 4095
  s_lshl_b32 s14, s12, 7
  s_add_u32 m0, s31, 49152
  s_add_u32 s14, s14, s13
  buffer_load_dwordx4 v104, s[16:19], s14 offen offset:0 sc1 lds
  buffer_load_dwordx4 v104, s[16:19], s14 offen offset:1024 sc1 lds
  buffer_load_dwordx4 v104, s[16:19], s14 offen offset:2048 sc1 lds
  buffer_load_dwordx4 v104, s[16:19], s14 offen offset:3072 sc1 lds
  s_add_u32 s12, s12, 128
  s_and_b32 s12, s12, 4095
  s_waitcnt vmcnt(4)
  s_barrier
  s_lshl_b32 s14, s12, 7
  s_add_u32 m0, s31, 81920
  s_add_u32 s14, s14, s13
  buffer_load_dwordx4 v104, s[16:19], s14 offen offset:0 sc1 lds
  buffer_load_dwordx4 v104, s[16:19], s14 offen offset:1024 sc1 lds
  buffer_load_dwordx4 v104, s[16:19], s14 offen offset:2048 sc1 lds
  buffer_load_dwordx4 v104, s[16:19], s14 offen offset:3072 sc1 lds
  s_add_u32 s12, s12, 128
  s_and_b32 s12, s12, 4095
  s_lshl_b32 s14, s12, 7
  s_add_u32 m0, s31, 114688
  s_add_u32 s14, s14, s13
  buffer_load_dwordx4 v104, s[16:19], s14 offen offset:0 sc1 lds
  buffer_load_dwordx4 v104, s[16:19], s14 offen offset:1024 sc1 lds
  buffer_load_dwordx4 v104, s[16:19], s14 offen offset:2048 sc1 lds
  buffer_load_dwordx4 v104, s[16:19], s14 offen offset:3072 sc1 lds
  s_add_u32 s12, s12, 128
  s_and_b32 s12, s12, 4095
  s_waitcnt vmcnt(8)
  s_barrier
  s_lshl_b32 s14, s12, 7
  s_add_u32 m0, s31, 16384
  s_add_u32 s14, s14, s13
  buffer_load_dwordx4 v104, s[16:19], s14 offen offset:0 sc1 lds
  buffer_load_dwordx4 v104, s[16:19], s14 offen offset:1024 sc1 lds
  buffer_load_dwordx4 v104, s[16:19], s14 offen offset:2048 sc1 lds
  buffer_load_dwordx4 v104, s[16:19], s14 offen offset:3072 sc1 lds
  s_add_u32 m0, s31, 0
  s_nop 0
  buffer_load_dwordx4 v105, s[8:11], s12 offen offset:0 lds
  buffer_load_dwordx4 v106, s[8:11], s12 offen offset:1024 lds
  buffer_load_dwordx4 v107, s[8:11], s12 offen offset:2048 lds
  buffer_load_dwordx4 v108, s[8:11], s12 offen offset:3072 lds
  s_add_u32 s12, s12, 128
  s_and_b32 s12, s12, 4095
  s_waitcnt vmcnt(12)
  s_barrier
  s_lshl_b32 s14, s12, 7
  s_add_u32 m0, s31, 49152
  s_add_u32 s14, s14, s13
  buffer_load_dwordx4 v104, s[16:19], s14 offen offset:0 sc1 lds
  buffer_load_dwordx4 v104, s[16:19], s14 offen offset:1024 sc1 lds
  buffer_load_dwordx4 v104, s[16:19], s14 offen offset:2048 sc1 lds
  buffer_load_dwordx4 v104, s[16:19], s14 offen offset:3072 sc1 lds
  s_add_u32 m0, s31, 32768
  s_nop 0
  buffer_load_dwordx4 v105, s[8:11], s12 offen offset:0 lds
  buffer_load_dwordx4 v106, s[8:11], s12 offen offset:1024 lds
  buffer_load_dwordx4 v107, s[8:11], s12 offen offset:2048 lds
  buffer_load_dwordx4 v108, s[8:11], s12 offen offset:3072 lds
  s_add_u32 s12, s12, 128
  s_and_b32 s12, s12, 4095
L_p3go:
  s_lshr_b32 s6, s3, 1
  s_lshl_b32 s6, s6, 2
  s_lshr_b32 s37, s4, 3
  s_add_u32 s6, s6, s37
  s_and_b32 s7, s3, 1
  s_lshl_b32 s7, s7, 3
  s_and_b32 s37, s4, 7
  s_add_u32 s7, s7, s37
  s_mov_b32 s20, s82
  s_mov_b32 s21, s83
  s_mov_b32 s22, 0x380000
  s_mov_b32 s23, 0x20000
  v_lshlrev_b32 v8, 4, v0
  s_lshl_b32 s41, s26, 11
  v_add_u32 v16, s41, v8
  v_add_u32 v17, 57344, v16
  v_lshrrev_b32 v10, 3, v0
  v_and_b32 v11, 7, v0
  v_bfe_u32 v12, v0, 4, 1
  v_lshlrev_b32 v12, 1, v12
  v_xor_b32 v11, v11, v12
  v_lshlrev_b32 v11, 4, v11
  s_lshl_b32 s37, s26, 4
  v_add_u32 v10, s37, v10
  v_lshlrev_b32 v10, 11, v10
  s_lshl_b32 s37, s7, 7
  v_add_u32 v10, s37, v10
  v_add_u32 v14, v10, v11
  v_xor_b32 v11, 64, v11
  v_add_u32 v10, 15360, v10
  v_add_u32 v15, v10, v11
  s_and_b32 s32, s3, 1
  s_mul_i32 s32, s32, 14
  s_add_u32 s43, s32, 14
  s_sub_u32 s37, s43, 28
  s_cmp_ge_u32 s43, 28
  s_cselect_b32 s43, s37, s43
  s_waitcnt vmcnt(16)
  s_barrier
  s_lshl_b32 s14, s12, 7
  s_add_u32 m0, s31, 81920
  s_add_u32 s14, s14, s13
  buffer_load_dwordx4 v104, s[16:19], s14 offen offset:0 sc1 lds
  buffer_load_dwordx4 v104, s[16:19], s14 offen offset:1024 sc1 lds
  buffer_load_dwordx4 v104, s[16:19], s14 offen offset:2048 sc1 lds
  buffer_load_dwordx4 v104, s[16:19], s14 offen offset:3072 sc1 lds
  s_add_u32 m0, s31, 65536
  s_nop 0
  buffer_load_dwordx4 v105, s[8:11], s12 offen offset:0 lds
  buffer_load_dwordx4 v106, s[8:11], s12 offen offset:1024 lds
  buffer_load_dwordx4 v107, s[8:11], s12 offen offset:2048 lds
  buffer_load_dwordx4 v108, s[8:11], s12 offen offset:3072 lds
  s_add_u32 s12, s12, 128
  s_and_b32 s12, s12, 4095
  s_waitcnt vmcnt(16)
  s_barrier
  s_lshl_b32 s14, s12, 7
  s_add_u32 m0, s31, 114688
  s_add_u32 s14, s14, s13
  buffer_load_dwordx4 v104, s[16:19], s14 offen offset:0 sc1 lds
  buffer_load_dwordx4 v104, s[16:19], s14 offen offset:1024 sc1 lds
  buffer_load_dwordx4 v104, s[16:19], s14 offen offset:2048 sc1 lds
  buffer_load_dwordx4 v104, s[16:19], s14 offen offset:3072 sc1 lds
  s_add_u32 m0, s31, 98304
  s_nop 0
  buffer_load_dwordx4 v105, s[8:11], s12 offen offset:0 lds
  buffer_load_dwordx4 v106, s[8:11], s12 offen offset:1024 lds
  buffer_load_dwordx4 v107, s[8:11], s12 offen offset:2048 lds
  buffer_load_dwordx4 v108, s[8:11], s12 offen offset:3072 lds
  s_add_u32 s12, s12, 128
  s_and_b32 s12, s12, 4095
  s_mov_b32 s35, 6
L1_ld_6:
  s_waitcnt vmcnt(16)
  s_barrier
  s_lshl_b32 s14, s12, 7
  s_add_u32 m0, s31, 16384
  s_add_u32 s14, s14, s13
  buffer_load_dwordx4 v104, s[16:19], s14 offen offset:0 sc1 lds
  buffer_load_dwordx4 v104, s[16:19], s14 offen offset:1024 sc1 lds
  buffer_load_dwordx4 v104, s[16:19], s14 offen offset:2048 sc1 lds
  buffer_load_dwordx4 v104, s[16:19], s14 offen offset:3072 sc1 lds
  s_add_u32 m0, s31, 0
  s_nop 0
  buffer_load_dwordx4 v105, s[8:11], s12 offen offset:0 lds
  buffer_load_dwordx4 v106, s[8:11], s12 offen offset:1024 lds
  buffer_load_dwordx4 v107, s[8:11], s12 offen offset:2048 lds
  buffer_load_dwordx4 v108, s[8:11], s12 offen offset:3072 lds
  s_add_u32 s12, s12, 128
  s_and_b32 s12, s12, 4095
  s_waitcnt vmcnt(16)
  s_barrier
  s_lshl_b32 s14, s12, 7
  s_add_u32 m0, s31, 49152
  s_add_u32 s14, s14, s13
  buffer_load_dwordx4 v104, s[16:19], s14 offen offset:0 sc1 lds
  buffer_load_dwordx4 v104, s[16:19], s14 offen offset:1024 sc1 lds
  buffer_load_dwordx4 v104, s[16:19], s14 offen offset:2048 sc1 lds
  buffer_load_dwordx4 v104, s[16:19], s14 offen offset:3072 sc1 lds
  s_add_u32 m0, s31, 32768
  s_nop 0
  buffer_load_dwordx4 v105, s[8:11], s12 offen offset:0 lds
  buffer_load_dwordx4 v106, s[8:11], s12 offen offset:1024 lds
  buffer_load_dwordx4 v107, s[8:11], s12 offen offset:2048 lds
  buffer_load_dwordx4 v108, s[8:11], s12 offen offset:3072 lds
  s_add_u32 s12, s12, 128
  s_and_b32 s12, s12, 4095
  s_waitcnt vmcnt(16)
  s_barrier
  s_lshl_b32 s14, s12, 7
  s_add_u32 m0, s31, 81920
  s_add_u32 s14, s14, s13
  buffer_load_dwordx4 v104, s[16:19], s14 offen offset:0 sc1 lds
  buffer_load_dwordx4 v104, s[16:19], s14 offen offset:1024 sc1 lds
  buffer_load_dwordx4 v104, s[16:19], s14 offen offset:2048 sc1 lds
  buffer_load_dwordx4 v104, s[16:19], s14 offen offset:3072 sc1 lds
  s_add_u32 m0, s31, 65536
  s_nop 0
  buffer_load_dwordx4 v105, s[8:11], s12 offen offset:0 lds
  buffer_load_dwordx4 v106, s[8:11], s12 offen offset:1024 lds
  buffer_load_dwordx4 v107, s[8:11], s12 offen offset:2048 lds
  buffer_load_dwordx4 v108, s[8:11], s12 offen offset:3072 lds
  s_add_u32 s12, s12, 128
  s_and_b32 s12, s12, 4095
  s_waitcnt vmcnt(16)
  s_barrier
  s_lshl_b32 s14, s12, 7
  s_add_u32 m0, s31, 114688
  s_add_u32 s14, s14, s13
  buffer_load_dwordx4 v104, s[16:19], s14 offen offset:0 sc1 lds
  buffer_load_dwordx4 v104, s[16:19], s14 offen offset:1024 sc1 lds
  buffer_load_dwordx4 v104, s[16:19], s14 offen offset:2048 sc1 lds
  buffer_load_dwordx4 v104, s[16:19], s14 offen offset:3072 sc1 lds
  s_add_u32 m0, s31, 98304
  s_nop 0
  buffer_load_dwordx4 v105, s[8:11], s12 offen offset:0 lds
  buffer_load_dwordx4 v106, s[8:11], s12 offen offset:1024 lds
  buffer_load_dwordx4 v107, s[8:11], s12 offen offset:2048 lds
  buffer_load_dwordx4 v108, s[8:11], s12 offen offset:3072 lds
  s_add_u32 s12, s12, 128
  s_and_b32 s12, s12, 4095
  s_sub_u32 s35, s35, 1
  s_cmp_lg_u32 s35, 0
  s_cbranch_scc1 L1_ld_6
  s_waitcnt vmcnt(16)
  s_barrier
  s_lshl_b32 s40, s43, 17
  s_add_u32 s43, s43, 1
  s_cmp_eq_u32 s43, 28
  s_cselect_b32 s43, 0, s43
  buffer_load_dwordx4 v[128:131], v14, s[20:23], s40 offen offset:0
  buffer_load_dwordx4 v[132:135], v15, s[20:23], s40 offen offset:1024
  s_lshl_b32 s40, s43, 17
  s_add_u32 s43, s43, 1
  s_cmp_eq_u32 s43, 28
  s_cselect_b32 s43, 0, s43
  buffer_load_dwordx4 v[136:139], v14, s[20:23], s40 offen offset:0
  buffer_load_dwordx4 v[140:143], v15, s[20:23], s40 offen offset:1024
  s_lshl_b32 s40, s43, 17
  s_add_u32 s43, s43, 1
  s_cmp_eq_u32 s43, 28
  s_cselect_b32 s43, 0, s43
  buffer_load_dwordx4 v[144:147], v14, s[20:23], s40 offen offset:0
  buffer_load_dwordx4 v[148:151], v15, s[20:23], s40 offen offset:1024
  s_waitcnt vmcnt(14)
  s_barrier
  s_lshl_b32 s40, s43, 17
  s_add_u32 s43, s43, 1
  s_cmp_eq_u32 s43, 28
  s_cselect_b32 s43, 0, s43
  buffer_load_dwordx4 v[152:155], v14, s[20:23], s40 offen offset:0
  buffer_load_dwordx4 v[156:159], v15, s[20:23], s40 offen offset:1024
  s_lshl_b32 s40, s43, 17
  s_add_u32 s43, s43, 1
  s_cmp_eq_u32 s43, 28
  s_cselect_b32 s43, 0, s43
  buffer_load_dwordx4 v[160:163], v14, s[20:23], s40 offen offset:0
  buffer_load_dwordx4 v[164:167], v15, s[20:23], s40 offen offset:1024
  s_lshl_b32 s40, s43, 17
  s_add_u32 s43, s43, 1
  s_cmp_eq_u32 s43, 28
  s_cselect_b32 s43, 0, s43
  buffer_load_dwordx4 v[168:171], v14, s[20:23], s40 offen offset:0
  buffer_load_dwordx4 v[172:175], v15, s[20:23], s40 offen offset:1024
  s_lshl_b32 s40, s43, 17
  s_add_u32 s43, s43, 1
  s_cmp_eq_u32 s43, 28
  s_cselect_b32 s43, 0, s43
  buffer_load_dwordx4 v[176:179], v14, s[20:23], s40 offen offset:0
  buffer_load_dwordx4 v[180:183], v15, s[20:23], s40 offen offset:1024
  s_waitcnt vmcnt(14)
  s_barrier
  s_lshl_b32 s40, s43, 17
  s_add_u32 s43, s43, 1
  s_cmp_eq_u32 s43, 28
  s_cselect_b32 s43, 0, s43
  buffer_load_dwordx4 v[184:187], v14, s[20:23], s40 offen offset:0
  buffer_load_dwordx4 v[188:191], v15, s[20:23], s40 offen offset:1024
  s_lshl_b32 s40, s43, 17
  s_add_u32 s43, s43, 1
  s_cmp_eq_u32 s43, 28
  s_cselect_b32 s43, 0, s43
  buffer_load_dwordx4 v[192:195], v14, s[20:23], s40 offen offset:0
  buffer_load_dwordx4 v[196:199], v15, s[20:23], s40 offen offset:1024
  s_lshl_b32 s40, s43, 17
  s_add_u32 s43, s43, 1
  s_cmp_eq_u32 s43, 28
  s_cselect_b32 s43, 0, s43
  buffer_load_dwordx4 v[200:203], v14, s[20:23], s40 offen offset:0
  buffer_load_dwordx4 v[204:207], v15, s[20:23], s40 offen offset:1024
  s_barrier
  s_lshl_b32 s40, s43, 17
  s_add_u32 s43, s43, 1
  s_cmp_eq_u32 s43, 28
  s_cselect_b32 s43, 0, s43
  buffer_load_dwordx4 v[208:211], v14, s[20:23], s40 offen offset:0
  buffer_load_dwordx4 v[212:215], v15, s[20:23], s40 offen offset:1024
  s_lshl_b32 s40, s43, 17
  s_add_u32 s43, s43, 1
  s_cmp_eq_u32 s43, 28
  s_cselect_b32 s43, 0, s43
  buffer_load_dwordx4 v[216:219], v14, s[20:23], s40 offen offset:0
  buffer_load_dwordx4 v[220:223], v15, s[20:23], s40 offen offset:1024
  s_lshl_b32 s40, s43, 17
  s_add_u32 s43, s43, 1
  s_cmp_eq_u32 s43, 28
  s_cselect_b32 s43, 0, s43
  buffer_load_dwordx4 v[224:227], v14, s[20:23], s40 offen offset:0
  buffer_load_dwordx4 v[228:231], v15, s[20:23], s40 offen offset:1024
  s_lshl_b32 s40, s43, 17
  s_add_u32 s43, s43, 1
  s_cmp_eq_u32 s43, 28
  s_cselect_b32 s43, 0, s43
  buffer_load_dwordx4 v[232:235], v14, s[20:23], s40 offen offset:0
  buffer_load_dwordx4 v[236:239], v15, s[20:23], s40 offen offset:1024
  v_mov_b32 v10, 155664
  s_mov_b32 s56, 0
L3_stw:
  ds_read_b32 v11, v10
  s_add_u32 s56, s56, 1
  s_waitcnt lgkmcnt(0)
  v_readfirstlane_b32 s37, v11
  s_cmp_ge_u32 s37, 4
  s_cbranch_scc1 L3_stw_d
  s_sleep 1
  s_cmp_lt_u32 s56, 1600000
  s_cbranch_scc1 L3_stw
L3_stw_d:
L4_load:
  s_setprio 0
  s_add_u32 m0, s41, 0
  s_lshl_b32 s40, s32, 17
  buffer_load_dwordx4 v14, s[20:23], s40 offen offset:0 lds
  buffer_load_dwordx4 v15, s[20:23], s40 offen offset:1024 lds
  s_add_u32 s32, s32, 1
  s_cmp_eq_u32 s32, 28
  s_cselect_b32 s32, 0, s32
  s_add_u32 m0, s41, 8192
  s_lshl_b32 s40, s32, 17
  buffer_load_dwordx4 v14, s[20:23], s40 offen offset:0 lds
  buffer_load_dwordx4 v15, s[20:23], s40 offen offset:1024 lds
  s_add_u32 s32, s32, 1
  s_cmp_eq_u32 s32, 28
  s_cselect_b32 s32, 0, s32
  s_add_u32 m0, s41, 16384
  s_lshl_b32 s40, s32, 17
  buffer_load_dwordx4 v14, s[20:23], s40 offen offset:0 lds
  buffer_load_dwordx4 v15, s[20:23], s40 offen offset:1024 lds
  s_add_u32 s32, s32, 1
  s_cmp_eq_u32 s32, 28
  s_cselect_b32 s32, 0, s32
  s_add_u32 m0, s41, 24576
  s_lshl_b32 s40, s32, 17
  buffer_load_dwordx4 v14, s[20:23], s40 offen offset:0 lds
  buffer_load_dwordx4 v15, s[20:23], s40 offen offset:1024 lds
  s_add_u32 s32, s32, 1
  s_cmp_eq_u32 s32, 28
  s_cselect_b32 s32, 0, s32
  s_add_u32 m0, s41, 32768
  s_lshl_b32 s40, s32, 17
  buffer_load_dwordx4 v14, s[20:23], s40 offen offset:0 lds
  buffer_load_dwordx4 v15, s[20:23], s40 offen offset:1024 lds
  s_add_u32 s32, s32, 1
  s_cmp_eq_u32 s32, 28
  s_cselect_b32 s32, 0, s32
  s_add_u32 m0, s41, 40960
  s_lshl_b32 s40, s32, 17
  buffer_load_dwordx4 v14, s[20:23], s40 offen offset:0 lds
  buffer_load_dwordx4 v15, s[20:23], s40 offen offset:1024 lds
  s_add_u32 s32, s32, 1
  s_cmp_eq_u32 s32, 28
  s_cselect_b32 s32, 0, s32
  s_add_u32 m0, s41, 49152
  s_lshl_b32 s40, s32, 17
  buffer_load_dwordx4 v14, s[20:23], s40 offen offset:0 lds
  buffer_load_dwordx4 v15, s[20:23], s40 offen offset:1024 lds
  s_add_u32 s32, s32, 1
  s_cmp_eq_u32 s32, 28
  s_cselect_b32 s32, 0, s32
  s_add_u32 m0, s41, 57344
  s_lshl_b32 s40, s32, 17
  buffer_load_dwordx4 v14, s[20:23], s40 offen offset:0 lds
  buffer_load_dwordx4 v15, s[20:23], s40 offen offset:1024 lds
  s_add_u32 s32, s32, 1
  s_cmp_eq_u32 s32, 28
  s_cselect_b32 s32, 0, s32
  s_add_u32 m0, s41, 65536
  s_lshl_b32 s40, s32, 17
  buffer_load_dwordx4 v14, s[20:23], s40 offen offset:0 lds
  buffer_load_dwordx4 v15, s[20:23], s40 offen offset:1024 lds
  s_add_u32 s32, s32, 1
  s_cmp_eq_u32 s32, 28
  s_cselect_b32 s32, 0, s32
  s_add_u32 m0, s41, 73728
  s_lshl_b32 s40, s32, 17
  buffer_load_dwordx4 v14, s[20:23], s40 offen offset:0 lds
  buffer_load_dwordx4 v15, s[20:23], s40 offen offset:1024 lds
  s_add_u32 s32, s32, 1
  s_cmp_eq_u32 s32, 28
  s_cselect_b32 s32, 0, s32
  s_add_u32 m0, s41, 81920
  s_lshl_b32 s40, s32, 17
  buffer_load_dwordx4 v14, s[20:23], s40 offen offset:0 lds
  buffer_load_dwordx4 v15, s[20:23], s40 offen offset:1024 lds
  s_add_u32 s32, s32, 1
  s_cmp_eq_u32 s32, 28
  s_cselect_b32 s32, 0, s32
  s_add_u32 m0, s41, 90112
  s_lshl_b32 s40, s32, 17
  buffer_load_dwordx4 v14, s[20:23], s40 offen offset:0 lds
  buffer_load_dwordx4 v15, s[20:23], s40 offen offset:1024 lds
  s_add_u32 s32, s32, 1
  s_cmp_eq_u32 s32, 28
  s_cselect_b32 s32, 0, s32
  s_add_u32 m0, s41, 98304
  s_lshl_b32 s40, s32, 17
  buffer_load_dwordx4 v14, s[20:23], s40 offen offset:0 lds
  buffer_load_dwordx4 v15, s[20:23], s40 offen offset:1024 lds
  s_add_u32 s32, s32, 1
  s_cmp_eq_u32 s32, 28
  s_cselect_b32 s32, 0, s32
  s_add_u32 m0, s41, 106496
  s_lshl_b32 s40, s32, 17
  buffer_load_dwordx4 v14, s[20:23], s40 offen offset:0 lds
  buffer_load_dwordx4 v15, s[20:23], s40 offen offset:1024 lds
  s_add_u32 s32, s32, 1
  s_cmp_eq_u32 s32, 28
  s_cselect_b32 s32, 0, s32
  s_cmp_ge_u32 s6, 8
  s_cselect_b32 s42, -1, 1
  s_cselect_b32 s39, 1, 0
  s_lshl_b32 s37, s6, 7
  s_sub_u32 s52, 2048, s37
  s_cmp_ge_u32 s6, 8
  s_cselect_b32 s52, s52, s37
  s_lshl_b32 s53, s7, 7
  s_sub_u32 s54, 1920, s53
  s_cmp_ge_u32 s7, 8
  s_cselect_b32 s53, s54, s53
  s_cselect_b32 s54, 1, 0
  s_xor_b32 s39, s39, s54
  s_cmp_eq_u32 s39, 0
  s_mov_b32 s57, 30605312
  s_cmov_b32 s57, 29360128
  s_add_u32 s57, s57, s53
  s_mul_i32 s54, s26, 320
  s_movk_i32 s55, 7282
  v_add_u32 v10, s54, v0
  v_add_u32 v10, 0, v10
  v_mul_u32_u24 v11, s55, v10
  v_lshrrev_b32 v11, 16, v11
  v_mul_u32_u24 v12, 9, v11
  v_sub_u32 v10, v10, v12
  v_min_u32 v11, 127, v11
  v_mul_lo_u32 v11, v11, s42
  v_add_u32 v11, s52, v11
  v_mul_u32_u24 v11, 1152, v11
  v_lshl_add_u32 v18, v10, 4, v11
  v_add_u32 v10, s54, v0
  v_add_u32 v10, 64, v10
  v_mul_u32_u24 v11, s55, v10
  v_lshrrev_b32 v11, 16, v11
  v_mul_u32_u24 v12, 9, v11
  v_sub_u32 v10, v10, v12
  v_min_u32 v11, 127, v11
  v_mul_lo_u32 v11, v11, s42
  v_add_u32 v11, s52, v11
  v_mul_u32_u24 v11, 1152, v11
  v_lshl_add_u32 v19, v10, 4, v11
  v_add_u32 v10, s54, v0
  v_add_u32 v10, 128, v10
  v_mul_u32_u24 v11, s55, v10
  v_lshrrev_b32 v11, 16, v11
  v_mul_u32_u24 v12, 9, v11
  v_sub_u32 v10, v10, v12
  v_min_u32 v11, 127, v11
  v_mul_lo_u32 v11, v11, s42
  v_add_u32 v11, s52, v11
  v_mul_u32_u24 v11, 1152, v11
  v_lshl_add_u32 v20, v10, 4, v11
  v_add_u32 v10, s54, v0
  v_add_u32 v10, 192, v10
  v_mul_u32_u24 v11, s55, v10
  v_lshrrev_b32 v11, 16, v11
  v_mul_u32_u24 v12, 9, v11
  v_sub_u32 v10, v10, v12
  v_min_u32 v11, 127, v11
  v_mul_lo_u32 v11, v11, s42
  v_add_u32 v11, s52, v11
  v_mul_u32_u24 v11, 1152, v11
  v_lshl_add_u32 v21, v10, 4, v11
  v_add_u32 v10, s54, v0
  v_add_u32 v10, 256, v10
  v_mul_u32_u24 v11, s55, v10
  v_lshrrev_b32 v11, 16, v11
  v_mul_u32_u24 v12, 9, v11
  v_sub_u32 v10, v10, v12
  v_min_u32 v11, 127, v11
  v_mul_lo_u32 v11, v11, s42
  v_add_u32 v11, s52, v11
  v_mul_u32_u24 v11, 1152, v11
  v_lshl_add_u32 v22, v10, 4, v11
  s_lshr_b32 s40, s6, 2
  s_mov_b32 s53, 0
  s_cmp_eq_u32 s40, 1
  s_cmov_b32 s53, 2048
  s_cmp_eq_u32 s40, 2
  s_cmov_b32 s53, 512
  s_cmp_eq_u32 s40, 3
  s_cmov_b32 s53, 2560
  s_and_b32 s40, s40, 1
  s_cmp_eq_u32 s40, 1
  s_cselect_b32 s42, -1, 1
  s_lshl_b32 s40, s26, 5
  s_add_u32 s37, s37, s40
  v_and_b32 v10, 31, v0
  v_add_u32 v10, s37, v10
  v_mul_lo_u32 v11, v10, s42
  v_add_u32 v11, s53, v11
  v_mov_b32 v12, 2050
  v_cmp_eq_u32 vcc, 512, v10
  s_nop 1
  v_cndmask_b32 v11, v11, v12, vcc
  v_mov_b32 v12, 2051
  v_cmp_eq_u32 vcc, 1536, v10
  s_nop 1
  v_cndmask_b32 v11, v11, v12, vcc
  v_mov_b32 v12, 1024
  v_cmp_eq_u32 vcc, 1024, v10
  s_nop 1
  v_cndmask_b32 v11, v11, v12, vcc
  v_lshlrev_b32 v23, 2, v11
  s_cmp_lg_u32 s26, 0
  s_cbranch_scc1 L4_lwait
  s_lshl_b32 s42, s6, 10
  s_add_u32 s42, s42, 31997952
  s_and_b32 s43, s3, 1
  s_mul_i32 s43, s43, 448
  s_add_u32 s43, s43, s42
  v_and_b32 v30, 15, v0
  v_min_u32 v30, 6, v30
  v_lshlrev_b32 v30, 6, v30
  s_mov_b32 exec_hi, 0
  s_mov_b32 exec_lo, 0x7f
  s_mov_b32 s56, 0
  buffer_load_dwordx2 v[24:25], v30, s[16:19], s43 offen sc1
  s_sleep 3
  buffer_load_dwordx2 v[26:27], v30, s[16:19], s43 offen sc1
  s_sleep 3
L1_pp_7:
  buffer_load_dwordx2 v[28:29], v30, s[16:19], s43 offen sc1
  s_waitcnt vmcnt(2)
  v_cmp_eq_u64 vcc, s[92:93], v[24:25]
  s_cmp_eq_u32 vcc_lo, 0x7f
  s_cbranch_scc1 L1_pp_7_d
  buffer_load_dwordx2 v[24:25], v30, s[16:19], s43 offen sc1
  s_waitcnt vmcnt(2)
  v_cmp_eq_u64 vcc, s[92:93], v[26:27]
  s_cmp_eq_u32 vcc_lo, 0x7f
  s_cbranch_scc1 L1_pp_7_d
  buffer_load_dwordx2 v[26:27], v30, s[16:19], s43 offen sc1
  s_waitcnt vmcnt(2)
  v_cmp_eq_u64 vcc, s[92:93], v[28:29]
  s_cmp_eq_u32 vcc_lo, 0x7f
  s_cbranch_scc1 L1_pp_7_d
  s_add_u32 s56, s56, 1
  s_cmp_lt_u32 s56, 100000
  s_cbranch_scc1 L1_pp_7
L1_pp_7_d:
  s_mov_b64 exec, -1
L4_lwait:
  s_waitcnt vmcnt(0)
  s_barrier
  s_cmp_lg_u32 s26, 0
  s_cbranch_scc1 L4_lw2
  s_mov_b32 s56, 0
L1_pf_8:
  v_and_b32 v26, 15, v0
  v_min_u32 v26, 13, v26
  v_lshlrev_b32 v26, 6, v26
  s_mov_b32 exec_hi, 0
  s_mov_b32 exec_lo, 0x3fff
  buffer_load_dwordx2 v[24:25], v26, s[16:19], s42 offen sc1
  s_mov_b64 exec, -1
L1_pf_8_c:
  s_waitcnt vmcnt(0)
  v_cmp_eq_u64 vcc, s[92:93], v[24:25]
  s_and_b32 s36, vcc_lo, 0x3fff
  s_cmp_eq_u32 s36, 0x3fff
  s_cbranch_scc1 L1_pd_9
  s_sleep 2
  s_add_u32 s56, s56, 1
  s_cmp_lt_u32 s56, 100000
  s_cbranch_scc1 L1_pf_8
L1_pd_9:
  s_mov_b32 s42, 32018432
  s_mov_b32 s56, 0
L1_pf_10:
  v_and_b32 v26, 31, v0
  v_min_u32 v26, 31, v26
  v_lshlrev_b32 v26, 6, v26
  s_mov_b32 exec_hi, 0
  s_mov_b32 exec_lo, 0xffffffff
  buffer_load_dwordx2 v[24:25], v26, s[16:19], s42 offen sc1
  s_mov_b64 exec, -1
L1_pf_10_c:
  s_waitcnt vmcnt(0)
  v_cmp_eq_u64 vcc, s[92:93], v[24:25]
  s_and_b32 s36, vcc_lo, 0xffffffff
  s_cmp_eq_u32 s36, 0xffffffff
  s_cbranch_scc1 L1_pd_11
  s_sleep 8
  s_add_u32 s56, s56, 1
  s_cmp_lt_u32 s56, 100000
  s_cbranch_scc1 L1_pf_10
L1_pd_11:
L4_lw2:
  s_barrier
  ds_write_b128 v16, v[128:131] offset:0
  ds_write_b128 v16, v[132:135] offset:1024
  ds_write_b128 v16, v[136:139] offset:8192
  ds_write_b128 v16, v[140:143] offset:9216
  ds_write_b128 v16, v[144:147] offset:16384
  ds_write_b128 v16, v[148:151] offset:17408
  ds_write_b128 v16, v[152:155] offset:24576
  ds_write_b128 v16, v[156:159] offset:25600
  ds_write_b128 v16, v[160:163] offset:32768
  ds_write_b128 v16, v[164:167] offset:33792
  ds_write_b128 v16, v[168:171] offset:40960
  ds_write_b128 v16, v[172:175] offset:41984
  ds_write_b128 v16, v[176:179] offset:49152
  ds_write_b128 v16, v[180:183] offset:50176
  s_mul_i32 s40, s26, 5120
  s_add_u32 s40, s40, 131072
  s_add_u32 m0, s40, 0
  s_nop 0
  buffer_load_dwordx4 v18, s[16:19], s57 offen sc1 lds
  s_add_u32 m0, s40, 1024
  s_nop 0
  buffer_load_dwordx4 v19, s[16:19], s57 offen sc1 lds
  s_add_u32 m0, s40, 2048
  s_nop 0
  buffer_load_dwordx4 v20, s[16:19], s57 offen sc1 lds
  s_add_u32 m0, s40, 3072
  s_nop 0
  buffer_load_dwordx4 v21, s[16:19], s57 offen sc1 lds
  s_add_u32 m0, s40, 4096
  s_nop 0
  buffer_load_dwordx4 v22, s[16:19], s57 offen sc1 lds
  s_lshl_b32 s40, s26, 8
  s_add_u32 m0, s40, 151552
  s_mov_b32 s40, 28323840
  buffer_load_dword v23, s[16:19], s40 offen sc1 lds
  s_waitcnt vmcnt(63) lgkmcnt(0)
  s_barrier
  ds_write_b128 v17, v[184:187] offset:0
  ds_write_b128 v17, v[188:191] offset:1024
  ds_write_b128 v17, v[192:195] offset:8192
  ds_write_b128 v17, v[196:199] offset:9216
  ds_write_b128 v17, v[200:203] offset:16384
  ds_write_b128 v17, v[204:207] offset:17408
  ds_write_b128 v17, v[208:211] offset:24576
  ds_write_b128 v17, v[212:215] offset:25600
  ds_write_b128 v17, v[216:219] offset:32768
  ds_write_b128 v17, v[220:223] offset:33792
  ds_write_b128 v17, v[224:227] offset:40960
  ds_write_b128 v17, v[228:231] offset:41984
  ds_write_b128 v17, v[232:235] offset:49152
  ds_write_b128 v17, v[236:239] offset:50176
  s_waitcnt vmcnt(0) lgkmcnt(0)
  s_barrier
  s_barrier
  s_endpgm
L_A:
  s_cmp_ge_u32 s4, 4
  s_cbranch_scc1 L_nocpf
  s_sub_u32 s56, s58, L_b4-gated_mix__spectral_fnet__mixer_gmlp__prompt_kernel
  s_subb_u32 s57, s59, 0
  s_lshl_b32 s37, s4, 2
  s_add_u32 s37, s37, s26
  s_mul_i32 s37, s37, 4096
  v_add_u32 v16, s37, v109
  v_min_u32 v16, L_end-gated_mix__spectral_fnet__mixer_gmlp__prompt_kernel-4096, v16
  global_load_dwordx4 v[120:123], v16, s[56:57] offset:0
  global_load_dwordx4 v[120:123], v16, s[56:57] offset:1024
  global_load_dwordx4 v[120:123], v16, s[56:57] offset:2048
  global_load_dwordx4 v[120:123], v16, s[56:57] offset:3072
  v_add_u32 v16, 4096, v16
L_nocpf:
  v_mov_b32 v124, 0
  v_mov_b32 v125, 0
  v_mov_b32 v126, 0
  v_mov_b32 v127, 0
  s_mov_b32 s48, s80
  s_mov_b32 s49, s81
  s_mov_b32 s50, 0x1000
  s_mov_b32 s51, 0x20000
  v_mov_b32 v128, 0
  v_mov_b32 v129, 0
  v_mov_b32 v130, 0
  v_mov_b32 v131, 0
  v_mov_b32 v132, 0
  v_mov_b32 v133, 0
  v_mov_b32 v134, 0
  v_mov_b32 v135, 0
  v_mov_b32 v136, 0
  v_mov_b32 v137, 0
  v_mov_b32 v138, 0
  v_mov_b32 v139, 0
  v_mov_b32 v140, 0
  v_mov_b32 v141, 0
  v_mov_b32 v142, 0
  v_mov_b32 v143, 0
  v_mov_b32 v144, 0
  v_mov_b32 v145, 0
  v_mov_b32 v146, 0
  v_mov_b32 v147, 0
  v_mov_b32 v148, 0
  v_mov_b32 v149, 0
  v_mov_b32 v150, 0
  v_mov_b32 v151, 0
  v_mov_b32 v152, 0
  v_mov_b32 v153, 0
  v_mov_b32 v154, 0
  v_mov_b32 v155, 0
  v_mov_b32 v156, 0
  v_mov_b32 v157, 0
  v_mov_b32 v158, 0
  v_mov_b32 v159, 0
  v_mov_b32 v160, 0
  v_mov_b32 v161, 0
  v_mov_b32 v162, 0
  v_mov_b32 v163, 0
  v_mov_b32 v164, 0
  v_mov_b32 v165, 0
  v_mov_b32 v166, 0
  v_mov_b32 v167, 0
  v_mov_b32 v168, 0
  v_mov_b32 v169, 0
  v_mov_b32 v170, 0
  v_mov_b32 v171, 0
  v_mov_b32 v172, 0
  v_mov_b32 v173, 0
  v_mov_b32 v174, 0
  v_mov_b32 v175, 0
  v_mov_b32 v176, 0
  v_mov_b32 v177, 0
  v_mov_b32 v178, 0
  v_mov_b32 v179, 0
  v_mov_b32 v180, 0
  v_mov_b32 v181, 0
  v_mov_b32 v182, 0
  v_mov_b32 v183, 0
  v_mov_b32 v184, 0
  v_mov_b32 v185, 0
  v_mov_b32 v186, 0
  v_mov_b32 v187, 0
  v_mov_b32 v188, 0
  v_mov_b32 v189, 0
  v_mov_b32 v190, 0
  v_mov_b32 v191, 0
  v_mov_b32 v16, 155648
  ds_write_b128 v16, v[128:131]
  ds_write_b128 v16, v[128:131] offset:16
  s_lshl_b32 s37, s26, 10
  s_add_u32 s37, s37, 131072
  v_add_u32 v14, s37, v109
  ds_write_b128 v14, v[128:131]
  ds_write_b128 v14, v[128:131] offset:4096
  v_lshrrev_b32 v16, 1, v15
  v_and_b32 v17, 1, v15
  v_lshl_add_u32 v19, v16, 5, v11
  v_lshl_add_u32 v19, v17, 2, v19
  v_lshlrev_b32 v19, 4, v19
  v_and_b32 v12, 7, v0
  s_lshl_b32 s37, s28, 2
  v_add_u32 v17, s37, v17
  v_xor_b32 v12, v12, v17
  v_lshlrev_b32 v12, 5, v12
  v_lshl_add_u32 v12, v16, 4, v12
  v_lshl_add_u32 v12, v11, 8, v12
  v_xor_b32 v13, 64, v12
  v_and_b32 v16, 15, v0
  s_lshl_b32 s37, s26, 9
  s_add_u32 s37, s37, 139264
  v_lshlrev_b32 v1, 4, v16
  v_add_u32 v1, s37, v1
  v_lshl_add_u32 v18, v15, 2, v1
  s_setprio 1
  s_waitcnt lgkmcnt(0)
  s_barrier
  ds_read_b64_tr_b16 v[48:49], v4 offset:16384
  ds_read_b64_tr_b16 v[50:51], v4 offset:17408
  ds_read_b128 v[32:35], v2 offset:0
  ds_read_b128 v[36:39], v2 offset:2048
  ds_read_b64_tr_b16 v[52:53], v5 offset:16384
  ds_read_b64_tr_b16 v[54:55], v5 offset:17408
  ds_read_b128 v[40:43], v2 offset:4096
  ds_read_b64_tr_b16 v[56:57], v6 offset:16384
  ds_read_b64_tr_b16 v[58:59], v6 offset:17408
  ds_read_b128 v[44:47], v2 offset:6144
  ds_read_b64_tr_b16 v[60:61], v7 offset:16384
  ds_read_b64_tr_b16 v[62:63], v7 offset:17408
  s_mov_b32 s44, s88
  s_mov_b32 s45, s89
  s_mov_b32 s46, 0x100
  s_mov_b32 s47, 0x20000
  v_mov_b32 v10, 0
  buffer_load_dwordx2 v[8:9], v10, s[44:47], 0 offen sc1
  s_mov_b32 s35, 8
  s_swappc_b64 s[62:63], s[58:59]
  s_mov_b32 s44, s88
  s_mov_b32 s45, s89
  s_mov_b32 s46, 0x100
  s_mov_b32 s47, 0x20000
  s_mov_b32 s56, 0
  v_mov_b32 v10, 0
  s_branch L1_nn_12_c
L1_nn_12:
  buffer_load_dwordx2 v[8:9], v10, s[44:47], 0 offen sc1
L1_nn_12_c:
  s_waitcnt vmcnt(0)
  v_readfirstlane_b32 s92, v8
  v_readfirstlane_b32 s93, v9
  s_add_u32 s56, s56, 1
  s_cmp_lg_u32 s92, 0
  s_cbranch_scc1 L1_nd_13
  s_cmp_lt_u32 s56, 100000
  s_cbranch_scc1 L1_nn_12
L1_nd_13:
  v_mov_b32 v28, s92
  v_mov_b32 v29, s93
  v_mov_b32 v88, 0xc0135761
  v_mov_b32 v89, 0xc0135761
  v_mov_b32 v90, 0xbdd2d3e8
  v_mov_b32 v91, 0xbdd2d3e8
  v_mov_b32 v92, 1.0
  v_mov_b32 v93, 1.0
  v_pk_mul_f32 v[64:65], v[128:129], v[128:129]
  v_pk_mul_f32 v[66:67], v[130:131], v[130:131]
  v_pk_mul_f32 v[68:69], v[132:133], v[132:133]
  v_pk_mul_f32 v[70:71], v[134:135], v[134:135]
  v_pk_fma_f32 v[64:65], v[64:65], v[90:91], v[88:89]
  v_pk_fma_f32 v[66:67], v[66:67], v[90:91], v[88:89]
  v_pk_fma_f32 v[68:69], v[68:69], v[90:91], v[88:89]
  v_pk_fma_f32 v[70:71], v[70:71], v[90:91], v[88:89]
  v_pk_mul_f32 v[64:65], v[64:65], v[128:129]
  v_pk_mul_f32 v[66:67], v[66:67], v[130:131]
  v_pk_mul_f32 v[68:69], v[68:69], v[132:133]
  v_pk_mul_f32 v[70:71], v[70:71], v[134:135]
  v_exp_f32 v64, v64
  v_pk_mul_f32 v[72:73], v[136:137], v[136:137]
  v_exp_f32 v65, v65
  v_pk_mul_f32 v[74:75], v[138:139], v[138:139]
  v_pk_mul_f32 v[76:77], v[140:141], v[140:141]
  v_exp_f32 v66, v66
  v_pk_mul_f32 v[78:79], v[142:143], v[142:143]
  v_exp_f32 v67, v67
  v_pk_fma_f32 v[72:73], v[72:73], v[90:91], v[88:89]
  v_pk_fma_f32 v[74:75], v[74:75], v[90:91], v[88:89]
  v_exp_f32 v68, v68
  v_pk_fma_f32 v[76:77], v[76:77], v[90:91], v[88:89]
  v_exp_f32 v69, v69
  v_pk_fma_f32 v[78:79], v[78:79], v[90:91], v[88:89]
  v_pk_mul_f32 v[72:73], v[72:73], v[136:137]
  v_exp_f32 v70, v70
  v_pk_mul_f32 v[74:75], v[74:75], v[138:139]
  v_exp_f32 v71, v71
  v_pk_mul_f32 v[76:77], v[76:77], v[140:141]
  v_pk_mul_f32 v[78:79], v[78:79], v[142:143]
  s_nop 0
  v_pk_add_f32 v[64:65], v[64:65], v[92:93]
  v_pk_add_f32 v[66:67], v[66:67], v[92:93]
  v_pk_add_f32 v[68:69], v[68:69], v[92:93]
  v_pk_add_f32 v[70:71], v[70:71], v[92:93]
  v_rcp_f32 v64, v64
  v_rcp_f32 v65, v65
  v_rcp_f32 v66, v66
  v_rcp_f32 v67, v67
  v_rcp_f32 v68, v68
  v_rcp_f32 v69, v69
  v_rcp_f32 v70, v70
  v_rcp_f32 v71, v71
  v_exp_f32 v72, v72
  v_pk_mul_f32 v[80:81], v[144:145], v[144:145]
  v_exp_f32 v73, v73
  v_pk_mul_f32 v[82:83], v[146:147], v[146:147]
  v_pk_mul_f32 v[84:85], v[148:149], v[148:149]
  v_exp_f32 v74, v74
  v_pk_mul_f32 v[86:87], v[150:151], v[150:151]
  v_exp_f32 v75, v75
  v_pk_fma_f32 v[80:81], v[80:81], v[90:91], v[88:89]
  v_pk_fma_f32 v[82:83], v[82:83], v[90:91], v[88:89]
  v_exp_f32 v76, v76
  v_pk_fma_f32 v[84:85], v[84:85], v[90:91], v[88:89]
  v_exp_f32 v77, v77
  v_pk_fma_f32 v[86:87], v[86:87], v[90:91], v[88:89]
  v_pk_mul_f32 v[80:81], v[80:81], v[144:145]
  v_exp_f32 v78, v78
  v_pk_mul_f32 v[82:83], v[82:83], v[146:147]
  v_exp_f32 v79, v79
  v_pk_mul_f32 v[84:85], v[84:85], v[148:149]
  v_pk_mul_f32 v[86:87], v[86:87], v[150:151]
  v_pk_add_f32 v[72:73], v[72:73], v[92:93]
  v_pk_add_f32 v[74:75], v[74:75], v[92:93]
  v_pk_add_f32 v[76:77], v[76:77], v[92:93]
  v_pk_add_f32 v[78:79], v[78:79], v[92:93]
  v_rcp_f32 v72, v72
  v_pk_mul_f32 v[192:193], v[128:129], v[64:65]
  v_rcp_f32 v73, v73
  v_pk_mul_f32 v[194:195], v[130:131], v[66:67]
  v_rcp_f32 v74, v74
  v_pk_mul_f32 v[196:197], v[132:133], v[68:69]
  v_rcp_f32 v75, v75
  v_pk_mul_f32 v[198:199], v[134:135], v[70:71]
  v_rcp_f32 v76, v76
  v_pk_mov_b32 v[128:129], 0, 0
  v_rcp_f32 v77, v77
  v_pk_mov_b32 v[130:131], 0, 0
  v_rcp_f32 v78, v78
  v_pk_mov_b32 v[132:133], 0, 0
  v_rcp_f32 v79, v79
  v_pk_mov_b32 v[134:135], 0, 0
  v_exp_f32 v80, v80
  v_pk_mul_f32 v[64:65], v[152:153], v[152:153]
  v_pk_mul_f32 v[66:67], v[154:155], v[154:155]
  v_exp_f32 v81, v81
  v_pk_mul_f32 v[68:69], v[156:157], v[156:157]
  v_pk_mul_f32 v[70:71], v[158:159], v[158:159]
  v_pk_fma_f32 v[64:65], v[64:65], v[90:91], v[88:89]
  v_exp_f32 v82, v82
  v_pk_fma_f32 v[66:67], v[66:67], v[90:91], v[88:89]
  v_pk_fma_f32 v[68:69], v[68:69], v[90:91], v[88:89]
  v_exp_f32 v83, v83
  v_pk_fma_f32 v[70:71], v[70:71], v[90:91], v[88:89]
  v_pk_mul_f32 v[64:65], v[64:65], v[152:153]
  v_pk_mul_f32 v[66:67], v[66:67], v[154:155]
  v_exp_f32 v84, v84
  v_pk_mul_f32 v[68:69], v[68:69], v[156:157]
  v_pk_mul_f32 v[70:71], v[70:71], v[158:159]
  v_exp_f32 v85, v85
  v_pk_mov_b32 v[96:97], v[192:193], v[192:193] op_sel:[0,1]
  v_pk_mul_f32 v[104:105], v[192:193], v[192:193]
  v_pk_add_f32 v[96:97], v[96:97], v[194:195]
  v_exp_f32 v86, v86
  v_pk_fma_f32 v[104:105], v[194:195], v[194:195], v[104:105]
  v_pk_mov_b32 v[98:99], v[196:197], v[196:197] op_sel:[0,1]
  v_exp_f32 v87, v87
  v_pk_mul_f32 v[106:107], v[196:197], v[196:197]
  v_pk_add_f32 v[98:99], v[98:99], v[198:199]
  v_pk_fma_f32 v[106:107], v[198:199], v[198:199], v[106:107]
  v_pk_add_f32 v[80:81], v[80:81], v[92:93]
  v_pk_add_f32 v[82:83], v[82:83], v[92:93]
  v_pk_add_f32 v[84:85], v[84:85], v[92:93]
  v_pk_add_f32 v[86:87], v[86:87], v[92:93]
  v_rcp_f32 v80, v80
  v_pk_mul_f32 v[200:201], v[136:137], v[72:73]
  v_rcp_f32 v81, v81
  v_pk_mul_f32 v[202:203], v[138:139], v[74:75]
  v_rcp_f32 v82, v82
  v_pk_mul_f32 v[204:205], v[140:141], v[76:77]
  v_rcp_f32 v83, v83
  v_pk_mul_f32 v[206:207], v[142:143], v[78:79]
  v_rcp_f32 v84, v84
  v_pk_mov_b32 v[136:137], 0, 0
  v_rcp_f32 v85, v85
  v_pk_mov_b32 v[138:139], 0, 0
  v_rcp_f32 v86, v86
  v_pk_mov_b32 v[140:141], 0, 0
  v_rcp_f32 v87, v87
  v_pk_mov_b32 v[142:143], 0, 0
  v_exp_f32 v64, v64
  v_pk_mul_f32 v[72:73], v[160:161], v[160:161]
  v_pk_mul_f32 v[74:75], v[162:163], v[162:163]
  v_exp_f32 v65, v65
  v_pk_mul_f32 v[76:77], v[164:165], v[164:165]
  v_pk_mul_f32 v[78:79], v[166:167], v[166:167]
  v_pk_fma_f32 v[72:73], v[72:73], v[90:91], v[88:89]
  v_exp_f32 v66, v66
  v_pk_fma_f32 v[74:75], v[74:75], v[90:91], v[88:89]
  v_pk_fma_f32 v[76:77], v[76:77], v[90:91], v[88:89]
  v_exp_f32 v67, v67
  v_pk_fma_f32 v[78:79], v[78:79], v[90:91], v[88:89]
  v_pk_mul_f32 v[72:73], v[72:73], v[160:161]
  v_pk_mul_f32 v[74:75], v[74:75], v[162:163]
  v_exp_f32 v68, v68
  v_pk_mul_f32 v[76:77], v[76:77], v[164:165]
  v_pk_mul_f32 v[78:79], v[78:79], v[166:167]
  v_exp_f32 v69, v69
  v_pk_mov_b32 v[100:101], v[200:201], v[200:201] op_sel:[0,1]
  v_pk_mul_f32 v[108:109], v[200:201], v[200:201]
  v_pk_add_f32 v[100:101], v[100:101], v[202:203]
  v_exp_f32 v70, v70
  v_pk_fma_f32 v[108:109], v[202:203], v[202:203], v[108:109]
  v_pk_mov_b32 v[102:103], v[204:205], v[204:205] op_sel:[0,1]
  v_exp_f32 v71, v71
  v_pk_mul_f32 v[110:111], v[204:205], v[204:205]
  v_pk_add_f32 v[102:103], v[102:103], v[206:207]
  v_pk_fma_f32 v[110:111], v[206:207], v[206:207], v[110:111]
  v_pk_add_f32 v[64:65], v[64:65], v[92:93]
  v_pk_add_f32 v[66:67], v[66:67], v[92:93]
  v_pk_add_f32 v[68:69], v[68:69], v[92:93]
  v_pk_add_f32 v[70:71], v[70:71], v[92:93]
  v_rcp_f32 v64, v64
  v_pk_mul_f32 v[208:209], v[144:145], v[80:81]
  v_rcp_f32 v65, v65
  v_pk_mul_f32 v[210:211], v[146:147], v[82:83]
  v_rcp_f32 v66, v66
  v_pk_mul_f32 v[212:213], v[148:149], v[84:85]
  v_rcp_f32 v67, v67
  v_pk_mul_f32 v[214:215], v[150:151], v[86:87]
  v_rcp_f32 v68, v68
  v_pk_mov_b32 v[144:145], 0, 0
  v_rcp_f32 v69, v69
  v_pk_mov_b32 v[146:147], 0, 0
  v_rcp_f32 v70, v70
  v_pk_mov_b32 v[148:149], 0, 0
  v_rcp_f32 v71, v71
  v_pk_mov_b32 v[150:151], 0, 0
  v_exp_f32 v72, v72
  v_pk_mul_f32 v[80:81], v[168:169], v[168:169]
  v_pk_mul_f32 v[82:83], v[170:171], v[170:171]
  v_exp_f32 v73, v73
  v_pk_mul_f32 v[84:85], v[172:173], v[172:173]
  v_pk_mul_f32 v[86:87], v[174:175], v[174:175]
  v_pk_fma_f32 v[80:81], v[80:81], v[90:91], v[88:89]
  v_exp_f32 v74, v74
  v_pk_fma_f32 v[82:83], v[82:83], v[90:91], v[88:89]
  v_pk_fma_f32 v[84:85], v[84:85], v[90:91], v[88:89]
  v_exp_f32 v75, v75
  v_pk_fma_f32 v[86:87], v[86:87], v[90:91], v[88:89]
  v_pk_mul_f32 v[80:81], v[80:81], v[168:169]
  v_pk_mul_f32 v[82:83], v[82:83], v[170:171]
  v_exp_f32 v76, v76
  v_pk_mul_f32 v[84:85], v[84:85], v[172:173]
  v_pk_mul_f32 v[86:87], v[86:87], v[174:175]
  v_exp_f32 v77, v77
  v_pk_add_f32 v[96:97], v[96:97], v[208:209]
  v_pk_fma_f32 v[104:105], v[208:209], v[208:209], v[104:105]
  v_pk_add_f32 v[96:97], v[96:97], v[210:211]
  v_exp_f32 v78, v78
  v_pk_fma_f32 v[104:105], v[210:211], v[210:211], v[104:105]
  v_pk_add_f32 v[98:99], v[98:99], v[212:213]
  v_exp_f32 v79, v79
  v_pk_fma_f32 v[106:107], v[212:213], v[212:213], v[106:107]
  v_pk_add_f32 v[98:99], v[98:99], v[214:215]
  v_pk_fma_f32 v[106:107], v[214:215], v[214:215], v[106:107]
  v_pk_add_f32 v[72:73], v[72:73], v[92:93]
  v_pk_add_f32 v[74:75], v[74:75], v[92:93]
  v_pk_add_f32 v[76:77], v[76:77], v[92:93]
  v_pk_add_f32 v[78:79], v[78:79], v[92:93]
  v_rcp_f32 v72, v72
  v_pk_mul_f32 v[216:217], v[152:153], v[64:65]
  v_rcp_f32 v73, v73
  v_pk_mul_f32 v[218:219], v[154:155], v[66:67]
  v_rcp_f32 v74, v74
  v_pk_mul_f32 v[220:221], v[156:157], v[68:69]
  v_rcp_f32 v75, v75
  v_pk_mul_f32 v[222:223], v[158:159], v[70:71]
  v_rcp_f32 v76, v76
  v_pk_mov_b32 v[152:153], 0, 0
  v_rcp_f32 v77, v77
  v_pk_mov_b32 v[154:155], 0, 0
  v_rcp_f32 v78, v78
  v_pk_mov_b32 v[156:157], 0, 0
  v_rcp_f32 v79, v79
  v_pk_mov_b32 v[158:159], 0, 0
  v_exp_f32 v80, v80
  v_pk_mul_f32 v[64:65], v[176:177], v[176:177]
  v_pk_mul_f32 v[66:67], v[178:179], v[178:179]
  v_exp_f32 v81, v81
  v_pk_mul_f32 v[68:69], v[180:181], v[180:181]
  v_pk_mul_f32 v[70:71], v[182:183], v[182:183]
  v_pk_fma_f32 v[64:65], v[64:65], v[90:91], v[88:89]
  v_exp_f32 v82, v82
  v_pk_fma_f32 v[66:67], v[66:67], v[90:91], v[88:89]
  v_pk_fma_f32 v[68:69], v[68:69], v[90:91], v[88:89]
  v_exp_f32 v83, v83
  v_pk_fma_f32 v[70:71], v[70:71], v[90:91], v[88:89]
  v_pk_mul_f32 v[64:65], v[64:65], v[176:177]
  v_pk_mul_f32 v[66:67], v[66:67], v[178:179]
  v_exp_f32 v84, v84
  v_pk_mul_f32 v[68:69], v[68:69], v[180:181]
  v_pk_mul_f32 v[70:71], v[70:71], v[182:183]
  v_exp_f32 v85, v85
  v_pk_add_f32 v[100:101], v[100:101], v[216:217]
  v_pk_fma_f32 v[108:109], v[216:217], v[216:217], v[108:109]
  v_pk_add_f32 v[100:101], v[100:101], v[218:219]
  v_exp_f32 v86, v86
  v_pk_fma_f32 v[108:109], v[218:219], v[218:219], v[108:109]
  v_pk_add_f32 v[102:103], v[102:103], v[220:221]
  v_exp_f32 v87, v87
  v_pk_fma_f32 v[110:111], v[220:221], v[220:221], v[110:111]
  v_pk_add_f32 v[102:103], v[102:103], v[222:223]
  v_pk_fma_f32 v[110:111], v[222:223], v[222:223], v[110:111]
  v_pk_add_f32 v[80:81], v[80:81], v[92:93]
  v_pk_add_f32 v[82:83], v[82:83], v[92:93]
  v_pk_add_f32 v[84:85], v[84:85], v[92:93]
  v_pk_add_f32 v[86:87], v[86:87], v[92:93]
  v_rcp_f32 v80, v80
  v_pk_mul_f32 v[224:225], v[160:161], v[72:73]
  v_rcp_f32 v81, v81
  v_pk_mul_f32 v[226:227], v[162:163], v[74:75]
  v_rcp_f32 v82, v82
  v_pk_mul_f32 v[228:229], v[164:165], v[76:77]
  v_rcp_f32 v83, v83
  v_pk_mul_f32 v[230:231], v[166:167], v[78:79]
  v_rcp_f32 v84, v84
  v_pk_mov_b32 v[160:161], 0, 0
  v_rcp_f32 v85, v85
  v_pk_mov_b32 v[162:163], 0, 0
  v_rcp_f32 v86, v86
  v_pk_mov_b32 v[164:165], 0, 0
  v_rcp_f32 v87, v87
  v_pk_mov_b32 v[166:167], 0, 0
  v_exp_f32 v64, v64
  v_pk_mul_f32 v[72:73], v[184:185], v[184:185]
  v_pk_mul_f32 v[74:75], v[186:187], v[186:187]
  v_exp_f32 v65, v65
  v_pk_mul_f32 v[76:77], v[188:189], v[188:189]
  v_pk_mul_f32 v[78:79], v[190:191], v[190:191]
  v_pk_fma_f32 v[72:73], v[72:73], v[90:91], v[88:89]
  v_exp_f32 v66, v66
  v_pk_fma_f32 v[74:75], v[74:75], v[90:91], v[88:89]
  v_pk_fma_f32 v[76:77], v[76:77], v[90:91], v[88:89]
  v_exp_f32 v67, v67
  v_pk_fma_f32 v[78:79], v[78:79], v[90:91], v[88:89]
  v_pk_mul_f32 v[72:73], v[72:73], v[184:185]
  v_pk_mul_f32 v[74:75], v[74:75], v[186:187]
  v_exp_f32 v68, v68
  v_pk_mul_f32 v[76:77], v[76:77], v[188:189]
  v_pk_mul_f32 v[78:79], v[78:79], v[190:191]
  v_exp_f32 v69, v69
  v_pk_add_f32 v[96:97], v[96:97], v[224:225]
  v_pk_fma_f32 v[104:105], v[224:225], v[224:225], v[104:105]
  v_pk_add_f32 v[96:97], v[96:97], v[226:227]
  v_exp_f32 v70, v70
  v_pk_fma_f32 v[104:105], v[226:227], v[226:227], v[104:105]
  v_pk_add_f32 v[98:99], v[98:99], v[228:229]
  v_exp_f32 v71, v71
  v_pk_fma_f32 v[106:107], v[228:229], v[228:229], v[106:107]
  v_pk_add_f32 v[98:99], v[98:99], v[230:231]
  v_pk_fma_f32 v[106:107], v[230:231], v[230:231], v[106:107]
  v_pk_add_f32 v[64:65], v[64:65], v[92:93]
  v_pk_add_f32 v[66:67], v[66:67], v[92:93]
  v_pk_add_f32 v[68:69], v[68:69], v[92:93]
  v_pk_add_f32 v[70:71], v[70:71], v[92:93]
  v_rcp_f32 v64, v64
  v_pk_mul_f32 v[232:233], v[168:169], v[80:81]
  v_rcp_f32 v65, v65
  v_pk_mul_f32 v[234:235], v[170:171], v[82:83]
  v_rcp_f32 v66, v66
  v_pk_mul_f32 v[236:237], v[172:173], v[84:85]
  v_rcp_f32 v67, v67
  v_pk_mul_f32 v[238:239], v[174:175], v[86:87]
  v_rcp_f32 v68, v68
  v_pk_mov_b32 v[168:169], 0, 0
  v_rcp_f32 v69, v69
  v_pk_mov_b32 v[170:171], 0, 0
  v_rcp_f32 v70, v70
  v_pk_mov_b32 v[172:173], 0, 0
  v_rcp_f32 v71, v71
  v_pk_mov_b32 v[174:175], 0, 0
  v_exp_f32 v72, v72
  v_pk_add_f32 v[100:101], v[100:101], v[232:233]
  v_exp_f32 v73, v73
  v_pk_fma_f32 v[108:109], v[232:233], v[232:233], v[108:109]
  v_exp_f32 v74, v74
  v_pk_add_f32 v[100:101], v[100:101], v[234:235]
  v_exp_f32 v75, v75
  v_pk_fma_f32 v[108:109], v[234:235], v[234:235], v[108:109]
  v_exp_f32 v76, v76
  v_pk_add_f32 v[102:103], v[102:103], v[236:237]
  v_exp_f32 v77, v77
  v_pk_fma_f32 v[110:111], v[236:237], v[236:237], v[110:111]
  v_exp_f32 v78, v78
  v_pk_add_f32 v[102:103], v[102:103], v[238:239]
  v_exp_f32 v79, v79
  v_pk_fma_f32 v[110:111], v[238:239], v[238:239], v[110:111]
  v_pk_add_f32 v[72:73], v[72:73], v[92:93]
  v_pk_add_f32 v[74:75], v[74:75], v[92:93]
  v_pk_add_f32 v[76:77], v[76:77], v[92:93]
  v_pk_add_f32 v[78:79], v[78:79], v[92:93]
  v_rcp_f32 v72, v72
  v_pk_mul_f32 v[240:241], v[176:177], v[64:65]
  v_rcp_f32 v73, v73
  v_pk_mul_f32 v[242:243], v[178:179], v[66:67]
  v_rcp_f32 v74, v74
  v_pk_mul_f32 v[244:245], v[180:181], v[68:69]
  v_rcp_f32 v75, v75
  v_pk_mul_f32 v[246:247], v[182:183], v[70:71]
  v_rcp_f32 v76, v76
  v_pk_mov_b32 v[176:177], 0, 0
  v_rcp_f32 v77, v77
  v_pk_mov_b32 v[178:179], 0, 0
  v_rcp_f32 v78, v78
  v_pk_mov_b32 v[180:181], 0, 0
  v_rcp_f32 v79, v79
  v_pk_mov_b32 v[182:183], 0, 0
  v_pk_add_f32 v[96:97], v[96:97], v[240:241]
  v_pk_fma_f32 v[104:105], v[240:241], v[240:241], v[104:105]
  v_pk_add_f32 v[96:97], v[96:97], v[242:243]
  v_pk_fma_f32 v[104:105], v[242:243], v[242:243], v[104:105]
  v_pk_add_f32 v[98:99], v[98:99], v[244:245]
  v_pk_fma_f32 v[106:107], v[244:245], v[244:245], v[106:107]
  v_pk_add_f32 v[98:99], v[98:99], v[246:247]
  v_pk_fma_f32 v[106:107], v[246:247], v[246:247], v[106:107]
  v_pk_mul_f32 v[248:249], v[184:185], v[72:73]
  v_pk_mul_f32 v[250:251], v[186:187], v[74:75]
  v_pk_mul_f32 v[252:253], v[188:189], v[76:77]
  v_pk_mul_f32 v[254:255], v[190:191], v[78:79]
  v_pk_mov_b32 v[184:185], 0, 0
  v_pk_mov_b32 v[186:187], 0, 0
  v_pk_mov_b32 v[188:189], 0, 0
  v_pk_mov_b32 v[190:191], 0, 0
  v_pk_add_f32 v[100:101], v[100:101], v[248:249]
  v_pk_fma_f32 v[108:109], v[248:249], v[248:249], v[108:109]
  v_pk_add_f32 v[100:101], v[100:101], v[250:251]
  v_pk_fma_f32 v[108:109], v[250:251], v[250:251], v[108:109]
  v_pk_add_f32 v[102:103], v[102:103], v[252:253]
  v_pk_fma_f32 v[110:111], v[252:253], v[252:253], v[110:111]
  v_pk_add_f32 v[102:103], v[102:103], v[254:255]
  v_pk_fma_f32 v[110:111], v[254:255], v[254:255], v[110:111]
  v_add_f32 v96, v96, v97
  v_add_f32 v104, v104, v105
  v_add_f32 v98, v98, v99
  v_add_f32 v106, v106, v107
  v_add_f32 v100, v100, v101
  v_add_f32 v108, v108, v109
  v_add_f32 v102, v102, v103
  v_add_f32 v110, v110, v111
  s_nop 1
  v_permlane16_swap_b32 v96, v98
  v_permlane16_swap_b32 v100, v102
  v_permlane16_swap_b32 v104, v106
  v_permlane16_swap_b32 v108, v110
  v_add_f32 v96, v96, v98
  v_add_f32 v100, v100, v102
  v_add_f32 v104, v104, v106
  v_add_f32 v108, v108, v110
  s_nop 1
  v_permlane32_swap_b32 v96, v100
  v_permlane32_swap_b32 v104, v108
  v_add_f32 v64, v96, v100
  v_add_f32 v65, v104, v108
  v_mov_b32 v66, 1
  v_mov_b32 v67, 1
  v_xor_b32 v17, 1024, v14
  ds_write_b128 v14, v[64:67] offset:0
  s_mov_b32 s56, 0
L1_sibA:
  ds_read_b128 v[68:71], v17 offset:0
  s_add_u32 s56, s56, 1
  s_waitcnt lgkmcnt(0)
  v_cmp_eq_u32 vcc, 1, v70
  s_cmp_eq_u64 vcc, -1
  s_cbranch_scc1 L1_sibA_ok
  s_cmp_lt_u32 s56, 800000
  s_cbranch_scc1 L1_sibA
L1_sibA_ok:
  v_pk_add_f32 v[26:27], v[64:65], v[68:69]
  s_mul_i32 s37, s24, 14
  s_lshl_b32 s37, s37, 11
  s_lshl_b32 s40, s27, 10
  s_add_u32 s37, s37, s40
  s_add_u32 s37, s37, 25165824
  s_lshl_b32 s40, s25, 11
  s_add_u32 s40, s40, s37
  s_cmp_eq_u32 s28, 0
  s_cselect_b32 exec_lo, -1, 0
  s_cselect_b32 exec_hi, 0, -1
  buffer_store_dwordx4 v[26:29], v19, s[16:19], s40 offen sc1
  s_mov_b64 exec, -1
  s_mul_i32 s40, s28, 14336
  s_add_u32 s57, s37, s40
  s_mov_b32 s35, 2
  s_swappc_b64 s[62:63], s[58:59]
  s_mov_b32 s40, s57
  buffer_load_dwordx4 v[96:99], v19, s[16:19], s40 offen offset:0 sc1
  buffer_load_dwordx4 v[100:103], v19, s[16:19], s40 offen offset:2048 sc1
  s_add_u32 s40, s40, 4096
  buffer_load_dwordx4 v[104:107], v19, s[16:19], s40 offen offset:0 sc1
  buffer_load_dwordx4 v[108:111], v19, s[16:19], s40 offen offset:2048 sc1
  s_add_u32 s40, s40, 4096
  buffer_load_dwordx4 v[112:115], v19, s[16:19], s40 offen offset:0 sc1
  buffer_load_dwordx4 v[116:119], v19, s[16:19], s40 offen offset:2048 sc1
  s_add_u32 s40, s40, 4096
  buffer_load_dwordx4 v[120:123], v19, s[16:19], s40 offen offset:0 sc1
  s_mov_b32 s35, 1
  s_swappc_b64 s[62:63], s[58:59]
  s_waitcnt vmcnt(0)
  s_mov_b32 s56, 0
  s_branch L1_chk
L1_poll:
  s_mov_b32 s40, s57
  buffer_load_dwordx4 v[96:99], v19, s[16:19], s40 offen offset:0 sc1
  buffer_load_dwordx4 v[100:103], v19, s[16:19], s40 offen offset:2048 sc1
  s_add_u32 s40, s40, 4096
  buffer_load_dwordx4 v[104:107], v19, s[16:19], s40 offen offset:0 sc1
  buffer_load_dwordx4 v[108:111], v19, s[16:19], s40 offen offset:2048 sc1
  s_add_u32 s40, s40, 4096
  buffer_load_dwordx4 v[112:115], v19, s[16:19], s40 offen offset:0 sc1
  buffer_load_dwordx4 v[116:119], v19, s[16:19], s40 offen offset:2048 sc1
  s_add_u32 s40, s40, 4096
  buffer_load_dwordx4 v[120:123], v19, s[16:19], s40 offen offset:0 sc1
  s_waitcnt vmcnt(0)
L1_chk:
  s_mov_b64 s[38:39], -1
  v_cmp_eq_u64 vcc, s[92:93], v[98:99]
  s_and_b64 s[38:39], s[38:39], vcc
  v_cmp_eq_u64 vcc, s[92:93], v[102:103]
  s_and_b64 s[38:39], s[38:39], vcc
  v_cmp_eq_u64 vcc, s[92:93], v[106:107]
  s_and_b64 s[38:39], s[38:39], vcc
  v_cmp_eq_u64 vcc, s[92:93], v[110:111]
  s_and_b64 s[38:39], s[38:39], vcc
  v_cmp_eq_u64 vcc, s[92:93], v[114:115]
  s_and_b64 s[38:39], s[38:39], vcc
  v_cmp_eq_u64 vcc, s[92:93], v[118:119]
  s_and_b64 s[38:39], s[38:39], vcc
  v_cmp_eq_u64 vcc, s[92:93], v[122:123]
  s_and_b64 s[38:39], s[38:39], vcc
  s_cmp_eq_u64 s[38:39], -1
  s_cbranch_scc1 L1_ok
  s_sleep 2
  s_add_u32 s56, s56, 1
  s_cmp_lt_u32 s56, 100000
  s_cbranch_scc1 L1_poll
L1_ok:
  v_pk_add_f32 v[96:97], v[96:97], v[100:101]
  v_pk_add_f32 v[96:97], v[96:97], v[104:105]
  v_pk_add_f32 v[96:97], v[96:97], v[108:109]
  v_pk_add_f32 v[96:97], v[96:97], v[112:113]
  v_pk_add_f32 v[96:97], v[96:97], v[116:117]
  v_pk_add_f32 v[96:97], v[96:97], v[120:121]
  v_mov_b32 v98, 1
  v_mov_b32 v99, 1
  v_xor_b32 v17, 1024, v14
  ds_write_b128 v14, v[96:99] offset:4096
  s_mov_b32 s56, 0
L1_sibB:
  ds_read_b128 v[100:103], v17 offset:4096
  s_add_u32 s56, s56, 1
  s_waitcnt lgkmcnt(0)
  v_cmp_eq_u32 vcc, 1, v102
  s_cmp_eq_u64 vcc, -1
  s_cbranch_scc1 L1_sibB_ok
  s_cmp_lt_u32 s56, 800000
  s_cbranch_scc1 L1_sibB
L1_sibB_ok:
  v_pk_add_f32 v[96:97], v[96:97], v[100:101]
  v_mul_f32 v96, 0x3a124925, v96
  v_mul_f32 v97, 0x3a124925, v97
  v_fma_f32 v97, -v96, v96, v97
  v_max_f32 v97, 0, v97
  v_add_f32 v97, 0x3727c5ac, v97
  v_rsq_f32 v97, v97
  s_nop 0
  v_mul_f32 v96, v96, v97
  v_sub_f32 v96, 0, v96
  ds_write_b32 v18, v97
  ds_write_b32 v18, v96 offset:256
  ds_read_b128 v[96:99], v1
  ds_read_b128 v[100:103], v1 offset:256
  s_lshl_b32 s40, s25, 5
  s_lshl_b32 s37, s24, 1
  s_add_u32 s40, s40, s37
  s_add_u32 s40, s40, s27
  s_lshl_b32 s40, s40, 14
  s_add_u32 s29, s40, 8388608
  s_add_u32 s30, s29, 8192
  s_waitcnt lgkmcnt(0)
  v_pk_fma_f32 v[192:193], v[192:193], v[96:97], v[100:101] op_sel_hi:[1,0,0]
  v_pk_fma_f32 v[194:195], v[194:195], v[96:97], v[100:101] op_sel_hi:[1,0,0]
  v_pk_fma_f32 v[208:209], v[208:209], v[96:97], v[100:101] op_sel_hi:[1,0,0]
  v_pk_fma_f32 v[210:211], v[210:211], v[96:97], v[100:101] op_sel_hi:[1,0,0]
  v_cvt_pk_bf16_f32 v64, v192, v193
  v_cvt_pk_bf16_f32 v65, v194, v195
  v_cvt_pk_bf16_f32 v66, v208, v209
  v_cvt_pk_bf16_f32 v67, v210, v211
  s_nop 1
  v_permlane16_swap_b32 v64, v66
  v_permlane16_swap_b32 v65, v67
  buffer_store_dwordx4 v[64:67], v12, s[16:19], s29 offen offset:0 sc1
  v_pk_fma_f32 v[224:225], v[224:225], v[96:97], v[100:101] op_sel_hi:[1,0,0]
  v_pk_fma_f32 v[226:227], v[226:227], v[96:97], v[100:101] op_sel_hi:[1,0,0]
  v_pk_fma_f32 v[240:241], v[240:241], v[96:97], v[100:101] op_sel_hi:[1,0,0]
  v_pk_fma_f32 v[242:243], v[242:243], v[96:97], v[100:101] op_sel_hi:[1,0,0]
  v_cvt_pk_bf16_f32 v68, v224, v225
  v_cvt_pk_bf16_f32 v69, v226, v227
  v_cvt_pk_bf16_f32 v70, v240, v241
  v_cvt_pk_bf16_f32 v71, v242, v243
  s_nop 1
  v_permlane16_swap_b32 v68, v70
  v_permlane16_swap_b32 v69, v71
  buffer_store_dwordx4 v[68:71], v13, s[16:19], s29 offen offset:0 sc1
  v_pk_fma_f32 v[196:197], v[196:197], v[96:97], v[100:101] op_sel:[0,1,1] op_sel_hi:[1,1,1]
  v_pk_fma_f32 v[198:199], v[198:199], v[96:97], v[100:101] op_sel:[0,1,1] op_sel_hi:[1,1,1]
  v_pk_fma_f32 v[212:213], v[212:213], v[96:97], v[100:101] op_sel:[0,1,1] op_sel_hi:[1,1,1]
  v_pk_fma_f32 v[214:215], v[214:215], v[96:97], v[100:101] op_sel:[0,1,1] op_sel_hi:[1,1,1]
  v_cvt_pk_bf16_f32 v72, v196, v197
  v_cvt_pk_bf16_f32 v73, v198, v199
  v_cvt_pk_bf16_f32 v74, v212, v213
  v_cvt_pk_bf16_f32 v75, v214, v215
  s_nop 1
  v_permlane16_swap_b32 v72, v74
  v_permlane16_swap_b32 v73, v75
  buffer_store_dwordx4 v[72:75], v12, s[16:19], s29 offen offset:1024 sc1
  v_pk_fma_f32 v[228:229], v[228:229], v[96:97], v[100:101] op_sel:[0,1,1] op_sel_hi:[1,1,1]
  v_pk_fma_f32 v[230:231], v[230:231], v[96:97], v[100:101] op_sel:[0,1,1] op_sel_hi:[1,1,1]
  v_pk_fma_f32 v[244:245], v[244:245], v[96:97], v[100:101] op_sel:[0,1,1] op_sel_hi:[1,1,1]
  v_pk_fma_f32 v[246:247], v[246:247], v[96:97], v[100:101] op_sel:[0,1,1] op_sel_hi:[1,1,1]
  v_cvt_pk_bf16_f32 v76, v228, v229
  v_cvt_pk_bf16_f32 v77, v230, v231
  v_cvt_pk_bf16_f32 v78, v244, v245
  v_cvt_pk_bf16_f32 v79, v246, v247
  s_nop 1
  v_permlane16_swap_b32 v76, v78
  v_permlane16_swap_b32 v77, v79
  buffer_store_dwordx4 v[76:79], v13, s[16:19], s29 offen offset:1024 sc1
  v_pk_fma_f32 v[200:201], v[200:201], v[98:99], v[102:103] op_sel_hi:[1,0,0]
  v_pk_fma_f32 v[202:203], v[202:203], v[98:99], v[102:103] op_sel_hi:[1,0,0]
  v_pk_fma_f32 v[216:217], v[216:217], v[98:99], v[102:103] op_sel_hi:[1,0,0]
  v_pk_fma_f32 v[218:219], v[218:219], v[98:99], v[102:103] op_sel_hi:[1,0,0]
  v_cvt_pk_bf16_f32 v80, v200, v201
  v_cvt_pk_bf16_f32 v81, v202, v203
  v_cvt_pk_bf16_f32 v82, v216, v217
  v_cvt_pk_bf16_f32 v83, v218, v219
  s_nop 1
  v_permlane16_swap_b32 v80, v82
  v_permlane16_swap_b32 v81, v83
  buffer_store_dwordx4 v[80:83], v12, s[16:19], s30 offen offset:0 sc1
  v_pk_fma_f32 v[232:233], v[232:233], v[98:99], v[102:103] op_sel_hi:[1,0,0]
  v_pk_fma_f32 v[234:235], v[234:235], v[98:99], v[102:103] op_sel_hi:[1,0,0]
  v_pk_fma_f32 v[248:249], v[248:249], v[98:99], v[102:103] op_sel_hi:[1,0,0]
  v_pk_fma_f32 v[250:251], v[250:251], v[98:99], v[102:103] op_sel_hi:[1,0,0]
  v_cvt_pk_bf16_f32 v84, v232, v233
  v_cvt_pk_bf16_f32 v85, v234, v235
  v_cvt_pk_bf16_f32 v86, v248, v249
  v_cvt_pk_bf16_f32 v87, v250, v251
  s_nop 1
  v_permlane16_swap_b32 v84, v86
  v_permlane16_swap_b32 v85, v87
  buffer_store_dwordx4 v[84:87], v13, s[16:19], s30 offen offset:0 sc1
  v_pk_fma_f32 v[204:205], v[204:205], v[98:99], v[102:103] op_sel:[0,1,1] op_sel_hi:[1,1,1]
  v_pk_fma_f32 v[206:207], v[206:207], v[98:99], v[102:103] op_sel:[0,1,1] op_sel_hi:[1,1,1]
  v_pk_fma_f32 v[220:221], v[220:221], v[98:99], v[102:103] op_sel:[0,1,1] op_sel_hi:[1,1,1]
  v_pk_fma_f32 v[222:223], v[222:223], v[98:99], v[102:103] op_sel:[0,1,1] op_sel_hi:[1,1,1]
  v_cvt_pk_bf16_f32 v88, v204, v205
  v_cvt_pk_bf16_f32 v89, v206, v207
  v_cvt_pk_bf16_f32 v90, v220, v221
  v_cvt_pk_bf16_f32 v91, v222, v223
  s_nop 1
  v_permlane16_swap_b32 v88, v90
  v_permlane16_swap_b32 v89, v91
  buffer_store_dwordx4 v[88:91], v12, s[16:19], s30 offen offset:1024 sc1
  v_pk_fma_f32 v[236:237], v[236:237], v[98:99], v[102:103] op_sel:[0,1,1] op_sel_hi:[1,1,1]
  v_pk_fma_f32 v[238:239], v[238:239], v[98:99], v[102:103] op_sel:[0,1,1] op_sel_hi:[1,1,1]
  v_pk_fma_f32 v[252:253], v[252:253], v[98:99], v[102:103] op_sel:[0,1,1] op_sel_hi:[1,1,1]
  v_pk_fma_f32 v[254:255], v[254:255], v[98:99], v[102:103] op_sel:[0,1,1] op_sel_hi:[1,1,1]
  v_cvt_pk_bf16_f32 v92, v236, v237
  v_cvt_pk_bf16_f32 v93, v238, v239
  v_cvt_pk_bf16_f32 v94, v252, v253
  v_cvt_pk_bf16_f32 v95, v254, v255
  s_nop 1
  v_permlane16_swap_b32 v92, v94
  v_permlane16_swap_b32 v93, v95
  buffer_store_dwordx4 v[92:95], v13, s[16:19], s30 offen offset:1024 sc1
  s_mov_b32 s35, 2
  s_swappc_b64 s[62:63], s[96:97]
  s_lshl_b32 s40, s25, 4
  s_add_u32 s40, s40, s24
  s_lshl_b32 s40, s40, 6
  s_add_u32 s40, s40, 31981568
  v_mov_b32 v96, s92
  v_mov_b32 v97, s93
  v_mov_b32 v98, s92
  v_mov_b32 v99, s93
  v_mov_b32 v100, 155648
  v_mov_b32 v101, 1
  s_mov_b64 exec, 1
  s_waitcnt vmcnt(0)
  ds_add_rtn_u32 v101, v100, v101
  s_mov_b64 exec, 15
  v_lshlrev_b32 v100, 4, v0
  s_waitcnt lgkmcnt(0)
  v_readfirstlane_b32 s36, v101
  s_cmp_lg_u32 s36, 3
  s_cbranch_scc1 L1_sf_14
  buffer_store_dwordx4 v[96:99], v100, s[16:19], s40 offen sc1
L1_sf_14:
  s_mov_b64 exec, -1
  s_lshl_b32 s37, s24, 7
  s_lshl_b32 s40, s27, 6
  s_add_u32 s37, s37, s40
  v_add_u32 v16, s37, v11
  v_lshlrev_b32 v16, 1, v16
  buffer_load_ushort v124, v16, s[48:51], 0 offen offset:0
  buffer_load_ushort v125, v16, s[48:51], 0 offen offset:8
  buffer_load_ushort v126, v16, s[48:51], 0 offen offset:64
  buffer_load_ushort v127, v16, s[48:51], 0 offen offset:72
  s_mov_b32 s35, 3
  s_swappc_b64 s[62:63], s[96:97]
  s_waitcnt vmcnt(0)
  v_lshlrev_b32 v124, 16, v124
  v_lshlrev_b32 v125, 16, v125
  v_lshlrev_b32 v126, 16, v126
  v_lshlrev_b32 v127, 16, v127
  s_mov_b32 s36, 0xbdd2d3e8
  v_mov_b32 v104, 0xc0135761
  s_nop 1
  v_pk_mov_b32 v[192:193], v[128:129], v[128:129] op_sel:[0,1]
  v_pk_mov_b32 v[128:129], v[124:125], v[124:125] op_sel:[0,0]
  v_pk_mov_b32 v[194:195], v[130:131], v[130:131] op_sel:[0,1]
  v_pk_mov_b32 v[130:131], v[124:125], v[124:125] op_sel:[0,0]
  v_pk_mov_b32 v[196:197], v[132:133], v[132:133] op_sel:[0,1]
  v_pk_mov_b32 v[132:133], v[124:125], v[124:125] op_sel:[1,1]
  v_pk_mov_b32 v[198:199], v[134:135], v[134:135] op_sel:[0,1]
  v_pk_mov_b32 v[134:135], v[124:125], v[124:125] op_sel:[1,1]
  v_pk_mov_b32 v[200:201], v[136:137], v[136:137] op_sel:[0,1]
  v_pk_mov_b32 v[136:137], v[126:127], v[126:127] op_sel:[0,0]
  v_pk_mov_b32 v[202:203], v[138:139], v[138:139] op_sel:[0,1]
  v_pk_mov_b32 v[138:139], v[126:127], v[126:127] op_sel:[0,0]
  v_pk_mov_b32 v[204:205], v[140:141], v[140:141] op_sel:[0,1]
  v_pk_mov_b32 v[140:141], v[126:127], v[126:127] op_sel:[1,1]
  v_pk_mov_b32 v[206:207], v[142:143], v[142:143] op_sel:[0,1]
  v_pk_mov_b32 v[142:143], v[126:127], v[126:127] op_sel:[1,1]
  v_pk_mov_b32 v[208:209], v[144:145], v[144:145] op_sel:[0,1]
  v_pk_mov_b32 v[144:145], v[124:125], v[124:125] op_sel:[0,0]
  v_pk_mov_b32 v[210:211], v[146:147], v[146:147] op_sel:[0,1]
  v_pk_mov_b32 v[146:147], v[124:125], v[124:125] op_sel:[0,0]
  v_pk_mov_b32 v[212:213], v[148:149], v[148:149] op_sel:[0,1]
  v_pk_mov_b32 v[148:149], v[124:125], v[124:125] op_sel:[1,1]
  v_pk_mov_b32 v[214:215], v[150:151], v[150:151] op_sel:[0,1]
  v_pk_mov_b32 v[150:151], v[124:125], v[124:125] op_sel:[1,1]
  v_pk_mov_b32 v[216:217], v[152:153], v[152:153] op_sel:[0,1]
  v_pk_mov_b32 v[152:153], v[126:127], v[126:127] op_sel:[0,0]
  v_pk_mov_b32 v[218:219], v[154:155], v[154:155] op_sel:[0,1]
  v_pk_mov_b32 v[154:155], v[126:127], v[126:127] op_sel:[0,0]
  v_pk_mov_b32 v[220:221], v[156:157], v[156:157] op_sel:[0,1]
  v_pk_mov_b32 v[156:157], v[126:127], v[126:127] op_sel:[1,1]
  v_pk_mov_b32 v[222:223], v[158:159], v[158:159] op_sel:[0,1]
  v_pk_mov_b32 v[158:159], v[126:127], v[126:127] op_sel:[1,1]
  v_pk_mov_b32 v[224:225], v[160:161], v[160:161] op_sel:[0,1]
  v_pk_mov_b32 v[160:161], v[124:125], v[124:125] op_sel:[0,0]
  v_pk_mov_b32 v[226:227], v[162:163], v[162:163] op_sel:[0,1]
  v_pk_mov_b32 v[162:163], v[124:125], v[124:125] op_sel:[0,0]
  v_pk_mov_b32 v[228:229], v[164:165], v[164:165] op_sel:[0,1]
  v_pk_mov_b32 v[164:165], v[124:125], v[124:125] op_sel:[1,1]
  v_pk_mov_b32 v[230:231], v[166:167], v[166:167] op_sel:[0,1]
  v_pk_mov_b32 v[166:167], v[124:125], v[124:125] op_sel:[1,1]
  v_pk_mov_b32 v[232:233], v[168:169], v[168:169] op_sel:[0,1]
  v_pk_mov_b32 v[168:169], v[126:127], v[126:127] op_sel:[0,0]
  v_pk_mov_b32 v[234:235], v[170:171], v[170:171] op_sel:[0,1]
  v_pk_mov_b32 v[170:171], v[126:127], v[126:127] op_sel:[0,0]
  v_pk_mov_b32 v[236:237], v[172:173], v[172:173] op_sel:[0,1]
  v_pk_mov_b32 v[172:173], v[126:127], v[126:127] op_sel:[1,1]
  v_pk_mov_b32 v[238:239], v[174:175], v[174:175] op_sel:[0,1]
  v_pk_mov_b32 v[174:175], v[126:127], v[126:127] op_sel:[1,1]
  v_pk_mov_b32 v[240:241], v[176:177], v[176:177] op_sel:[0,1]
  v_pk_mov_b32 v[176:177], v[124:125], v[124:125] op_sel:[0,0]
  v_pk_mov_b32 v[242:243], v[178:179], v[178:179] op_sel:[0,1]
  v_pk_mov_b32 v[178:179], v[124:125], v[124:125] op_sel:[0,0]
  v_pk_mov_b32 v[244:245], v[180:181], v[180:181] op_sel:[0,1]
  v_pk_mov_b32 v[180:181], v[124:125], v[124:125] op_sel:[1,1]
  v_pk_mov_b32 v[246:247], v[182:183], v[182:183] op_sel:[0,1]
  v_pk_mov_b32 v[182:183], v[124:125], v[124:125] op_sel:[1,1]
  v_pk_mov_b32 v[248:249], v[184:185], v[184:185] op_sel:[0,1]
  v_pk_mov_b32 v[184:185], v[126:127], v[126:127] op_sel:[0,0]
  v_pk_mov_b32 v[250:251], v[186:187], v[186:187] op_sel:[0,1]
  v_pk_mov_b32 v[186:187], v[126:127], v[126:127] op_sel:[0,0]
  v_pk_mov_b32 v[252:253], v[188:189], v[188:189] op_sel:[0,1]
  v_pk_mov_b32 v[188:189], v[126:127], v[126:127] op_sel:[1,1]
  v_pk_mov_b32 v[254:255], v[190:191], v[190:191] op_sel:[0,1]
  v_pk_mov_b32 v[190:191], v[126:127], v[126:127] op_sel:[1,1]
  s_waitcnt lgkmcnt(0)
  s_barrier
  ds_read_b64_tr_b16 v[48:49], v4 offset:16384
  ds_read_b64_tr_b16 v[50:51], v4 offset:17408
  ds_read_b128 v[32:35], v2 offset:0
  ds_read_b128 v[36:39], v2 offset:2048
  ds_read_b64_tr_b16 v[52:53], v5 offset:16384
  ds_read_b64_tr_b16 v[54:55], v5 offset:17408
  ds_read_b128 v[40:43], v2 offset:4096
  ds_read_b64_tr_b16 v[56:57], v6 offset:16384
  ds_read_b64_tr_b16 v[58:59], v6 offset:17408
  ds_read_b128 v[44:47], v2 offset:6144
  ds_read_b64_tr_b16 v[60:61], v7 offset:16384
  ds_read_b64_tr_b16 v[62:63], v7 offset:17408
  s_waitcnt lgkmcnt(0)
  v_mfma_f32_16x16x32_bf16 v[128:131], v[48:51], v[32:35], v[128:131]
  ds_read_b64_tr_b16 v[80:81], v4 offset:24576
  ds_read_b64_tr_b16 v[82:83], v4 offset:25600
  v_mul_f32 v96, v192, v192
  v_mul_f32 v97, v193, v193
  v_mfma_f32_16x16x32_bf16 v[132:135], v[48:51], v[36:39], v[132:135]
  ds_read_b128 v[64:67], v3 offset:0
  v_mul_f32 v98, v194, v194
  v_mfma_f32_16x16x32_bf16 v[136:139], v[48:51], v[40:43], v[136:139]
  ds_read_b128 v[68:71], v3 offset:2048
  v_mul_f32 v99, v195, v195
  v_mfma_f32_16x16x32_bf16 v[140:143], v[48:51], v[44:47], v[140:143]
  ds_read_b64_tr_b16 v[84:85], v5 offset:24576
  v_fma_f32 v96, v96, s36, v104
  v_mfma_f32_16x16x32_bf16 v[144:147], v[52:55], v[32:35], v[144:147]
  ds_read_b64_tr_b16 v[86:87], v5 offset:25600
  v_fma_f32 v97, v97, s36, v104
  v_mfma_f32_16x16x32_bf16 v[148:151], v[52:55], v[36:39], v[148:151]
  ds_read_b128 v[72:75], v3 offset:4096
  v_fma_f32 v98, v98, s36, v104
  v_mfma_f32_16x16x32_bf16 v[152:155], v[52:55], v[40:43], v[152:155]
  ds_read_b64_tr_b16 v[88:89], v6 offset:24576
  v_fma_f32 v99, v99, s36, v104
  v_mfma_f32_16x16x32_bf16 v[156:159], v[52:55], v[44:47], v[156:159]
  ds_read_b64_tr_b16 v[90:91], v6 offset:25600
  v_mul_f32 v96, v96, v192
  v_mfma_f32_16x16x32_bf16 v[160:163], v[56:59], v[32:35], v[160:163]
  ds_read_b128 v[76:79], v3 offset:6144
  v_mul_f32 v97, v97, v193
  v_mul_f32 v98, v98, v194
  v_mfma_f32_16x16x32_bf16 v[164:167], v[56:59], v[36:39], v[164:167]
  ds_read_b64_tr_b16 v[92:93], v7 offset:24576
  v_mul_f32 v99, v99, v195
  v_mfma_f32_16x16x32_bf16 v[168:171], v[56:59], v[40:43], v[168:171]
  ds_read_b64_tr_b16 v[94:95], v7 offset:25600
  v_exp_f32 v96, v96
  v_mfma_f32_16x16x32_bf16 v[172:175], v[56:59], v[44:47], v[172:175]
  v_exp_f32 v97, v97
  v_mfma_f32_16x16x32_bf16 v[176:179], v[60:63], v[32:35], v[176:179]
  v_exp_f32 v98, v98
  v_mfma_f32_16x16x32_bf16 v[180:183], v[60:63], v[36:39], v[180:183]
  v_exp_f32 v99, v99
  v_mfma_f32_16x16x32_bf16 v[184:187], v[60:63], v[40:43], v[184:187]
  v_add_f32 v96, 1.0, v96
  v_mfma_f32_16x16x32_bf16 v[188:191], v[60:63], v[44:47], v[188:191]
  v_add_f32 v97, 1.0, v97
  s_waitcnt lgkmcnt(0)
  s_barrier
  v_mfma_f32_16x16x32_bf16 v[128:131], v[80:83], v[64:67], v[128:131]
  ds_read_b64_tr_b16 v[48:49], v4 offset:49152
  ds_read_b64_tr_b16 v[50:51], v4 offset:50176
  v_add_f32 v98, 1.0, v98
  v_add_f32 v99, 1.0, v99
  v_mfma_f32_16x16x32_bf16 v[132:135], v[80:83], v[68:71], v[132:135]
  ds_read_b128 v[32:35], v2 offset:32768
  v_rcp_f32 v96, v96
  v_mfma_f32_16x16x32_bf16 v[136:139], v[80:83], v[72:75], v[136:139]
  ds_read_b128 v[36:39], v2 offset:34816
  v_rcp_f32 v97, v97
  v_mfma_f32_16x16x32_bf16 v[140:143], v[80:83], v[76:79], v[140:143]
  ds_read_b64_tr_b16 v[52:53], v5 offset:49152
  v_rcp_f32 v98, v98
  v_mfma_f32_16x16x32_bf16 v[144:147], v[84:87], v[64:67], v[144:147]
  ds_read_b64_tr_b16 v[54:55], v5 offset:50176
  v_rcp_f32 v99, v99
  v_mfma_f32_16x16x32_bf16 v[148:151], v[84:87], v[68:71], v[148:151]
  ds_read_b128 v[40:43], v2 offset:36864
  v_mul_f32 v192, v192, v96
  v_mul_f32 v193, v193, v97
  v_mfma_f32_16x16x32_bf16 v[152:155], v[84:87], v[72:75], v[152:155]
  ds_read_b64_tr_b16 v[56:57], v6 offset:49152
  v_mul_f32 v194, v194, v98
  v_mfma_f32_16x16x32_bf16 v[156:159], v[84:87], v[76:79], v[156:159]
  ds_read_b64_tr_b16 v[58:59], v6 offset:50176
  v_mul_f32 v195, v195, v99
  v_mfma_f32_16x16x32_bf16 v[160:163], v[88:91], v[64:67], v[160:163]
  ds_read_b128 v[44:47], v2 offset:38912
  v_mul_f32 v100, v196, v196
  v_mfma_f32_16x16x32_bf16 v[164:167], v[88:91], v[68:71], v[164:167]
  ds_read_b64_tr_b16 v[60:61], v7 offset:49152
  v_mul_f32 v101, v197, v197
  v_mfma_f32_16x16x32_bf16 v[168:171], v[88:91], v[72:75], v[168:171]
  ds_read_b64_tr_b16 v[62:63], v7 offset:50176
  v_mul_f32 v102, v198, v198
  v_mul_f32 v103, v199, v199
  v_mfma_f32_16x16x32_bf16 v[172:175], v[88:91], v[76:79], v[172:175]
  v_fma_f32 v100, v100, s36, v104
  v_mfma_f32_16x16x32_bf16 v[176:179], v[92:95], v[64:67], v[176:179]
  v_fma_f32 v101, v101, s36, v104
  v_mfma_f32_16x16x32_bf16 v[180:183], v[92:95], v[68:71], v[180:183]
  v_fma_f32 v102, v102, s36, v104
  v_mfma_f32_16x16x32_bf16 v[184:187], v[92:95], v[72:75], v[184:187]
  v_fma_f32 v103, v103, s36, v104
  v_mfma_f32_16x16x32_bf16 v[188:191], v[92:95], v[76:79], v[188:191]
  v_mul_f32 v100, v100, v196
  s_waitcnt lgkmcnt(0)
  v_mfma_f32_16x16x32_bf16 v[128:131], v[48:51], v[32:35], v[128:131]
  ds_read_b64_tr_b16 v[80:81], v4 offset:57344
  ds_read_b64_tr_b16 v[82:83], v4 offset:58368
  v_mul_f32 v101, v101, v197
  v_mul_f32 v102, v102, v198
  v_mfma_f32_16x16x32_bf16 v[132:135], v[48:51], v[36:39], v[132:135]
  ds_read_b128 v[64:67], v3 offset:32768
  v_mul_f32 v103, v103, v199
  v_mfma_f32_16x16x32_bf16 v[136:139], v[48:51], v[40:43], v[136:139]
  ds_read_b128 v[68:71], v3 offset:34816
  v_exp_f32 v100, v100
  v_mfma_f32_16x16x32_bf16 v[140:143], v[48:51], v[44:47], v[140:143]
  ds_read_b64_tr_b16 v[84:85], v5 offset:57344
  v_exp_f32 v101, v101
  v_mfma_f32_16x16x32_bf16 v[144:147], v[52:55], v[32:35], v[144:147]
  ds_read_b64_tr_b16 v[86:87], v5 offset:58368
  v_exp_f32 v102, v102
  v_mfma_f32_16x16x32_bf16 v[148:151], v[52:55], v[36:39], v[148:151]
  ds_read_b128 v[72:75], v3 offset:36864
  v_exp_f32 v103, v103
  v_add_f32 v100, 1.0, v100
  v_mfma_f32_16x16x32_bf16 v[152:155], v[52:55], v[40:43], v[152:155]
  ds_read_b64_tr_b16 v[88:89], v6 offset:57344
  v_add_f32 v101, 1.0, v101
  v_mfma_f32_16x16x32_bf16 v[156:159], v[52:55], v[44:47], v[156:159]
  ds_read_b64_tr_b16 v[90:91], v6 offset:58368
  v_add_f32 v102, 1.0, v102
  v_mfma_f32_16x16x32_bf16 v[160:163], v[56:59], v[32:35], v[160:163]
  ds_read_b128 v[76:79], v3 offset:38912
  v_add_f32 v103, 1.0, v103
  v_mfma_f32_16x16x32_bf16 v[164:167], v[56:59], v[36:39], v[164:167]
  ds_read_b64_tr_b16 v[92:93], v7 offset:57344
  v_rcp_f32 v100, v100
  v_mfma_f32_16x16x32_bf16 v[168:171], v[56:59], v[40:43], v[168:171]
  ds_read_b64_tr_b16 v[94:95], v7 offset:58368
  v_rcp_f32 v101, v101
  v_rcp_f32 v102, v102
  v_mfma_f32_16x16x32_bf16 v[172:175], v[56:59], v[44:47], v[172:175]
  v_rcp_f32 v103, v103
  v_mfma_f32_16x16x32_bf16 v[176:179], v[60:63], v[32:35], v[176:179]
  v_mul_f32 v196, v196, v100
  v_mfma_f32_16x16x32_bf16 v[180:183], v[60:63], v[36:39], v[180:183]
  v_mul_f32 v197, v197, v101
  v_mfma_f32_16x16x32_bf16 v[184:187], v[60:63], v[40:43], v[184:187]
  v_mul_f32 v198, v198, v102
  v_mfma_f32_16x16x32_bf16 v[188:191], v[60:63], v[44:47], v[188:191]
  v_mul_f32 v199, v199, v103
  s_waitcnt lgkmcnt(0)
  s_barrier
  v_mfma_f32_16x16x32_bf16 v[128:131], v[80:83], v[64:67], v[128:131]
  ds_read_b64_tr_b16 v[48:49], v22 offset:16384
  ds_read_b64_tr_b16 v[50:51], v22 offset:17408
  v_mul_f32 v96, v200, v200
  v_mul_f32 v97, v201, v201
  v_mfma_f32_16x16x32_bf16 v[132:135], v[80:83], v[68:71], v[132:135]
  ds_read_b128 v[32:35], v20 offset:0
  v_mul_f32 v98, v202, v202
  v_mfma_f32_16x16x32_bf16 v[136:139], v[80:83], v[72:75], v[136:139]
  ds_read_b128 v[36:39], v20 offset:2048
  v_mul_f32 v99, v203, v203
  v_mfma_f32_16x16x32_bf16 v[140:143], v[80:83], v[76:79], v[140:143]
  ds_read_b64_tr_b16 v[52:53], v23 offset:16384
  v_fma_f32 v96, v96, s36, v104
  v_mfma_f32_16x16x32_bf16 v[144:147], v[84:87], v[64:67], v[144:147]
  ds_read_b64_tr_b16 v[54:55], v23 offset:17408
  v_fma_f32 v97, v97, s36, v104
  v_mfma_f32_16x16x32_bf16 v[148:151], v[84:87], v[68:71], v[148:151]
  ds_read_b128 v[40:43], v20 offset:4096
  v_fma_f32 v98, v98, s36, v104
  v_mfma_f32_16x16x32_bf16 v[152:155], v[84:87], v[72:75], v[152:155]
  ds_read_b64_tr_b16 v[56:57], v24 offset:16384
  v_fma_f32 v99, v99, s36, v104
  v_mfma_f32_16x16x32_bf16 v[156:159], v[84:87], v[76:79], v[156:159]
  ds_read_b64_tr_b16 v[58:59], v24 offset:17408
  v_mul_f32 v96, v96, v200
  v_mfma_f32_16x16x32_bf16 v[160:163], v[88:91], v[64:67], v[160:163]
  ds_read_b128 v[44:47], v20 offset:6144
  v_mul_f32 v97, v97, v201
  v_mul_f32 v98, v98, v202
  v_mfma_f32_16x16x32_bf16 v[164:167], v[88:91], v[68:71], v[164:167]
  ds_read_b64_tr_b16 v[60:61], v25 offset:16384
  v_mul_f32 v99, v99, v203
  v_mfma_f32_16x16x32_bf16 v[168:171], v[88:91], v[72:75], v[168:171]
  ds_read_b64_tr_b16 v[62:63], v25 offset:17408
  v_exp_f32 v96, v96
  v_mfma_f32_16x16x32_bf16 v[172:175], v[88:91], v[76:79], v[172:175]
  v_exp_f32 v97, v97
  v_mfma_f32_16x16x32_bf16 v[176:179], v[92:95], v[64:67], v[176:179]
  v_exp_f32 v98, v98
  v_mfma_f32_16x16x32_bf16 v[180:183], v[92:95], v[68:71], v[180:183]
  v_exp_f32 v99, v99
  v_mfma_f32_16x16x32_bf16 v[184:187], v[92:95], v[72:75], v[184:187]
  v_add_f32 v96, 1.0, v96
  v_mfma_f32_16x16x32_bf16 v[188:191], v[92:95], v[76:79], v[188:191]
  v_add_f32 v97, 1.0, v97
  s_waitcnt lgkmcnt(0)
  v_mfma_f32_16x16x32_bf16 v[128:131], v[48:51], v[32:35], v[128:131]
  ds_read_b64_tr_b16 v[80:81], v22 offset:24576
  ds_read_b64_tr_b16 v[82:83], v22 offset:25600
  v_add_f32 v98, 1.0, v98
  v_add_f32 v99, 1.0, v99
  v_mfma_f32_16x16x32_bf16 v[132:135], v[48:51], v[36:39], v[132:135]
  ds_read_b128 v[64:67], v21 offset:0
  v_rcp_f32 v96, v96
  v_mfma_f32_16x16x32_bf16 v[136:139], v[48:51], v[40:43], v[136:139]
  ds_read_b128 v[68:71], v21 offset:2048
  v_rcp_f32 v97, v97
  v_mfma_f32_16x16x32_bf16 v[140:143], v[48:51], v[44:47], v[140:143]
  ds_read_b64_tr_b16 v[84:85], v23 offset:24576
  v_rcp_f32 v98, v98
  v_mfma_f32_16x16x32_bf16 v[144:147], v[52:55], v[32:35], v[144:147]
  ds_read_b64_tr_b16 v[86:87], v23 offset:25600
  v_rcp_f32 v99, v99
  v_mfma_f32_16x16x32_bf16 v[148:151], v[52:55], v[36:39], v[148:151]
  ds_read_b128 v[72:75], v21 offset:4096
  v_mul_f32 v200, v200, v96
  v_mul_f32 v201, v201, v97
  v_mfma_f32_16x16x32_bf16 v[152:155], v[52:55], v[40:43], v[152:155]
  ds_read_b64_tr_b16 v[88:89], v24 offset:24576
  v_mul_f32 v202, v202, v98
  v_mfma_f32_16x16x32_bf16 v[156:159], v[52:55], v[44:47], v[156:159]
  ds_read_b64_tr_b16 v[90:91], v24 offset:25600
  v_mul_f32 v203, v203, v99
  v_mfma_f32_16x16x32_bf16 v[160:163], v[56:59], v[32:35], v[160:163]
  ds_read_b128 v[76:79], v21 offset:6144
  v_mul_f32 v100, v204, v204
  v_mfma_f32_16x16x32_bf16 v[164:167], v[56:59], v[36:39], v[164:167]
  ds_read_b64_tr_b16 v[92:93], v25 offset:24576
  v_mul_f32 v101, v205, v205
  v_mfma_f32_16x16x32_bf16 v[168:171], v[56:59], v[40:43], v[168:171]
  ds_read_b64_tr_b16 v[94:95], v25 offset:25600
  v_mul_f32 v102, v206, v206
  v_mul_f32 v103, v207, v207
  v_mfma_f32_16x16x32_bf16 v[172:175], v[56:59], v[44:47], v[172:175]
  v_fma_f32 v100, v100, s36, v104
  v_mfma_f32_16x16x32_bf16 v[176:179], v[60:63], v[32:35], v[176:179]
  v_fma_f32 v101, v101, s36, v104
  v_mfma_f32_16x16x32_bf16 v[180:183], v[60:63], v[36:39], v[180:183]
  v_fma_f32 v102, v102, s36, v104
  v_mfma_f32_16x16x32_bf16 v[184:187], v[60:63], v[40:43], v[184:187]
  v_fma_f32 v103, v103, s36, v104
  v_mfma_f32_16x16x32_bf16 v[188:191], v[60:63], v[44:47], v[188:191]
  v_mul_f32 v100, v100, v204
  s_waitcnt lgkmcnt(0)
  s_barrier
  v_mfma_f32_16x16x32_bf16 v[128:131], v[80:83], v[64:67], v[128:131]
  ds_read_b64_tr_b16 v[48:49], v22 offset:49152
  ds_read_b64_tr_b16 v[50:51], v22 offset:50176
  v_mul_f32 v101, v101, v205
  v_mul_f32 v102, v102, v206
  v_mfma_f32_16x16x32_bf16 v[132:135], v[80:83], v[68:71], v[132:135]
  ds_read_b128 v[32:35], v20 offset:32768
  v_mul_f32 v103, v103, v207
  v_mfma_f32_16x16x32_bf16 v[136:139], v[80:83], v[72:75], v[136:139]
  ds_read_b128 v[36:39], v20 offset:34816
  v_exp_f32 v100, v100
  v_mfma_f32_16x16x32_bf16 v[140:143], v[80:83], v[76:79], v[140:143]
  ds_read_b64_tr_b16 v[52:53], v23 offset:49152
  v_exp_f32 v101, v101
  v_mfma_f32_16x16x32_bf16 v[144:147], v[84:87], v[64:67], v[144:147]
  ds_read_b64_tr_b16 v[54:55], v23 offset:50176
  v_exp_f32 v102, v102
  v_mfma_f32_16x16x32_bf16 v[148:151], v[84:87], v[68:71], v[148:151]
  ds_read_b128 v[40:43], v20 offset:36864
  v_exp_f32 v103, v103
  v_add_f32 v100, 1.0, v100
  v_mfma_f32_16x16x32_bf16 v[152:155], v[84:87], v[72:75], v[152:155]
  ds_read_b64_tr_b16 v[56:57], v24 offset:49152
  v_add_f32 v101, 1.0, v101
  v_mfma_f32_16x16x32_bf16 v[156:159], v[84:87], v[76:79], v[156:159]
  ds_read_b64_tr_b16 v[58:59], v24 offset:50176
  v_add_f32 v102, 1.0, v102
  v_mfma_f32_16x16x32_bf16 v[160:163], v[88:91], v[64:67], v[160:163]
  ds_read_b128 v[44:47], v20 offset:38912
  v_add_f32 v103, 1.0, v103
  v_mfma_f32_16x16x32_bf16 v[164:167], v[88:91], v[68:71], v[164:167]
  ds_read_b64_tr_b16 v[60:61], v25 offset:49152
  v_rcp_f32 v100, v100
  v_mfma_f32_16x16x32_bf16 v[168:171], v[88:91], v[72:75], v[168:171]
  ds_read_b64_tr_b16 v[62:63], v25 offset:50176
  v_rcp_f32 v101, v101
  v_rcp_f32 v102, v102
  v_mfma_f32_16x16x32_bf16 v[172:175], v[88:91], v[76:79], v[172:175]
  v_rcp_f32 v103, v103
  v_mfma_f32_16x16x32_bf16 v[176:179], v[92:95], v[64:67], v[176:179]
  v_mul_f32 v204, v204, v100
  v_mfma_f32_16x16x32_bf16 v[180:183], v[92:95], v[68:71], v[180:183]
  v_mul_f32 v205, v205, v101
  v_mfma_f32_16x16x32_bf16 v[184:187], v[92:95], v[72:75], v[184:187]
  v_mul_f32 v206, v206, v102
  v_mfma_f32_16x16x32_bf16 v[188:191], v[92:95], v[76:79], v[188:191]
  v_mul_f32 v207, v207, v103
  s_waitcnt lgkmcnt(0)
  v_mfma_f32_16x16x32_bf16 v[128:131], v[48:51], v[32:35], v[128:131]
  ds_read_b64_tr_b16 v[80:81], v22 offset:57344
  ds_read_b64_tr_b16 v[82:83], v22 offset:58368
  v_mul_f32 v96, v208, v208
  v_mul_f32 v97, v209, v209
  v_mfma_f32_16x16x32_bf16 v[132:135], v[48:51], v[36:39], v[132:135]
  ds_read_b128 v[64:67], v21 offset:32768
  v_mul_f32 v98, v210, v210
  v_mfma_f32_16x16x32_bf16 v[136:139], v[48:51], v[40:43], v[136:139]
  ds_read_b128 v[68:71], v21 offset:34816
  v_mul_f32 v99, v211, v211
  v_mfma_f32_16x16x32_bf16 v[140:143], v[48:51], v[44:47], v[140:143]
  ds_read_b64_tr_b16 v[84:85], v23 offset:57344
  v_fma_f32 v96, v96, s36, v104
  v_mfma_f32_16x16x32_bf16 v[144:147], v[52:55], v[32:35], v[144:147]
  ds_read_b64_tr_b16 v[86:87], v23 offset:58368
  v_fma_f32 v97, v97, s36, v104
  v_mfma_f32_16x16x32_bf16 v[148:151], v[52:55], v[36:39], v[148:151]
  ds_read_b128 v[72:75], v21 offset:36864
  v_fma_f32 v98, v98, s36, v104
  v_mfma_f32_16x16x32_bf16 v[152:155], v[52:55], v[40:43], v[152:155]
  ds_read_b64_tr_b16 v[88:89], v24 offset:57344
  v_fma_f32 v99, v99, s36, v104
  v_mfma_f32_16x16x32_bf16 v[156:159], v[52:55], v[44:47], v[156:159]
  ds_read_b64_tr_b16 v[90:91], v24 offset:58368
  v_mul_f32 v96, v96, v208
  v_mfma_f32_16x16x32_bf16 v[160:163], v[56:59], v[32:35], v[160:163]
  ds_read_b128 v[76:79], v21 offset:38912
  v_mul_f32 v97, v97, v209
  v_mul_f32 v98, v98, v210
  v_mfma_f32_16x16x32_bf16 v[164:167], v[56:59], v[36:39], v[164:167]
  ds_read_b64_tr_b16 v[92:93], v25 offset:57344
  v_mul_f32 v99, v99, v211
  v_mfma_f32_16x16x32_bf16 v[168:171], v[56:59], v[40:43], v[168:171]
  ds_read_b64_tr_b16 v[94:95], v25 offset:58368
  v_exp_f32 v96, v96
  v_mfma_f32_16x16x32_bf16 v[172:175], v[56:59], v[44:47], v[172:175]
  v_exp_f32 v97, v97
  v_mfma_f32_16x16x32_bf16 v[176:179], v[60:63], v[32:35], v[176:179]
  v_exp_f32 v98, v98
  v_mfma_f32_16x16x32_bf16 v[180:183], v[60:63], v[36:39], v[180:183]
  v_exp_f32 v99, v99
  v_mfma_f32_16x16x32_bf16 v[184:187], v[60:63], v[40:43], v[184:187]
  v_add_f32 v96, 1.0, v96
  v_mfma_f32_16x16x32_bf16 v[188:191], v[60:63], v[44:47], v[188:191]
  v_add_f32 v97, 1.0, v97
  s_waitcnt lgkmcnt(0)
  s_barrier
  v_mfma_f32_16x16x32_bf16 v[128:131], v[80:83], v[64:67], v[128:131]
  ds_read_b64_tr_b16 v[48:49], v4 offset:16384
  ds_read_b64_tr_b16 v[50:51], v4 offset:17408
  v_add_f32 v98, 1.0, v98
  v_add_f32 v99, 1.0, v99
  v_mfma_f32_16x16x32_bf16 v[132:135], v[80:83], v[68:71], v[132:135]
  ds_read_b128 v[32:35], v2 offset:0
  v_rcp_f32 v96, v96
  v_mfma_f32_16x16x32_bf16 v[136:139], v[80:83], v[72:75], v[136:139]
  ds_read_b128 v[36:39], v2 offset:2048
  v_rcp_f32 v97, v97
  v_mfma_f32_16x16x32_bf16 v[140:143], v[80:83], v[76:79], v[140:143]
  ds_read_b64_tr_b16 v[52:53], v5 offset:16384
  v_rcp_f32 v98, v98
  v_mfma_f32_16x16x32_bf16 v[144:147], v[84:87], v[64:67], v[144:147]
  ds_read_b64_tr_b16 v[54:55], v5 offset:17408
  v_rcp_f32 v99, v99
  v_mfma_f32_16x16x32_bf16 v[148:151], v[84:87], v[68:71], v[148:151]
  ds_read_b128 v[40:43], v2 offset:4096
  v_mul_f32 v208, v208, v96
  v_mul_f32 v209, v209, v97
  v_mfma_f32_16x16x32_bf16 v[152:155], v[84:87], v[72:75], v[152:155]
  ds_read_b64_tr_b16 v[56:57], v6 offset:16384
  v_mul_f32 v210, v210, v98
  v_mfma_f32_16x16x32_bf16 v[156:159], v[84:87], v[76:79], v[156:159]
  ds_read_b64_tr_b16 v[58:59], v6 offset:17408
  v_mul_f32 v211, v211, v99
  v_mfma_f32_16x16x32_bf16 v[160:163], v[88:91], v[64:67], v[160:163]
  ds_read_b128 v[44:47], v2 offset:6144
  v_mul_f32 v100, v212, v212
  v_mfma_f32_16x16x32_bf16 v[164:167], v[88:91], v[68:71], v[164:167]
  ds_read_b64_tr_b16 v[60:61], v7 offset:16384
  v_mul_f32 v101, v213, v213
  v_mfma_f32_16x16x32_bf16 v[168:171], v[88:91], v[72:75], v[168:171]
  ds_read_b64_tr_b16 v[62:63], v7 offset:17408
  v_mul_f32 v102, v214, v214
  v_mul_f32 v103, v215, v215
  v_mfma_f32_16x16x32_bf16 v[172:175], v[88:91], v[76:79], v[172:175]
  v_fma_f32 v100, v100, s36, v104
  v_mfma_f32_16x16x32_bf16 v[176:179], v[92:95], v[64:67], v[176:179]
  v_fma_f32 v101, v101, s36, v104
  v_mfma_f32_16x16x32_bf16 v[180:183], v[92:95], v[68:71], v[180:183]
  v_fma_f32 v102, v102, s36, v104
  v_mfma_f32_16x16x32_bf16 v[184:187], v[92:95], v[72:75], v[184:187]
  v_fma_f32 v103, v103, s36, v104
  v_mfma_f32_16x16x32_bf16 v[188:191], v[92:95], v[76:79], v[188:191]
  v_mul_f32 v100, v100, v212
  s_waitcnt lgkmcnt(0)
  v_mfma_f32_16x16x32_bf16 v[128:131], v[48:51], v[32:35], v[128:131]
  ds_read_b64_tr_b16 v[80:81], v4 offset:24576
  ds_read_b64_tr_b16 v[82:83], v4 offset:25600
  v_mul_f32 v101, v101, v213
  v_mul_f32 v102, v102, v214
  v_mfma_f32_16x16x32_bf16 v[132:135], v[48:51], v[36:39], v[132:135]
  ds_read_b128 v[64:67], v3 offset:0
  v_mul_f32 v103, v103, v215
  v_mfma_f32_16x16x32_bf16 v[136:139], v[48:51], v[40:43], v[136:139]
  ds_read_b128 v[68:71], v3 offset:2048
  v_exp_f32 v100, v100
  v_mfma_f32_16x16x32_bf16 v[140:143], v[48:51], v[44:47], v[140:143]
  ds_read_b64_tr_b16 v[84:85], v5 offset:24576
  v_exp_f32 v101, v101
  v_mfma_f32_16x16x32_bf16 v[144:147], v[52:55], v[32:35], v[144:147]
  ds_read_b64_tr_b16 v[86:87], v5 offset:25600
  v_exp_f32 v102, v102
  v_mfma_f32_16x16x32_bf16 v[148:151], v[52:55], v[36:39], v[148:151]
  ds_read_b128 v[72:75], v3 offset:4096
  v_exp_f32 v103, v103
  v_add_f32 v100, 1.0, v100
  v_mfma_f32_16x16x32_bf16 v[152:155], v[52:55], v[40:43], v[152:155]
  ds_read_b64_tr_b16 v[88:89], v6 offset:24576
  v_add_f32 v101, 1.0, v101
  v_mfma_f32_16x16x32_bf16 v[156:159], v[52:55], v[44:47], v[156:159]
  ds_read_b64_tr_b16 v[90:91], v6 offset:25600
  v_add_f32 v102, 1.0, v102
  v_mfma_f32_16x16x32_bf16 v[160:163], v[56:59], v[32:35], v[160:163]
  ds_read_b128 v[76:79], v3 offset:6144
  v_add_f32 v103, 1.0, v103
  v_mfma_f32_16x16x32_bf16 v[164:167], v[56:59], v[36:39], v[164:167]
  ds_read_b64_tr_b16 v[92:93], v7 offset:24576
  v_rcp_f32 v100, v100
  v_mfma_f32_16x16x32_bf16 v[168:171], v[56:59], v[40:43], v[168:171]
  ds_read_b64_tr_b16 v[94:95], v7 offset:25600
  v_rcp_f32 v101, v101
  v_rcp_f32 v102, v102
  v_mfma_f32_16x16x32_bf16 v[172:175], v[56:59], v[44:47], v[172:175]
  v_rcp_f32 v103, v103
  v_mfma_f32_16x16x32_bf16 v[176:179], v[60:63], v[32:35], v[176:179]
  v_mul_f32 v212, v212, v100
  v_mfma_f32_16x16x32_bf16 v[180:183], v[60:63], v[36:39], v[180:183]
  v_mul_f32 v213, v213, v101
  v_mfma_f32_16x16x32_bf16 v[184:187], v[60:63], v[40:43], v[184:187]
  v_mul_f32 v214, v214, v102
  v_mfma_f32_16x16x32_bf16 v[188:191], v[60:63], v[44:47], v[188:191]
  v_mul_f32 v215, v215, v103
  s_waitcnt lgkmcnt(0)
  s_barrier
  v_mfma_f32_16x16x32_bf16 v[128:131], v[80:83], v[64:67], v[128:131]
  ds_read_b64_tr_b16 v[48:49], v4 offset:49152
  ds_read_b64_tr_b16 v[50:51], v4 offset:50176
  v_mul_f32 v96, v216, v216
  v_mul_f32 v97, v217, v217
  v_mfma_f32_16x16x32_bf16 v[132:135], v[80:83], v[68:71], v[132:135]
  ds_read_b128 v[32:35], v2 offset:32768
  v_mul_f32 v98, v218, v218
  v_mfma_f32_16x16x32_bf16 v[136:139], v[80:83], v[72:75], v[136:139]
  ds_read_b128 v[36:39], v2 offset:34816
  v_mul_f32 v99, v219, v219
  v_mfma_f32_16x16x32_bf16 v[140:143], v[80:83], v[76:79], v[140:143]
  ds_read_b64_tr_b16 v[52:53], v5 offset:49152
  v_fma_f32 v96, v96, s36, v104
  v_mfma_f32_16x16x32_bf16 v[144:147], v[84:87], v[64:67], v[144:147]
  ds_read_b64_tr_b16 v[54:55], v5 offset:50176
  v_fma_f32 v97, v97, s36, v104
  v_mfma_f32_16x16x32_bf16 v[148:151], v[84:87], v[68:71], v[148:151]
  ds_read_b128 v[40:43], v2 offset:36864
  v_fma_f32 v98, v98, s36, v104
  v_mfma_f32_16x16x32_bf16 v[152:155], v[84:87], v[72:75], v[152:155]
  ds_read_b64_tr_b16 v[56:57], v6 offset:49152
  v_fma_f32 v99, v99, s36, v104
  v_mfma_f32_16x16x32_bf16 v[156:159], v[84:87], v[76:79], v[156:159]
  ds_read_b64_tr_b16 v[58:59], v6 offset:50176
  v_mul_f32 v96, v96, v216
  v_mfma_f32_16x16x32_bf16 v[160:163], v[88:91], v[64:67], v[160:163]
  ds_read_b128 v[44:47], v2 offset:38912
  v_mul_f32 v97, v97, v217
  v_mul_f32 v98, v98, v218
  v_mfma_f32_16x16x32_bf16 v[164:167], v[88:91], v[68:71], v[164:167]
  ds_read_b64_tr_b16 v[60:61], v7 offset:49152
  v_mul_f32 v99, v99, v219
  v_mfma_f32_16x16x32_bf16 v[168:171], v[88:91], v[72:75], v[168:171]
  ds_read_b64_tr_b16 v[62:63], v7 offset:50176
  v_exp_f32 v96, v96
  v_mfma_f32_16x16x32_bf16 v[172:175], v[88:91], v[76:79], v[172:175]
  v_exp_f32 v97, v97
  v_mfma_f32_16x16x32_bf16 v[176:179], v[92:95], v[64:67], v[176:179]
  v_exp_f32 v98, v98
  v_mfma_f32_16x16x32_bf16 v[180:183], v[92:95], v[68:71], v[180:183]
  v_exp_f32 v99, v99
  v_mfma_f32_16x16x32_bf16 v[184:187], v[92:95], v[72:75], v[184:187]
  v_add_f32 v96, 1.0, v96
  v_mfma_f32_16x16x32_bf16 v[188:191], v[92:95], v[76:79], v[188:191]
  v_add_f32 v97, 1.0, v97
  s_waitcnt lgkmcnt(0)
  v_mfma_f32_16x16x32_bf16 v[128:131], v[48:51], v[32:35], v[128:131]
  ds_read_b64_tr_b16 v[80:81], v4 offset:57344
  ds_read_b64_tr_b16 v[82:83], v4 offset:58368
  v_add_f32 v98, 1.0, v98
  v_add_f32 v99, 1.0, v99
  v_mfma_f32_16x16x32_bf16 v[132:135], v[48:51], v[36:39], v[132:135]
  ds_read_b128 v[64:67], v3 offset:32768
  v_rcp_f32 v96, v96
  v_mfma_f32_16x16x32_bf16 v[136:139], v[48:51], v[40:43], v[136:139]
  ds_read_b128 v[68:71], v3 offset:34816
  v_rcp_f32 v97, v97
  v_mfma_f32_16x16x32_bf16 v[140:143], v[48:51], v[44:47], v[140:143]
  ds_read_b64_tr_b16 v[84:85], v5 offset:57344
  v_rcp_f32 v98, v98
  v_mfma_f32_16x16x32_bf16 v[144:147], v[52:55], v[32:35], v[144:147]
  ds_read_b64_tr_b16 v[86:87], v5 offset:58368
  v_rcp_f32 v99, v99
  v_mfma_f32_16x16x32_bf16 v[148:151], v[52:55], v[36:39], v[148:151]
  ds_read_b128 v[72:75], v3 offset:36864
  v_mul_f32 v216, v216, v96
  v_mul_f32 v217, v217, v97
  v_mfma_f32_16x16x32_bf16 v[152:155], v[52:55], v[40:43], v[152:155]
  ds_read_b64_tr_b16 v[88:89], v6 offset:57344
  v_mul_f32 v218, v218, v98
  v_mfma_f32_16x16x32_bf16 v[156:159], v[52:55], v[44:47], v[156:159]
  ds_read_b64_tr_b16 v[90:91], v6 offset:58368
  v_mul_f32 v219, v219, v99
  v_mfma_f32_16x16x32_bf16 v[160:163], v[56:59], v[32:35], v[160:163]
  ds_read_b128 v[76:79], v3 offset:38912
  v_mul_f32 v100, v220, v220
  v_mfma_f32_16x16x32_bf16 v[164:167], v[56:59], v[36:39], v[164:167]
  ds_read_b64_tr_b16 v[92:93], v7 offset:57344
  v_mul_f32 v101, v221, v221
  v_mfma_f32_16x16x32_bf16 v[168:171], v[56:59], v[40:43], v[168:171]
  ds_read_b64_tr_b16 v[94:95], v7 offset:58368
  v_mul_f32 v102, v222, v222
  v_mul_f32 v103, v223, v223
  v_mfma_f32_16x16x32_bf16 v[172:175], v[56:59], v[44:47], v[172:175]
  v_fma_f32 v100, v100, s36, v104
  v_mfma_f32_16x16x32_bf16 v[176:179], v[60:63], v[32:35], v[176:179]
  v_fma_f32 v101, v101, s36, v104
  v_mfma_f32_16x16x32_bf16 v[180:183], v[60:63], v[36:39], v[180:183]
  v_fma_f32 v102, v102, s36, v104
  v_mfma_f32_16x16x32_bf16 v[184:187], v[60:63], v[40:43], v[184:187]
  v_fma_f32 v103, v103, s36, v104
  v_mfma_f32_16x16x32_bf16 v[188:191], v[60:63], v[44:47], v[188:191]
  v_mul_f32 v100, v100, v220
  s_waitcnt lgkmcnt(0)
  s_barrier
  v_mfma_f32_16x16x32_bf16 v[128:131], v[80:83], v[64:67], v[128:131]
  ds_read_b64_tr_b16 v[48:49], v22 offset:16384
  ds_read_b64_tr_b16 v[50:51], v22 offset:17408
  v_mul_f32 v101, v101, v221
  v_mul_f32 v102, v102, v222
  v_mfma_f32_16x16x32_bf16 v[132:135], v[80:83], v[68:71], v[132:135]
  ds_read_b128 v[32:35], v20 offset:0
  v_mul_f32 v103, v103, v223
  v_mfma_f32_16x16x32_bf16 v[136:139], v[80:83], v[72:75], v[136:139]
  ds_read_b128 v[36:39], v20 offset:2048
  v_exp_f32 v100, v100
  v_mfma_f32_16x16x32_bf16 v[140:143], v[80:83], v[76:79], v[140:143]
  ds_read_b64_tr_b16 v[52:53], v23 offset:16384
  v_exp_f32 v101, v101
  v_mfma_f32_16x16x32_bf16 v[144:147], v[84:87], v[64:67], v[144:147]
  ds_read_b64_tr_b16 v[54:55], v23 offset:17408
  v_exp_f32 v102, v102
  v_mfma_f32_16x16x32_bf16 v[148:151], v[84:87], v[68:71], v[148:151]
  ds_read_b128 v[40:43], v20 offset:4096
  v_exp_f32 v103, v103
  v_add_f32 v100, 1.0, v100
  v_mfma_f32_16x16x32_bf16 v[152:155], v[84:87], v[72:75], v[152:155]
  ds_read_b64_tr_b16 v[56:57], v24 offset:16384
  v_add_f32 v101, 1.0, v101
  v_mfma_f32_16x16x32_bf16 v[156:159], v[84:87], v[76:79], v[156:159]
  ds_read_b64_tr_b16 v[58:59], v24 offset:17408
  v_add_f32 v102, 1.0, v102
  v_mfma_f32_16x16x32_bf16 v[160:163], v[88:91], v[64:67], v[160:163]
  ds_read_b128 v[44:47], v20 offset:6144
  v_add_f32 v103, 1.0, v103
  v_mfma_f32_16x16x32_bf16 v[164:167], v[88:91], v[68:71], v[164:167]
  ds_read_b64_tr_b16 v[60:61], v25 offset:16384
  v_rcp_f32 v100, v100
  v_mfma_f32_16x16x32_bf16 v[168:171], v[88:91], v[72:75], v[168:171]
  ds_read_b64_tr_b16 v[62:63], v25 offset:17408
  v_rcp_f32 v101, v101
  v_rcp_f32 v102, v102
  v_mfma_f32_16x16x32_bf16 v[172:175], v[88:91], v[76:79], v[172:175]
  v_rcp_f32 v103, v103
  v_mfma_f32_16x16x32_bf16 v[176:179], v[92:95], v[64:67], v[176:179]
  v_mul_f32 v220, v220, v100
  v_mfma_f32_16x16x32_bf16 v[180:183], v[92:95], v[68:71], v[180:183]
  v_mul_f32 v221, v221, v101
  v_mfma_f32_16x16x32_bf16 v[184:187], v[92:95], v[72:75], v[184:187]
  v_mul_f32 v222, v222, v102
  v_mfma_f32_16x16x32_bf16 v[188:191], v[92:95], v[76:79], v[188:191]
  v_mul_f32 v223, v223, v103
  s_waitcnt lgkmcnt(0)
  v_mfma_f32_16x16x32_bf16 v[128:131], v[48:51], v[32:35], v[128:131]
  ds_read_b64_tr_b16 v[80:81], v22 offset:24576
  ds_read_b64_tr_b16 v[82:83], v22 offset:25600
  v_mul_f32 v96, v224, v224
  v_mul_f32 v97, v225, v225
  v_mfma_f32_16x16x32_bf16 v[132:135], v[48:51], v[36:39], v[132:135]
  ds_read_b128 v[64:67], v21 offset:0
  v_mul_f32 v98, v226, v226
  v_mfma_f32_16x16x32_bf16 v[136:139], v[48:51], v[40:43], v[136:139]
  ds_read_b128 v[68:71], v21 offset:2048
  v_mul_f32 v99, v227, v227
  v_mfma_f32_16x16x32_bf16 v[140:143], v[48:51], v[44:47], v[140:143]
  ds_read_b64_tr_b16 v[84:85], v23 offset:24576
  v_fma_f32 v96, v96, s36, v104
  v_mfma_f32_16x16x32_bf16 v[144:147], v[52:55], v[32:35], v[144:147]
  ds_read_b64_tr_b16 v[86:87], v23 offset:25600
  v_fma_f32 v97, v97, s36, v104
  v_mfma_f32_16x16x32_bf16 v[148:151], v[52:55], v[36:39], v[148:151]
  ds_read_b128 v[72:75], v21 offset:4096
  v_fma_f32 v98, v98, s36, v104
  v_mfma_f32_16x16x32_bf16 v[152:155], v[52:55], v[40:43], v[152:155]
  ds_read_b64_tr_b16 v[88:89], v24 offset:24576
  v_fma_f32 v99, v99, s36, v104
  v_mfma_f32_16x16x32_bf16 v[156:159], v[52:55], v[44:47], v[156:159]
  ds_read_b64_tr_b16 v[90:91], v24 offset:25600
  v_mul_f32 v96, v96, v224
  v_mfma_f32_16x16x32_bf16 v[160:163], v[56:59], v[32:35], v[160:163]
  ds_read_b128 v[76:79], v21 offset:6144
  v_mul_f32 v97, v97, v225
  v_mul_f32 v98, v98, v226
  v_mfma_f32_16x16x32_bf16 v[164:167], v[56:59], v[36:39], v[164:167]
  ds_read_b64_tr_b16 v[92:93], v25 offset:24576
  v_mul_f32 v99, v99, v227
  v_mfma_f32_16x16x32_bf16 v[168:171], v[56:59], v[40:43], v[168:171]
  ds_read_b64_tr_b16 v[94:95], v25 offset:25600
  v_exp_f32 v96, v96
  v_mfma_f32_16x16x32_bf16 v[172:175], v[56:59], v[44:47], v[172:175]
  v_exp_f32 v97, v97
  v_mfma_f32_16x16x32_bf16 v[176:179], v[60:63], v[32:35], v[176:179]
  v_exp_f32 v98, v98
  v_mfma_f32_16x16x32_bf16 v[180:183], v[60:63], v[36:39], v[180:183]
  v_exp_f32 v99, v99
  v_mfma_f32_16x16x32_bf16 v[184:187], v[60:63], v[40:43], v[184:187]
  v_add_f32 v96, 1.0, v96
  v_mfma_f32_16x16x32_bf16 v[188:191], v[60:63], v[44:47], v[188:191]
  v_add_f32 v97, 1.0, v97
  s_waitcnt lgkmcnt(0)
  s_barrier
  v_mfma_f32_16x16x32_bf16 v[128:131], v[80:83], v[64:67], v[128:131]
  ds_read_b64_tr_b16 v[48:49], v22 offset:49152
  ds_read_b64_tr_b16 v[50:51], v22 offset:50176
  v_add_f32 v98, 1.0, v98
  v_add_f32 v99, 1.0, v99
  v_mfma_f32_16x16x32_bf16 v[132:135], v[80:83], v[68:71], v[132:135]
  ds_read_b128 v[32:35], v20 offset:32768
  v_rcp_f32 v96, v96
  v_mfma_f32_16x16x32_bf16 v[136:139], v[80:83], v[72:75], v[136:139]
  ds_read_b128 v[36:39], v20 offset:34816
  v_rcp_f32 v97, v97
  v_mfma_f32_16x16x32_bf16 v[140:143], v[80:83], v[76:79], v[140:143]
  ds_read_b64_tr_b16 v[52:53], v23 offset:49152
  v_rcp_f32 v98, v98
  v_mfma_f32_16x16x32_bf16 v[144:147], v[84:87], v[64:67], v[144:147]
  ds_read_b64_tr_b16 v[54:55], v23 offset:50176
  v_rcp_f32 v99, v99
  v_mfma_f32_16x16x32_bf16 v[148:151], v[84:87], v[68:71], v[148:151]
  ds_read_b128 v[40:43], v20 offset:36864
  v_mul_f32 v224, v224, v96
  v_mul_f32 v225, v225, v97
  v_mfma_f32_16x16x32_bf16 v[152:155], v[84:87], v[72:75], v[152:155]
  ds_read_b64_tr_b16 v[56:57], v24 offset:49152
  v_mul_f32 v226, v226, v98
  v_mfma_f32_16x16x32_bf16 v[156:159], v[84:87], v[76:79], v[156:159]
  ds_read_b64_tr_b16 v[58:59], v24 offset:50176
  v_mul_f32 v227, v227, v99
  v_mfma_f32_16x16x32_bf16 v[160:163], v[88:91], v[64:67], v[160:163]
  ds_read_b128 v[44:47], v20 offset:38912
  v_mul_f32 v100, v228, v228
  v_mfma_f32_16x16x32_bf16 v[164:167], v[88:91], v[68:71], v[164:167]
  ds_read_b64_tr_b16 v[60:61], v25 offset:49152
  v_mul_f32 v101, v229, v229
  v_mfma_f32_16x16x32_bf16 v[168:171], v[88:91], v[72:75], v[168:171]
  ds_read_b64_tr_b16 v[62:63], v25 offset:50176
  v_mul_f32 v102, v230, v230
  v_mul_f32 v103, v231, v231
  v_mfma_f32_16x16x32_bf16 v[172:175], v[88:91], v[76:79], v[172:175]
  v_fma_f32 v100, v100, s36, v104
  v_mfma_f32_16x16x32_bf16 v[176:179], v[92:95], v[64:67], v[176:179]
  v_fma_f32 v101, v101, s36, v104
  v_mfma_f32_16x16x32_bf16 v[180:183], v[92:95], v[68:71], v[180:183]
  v_fma_f32 v102, v102, s36, v104
  v_mfma_f32_16x16x32_bf16 v[184:187], v[92:95], v[72:75], v[184:187]
  v_fma_f32 v103, v103, s36, v104
  v_mfma_f32_16x16x32_bf16 v[188:191], v[92:95], v[76:79], v[188:191]
  v_mul_f32 v100, v100, v228
  s_waitcnt lgkmcnt(0)
  v_mfma_f32_16x16x32_bf16 v[128:131], v[48:51], v[32:35], v[128:131]
  ds_read_b64_tr_b16 v[80:81], v22 offset:57344
  ds_read_b64_tr_b16 v[82:83], v22 offset:58368
  v_mul_f32 v101, v101, v229
  v_mul_f32 v102, v102, v230
  v_mfma_f32_16x16x32_bf16 v[132:135], v[48:51], v[36:39], v[132:135]
  ds_read_b128 v[64:67], v21 offset:32768
  v_mul_f32 v103, v103, v231
  v_mfma_f32_16x16x32_bf16 v[136:139], v[48:51], v[40:43], v[136:139]
  ds_read_b128 v[68:71], v21 offset:34816
  v_exp_f32 v100, v100
  v_mfma_f32_16x16x32_bf16 v[140:143], v[48:51], v[44:47], v[140:143]
  ds_read_b64_tr_b16 v[84:85], v23 offset:57344
  v_exp_f32 v101, v101
  v_mfma_f32_16x16x32_bf16 v[144:147], v[52:55], v[32:35], v[144:147]
  ds_read_b64_tr_b16 v[86:87], v23 offset:58368
  v_exp_f32 v102, v102
  v_mfma_f32_16x16x32_bf16 v[148:151], v[52:55], v[36:39], v[148:151]
  ds_read_b128 v[72:75], v21 offset:36864
  v_exp_f32 v103, v103
  v_add_f32 v100, 1.0, v100
  v_mfma_f32_16x16x32_bf16 v[152:155], v[52:55], v[40:43], v[152:155]
  ds_read_b64_tr_b16 v[88:89], v24 offset:57344
  v_add_f32 v101, 1.0, v101
  v_mfma_f32_16x16x32_bf16 v[156:159], v[52:55], v[44:47], v[156:159]
  ds_read_b64_tr_b16 v[90:91], v24 offset:58368
  v_add_f32 v102, 1.0, v102
  v_mfma_f32_16x16x32_bf16 v[160:163], v[56:59], v[32:35], v[160:163]
  ds_read_b128 v[76:79], v21 offset:38912
  v_add_f32 v103, 1.0, v103
  v_mfma_f32_16x16x32_bf16 v[164:167], v[56:59], v[36:39], v[164:167]
  ds_read_b64_tr_b16 v[92:93], v25 offset:57344
  v_rcp_f32 v100, v100
  v_mfma_f32_16x16x32_bf16 v[168:171], v[56:59], v[40:43], v[168:171]
  ds_read_b64_tr_b16 v[94:95], v25 offset:58368
  v_rcp_f32 v101, v101
  v_rcp_f32 v102, v102
  v_mfma_f32_16x16x32_bf16 v[172:175], v[56:59], v[44:47], v[172:175]
  v_rcp_f32 v103, v103
  v_mfma_f32_16x16x32_bf16 v[176:179], v[60:63], v[32:35], v[176:179]
  v_mul_f32 v228, v228, v100
  v_mfma_f32_16x16x32_bf16 v[180:183], v[60:63], v[36:39], v[180:183]
  v_mul_f32 v229, v229, v101
  v_mfma_f32_16x16x32_bf16 v[184:187], v[60:63], v[40:43], v[184:187]
  v_mul_f32 v230, v230, v102
  v_mfma_f32_16x16x32_bf16 v[188:191], v[60:63], v[44:47], v[188:191]
  v_mul_f32 v231, v231, v103
  s_waitcnt lgkmcnt(0)
  s_barrier
  v_mfma_f32_16x16x32_bf16 v[128:131], v[80:83], v[64:67], v[128:131]
  ds_read_b64_tr_b16 v[48:49], v4 offset:16384
  ds_read_b64_tr_b16 v[50:51], v4 offset:17408
  v_mul_f32 v96, v232, v232
  v_mul_f32 v97, v233, v233
  v_mfma_f32_16x16x32_bf16 v[132:135], v[80:83], v[68:71], v[132:135]
  ds_read_b128 v[32:35], v2 offset:0
  v_mul_f32 v98, v234, v234
  v_mfma_f32_16x16x32_bf16 v[136:139], v[80:83], v[72:75], v[136:139]
  ds_read_b128 v[36:39], v2 offset:2048
  v_mul_f32 v99, v235, v235
  v_mfma_f32_16x16x32_bf16 v[140:143], v[80:83], v[76:79], v[140:143]
  ds_read_b64_tr_b16 v[52:53], v5 offset:16384
  v_fma_f32 v96, v96, s36, v104
  v_mfma_f32_16x16x32_bf16 v[144:147], v[84:87], v[64:67], v[144:147]
  ds_read_b64_tr_b16 v[54:55], v5 offset:17408
  v_fma_f32 v97, v97, s36, v104
  v_mfma_f32_16x16x32_bf16 v[148:151], v[84:87], v[68:71], v[148:151]
  ds_read_b128 v[40:43], v2 offset:4096
  v_fma_f32 v98, v98, s36, v104
  v_mfma_f32_16x16x32_bf16 v[152:155], v[84:87], v[72:75], v[152:155]
  ds_read_b64_tr_b16 v[56:57], v6 offset:16384
  v_fma_f32 v99, v99, s36, v104
  v_mfma_f32_16x16x32_bf16 v[156:159], v[84:87], v[76:79], v[156:159]
  ds_read_b64_tr_b16 v[58:59], v6 offset:17408
  v_mul_f32 v96, v96, v232
  v_mfma_f32_16x16x32_bf16 v[160:163], v[88:91], v[64:67], v[160:163]
  ds_read_b128 v[44:47], v2 offset:6144
  v_mul_f32 v97, v97, v233
  v_mul_f32 v98, v98, v234
  v_mfma_f32_16x16x32_bf16 v[164:167], v[88:91], v[68:71], v[164:167]
  ds_read_b64_tr_b16 v[60:61], v7 offset:16384
  v_mul_f32 v99, v99, v235
  v_mfma_f32_16x16x32_bf16 v[168:171], v[88:91], v[72:75], v[168:171]
  ds_read_b64_tr_b16 v[62:63], v7 offset:17408
  v_exp_f32 v96, v96
  v_mfma_f32_16x16x32_bf16 v[172:175], v[88:91], v[76:79], v[172:175]
  v_exp_f32 v97, v97
  v_mfma_f32_16x16x32_bf16 v[176:179], v[92:95], v[64:67], v[176:179]
  v_exp_f32 v98, v98
  v_mfma_f32_16x16x32_bf16 v[180:183], v[92:95], v[68:71], v[180:183]
  v_exp_f32 v99, v99
  v_mfma_f32_16x16x32_bf16 v[184:187], v[92:95], v[72:75], v[184:187]
  v_add_f32 v96, 1.0, v96
  v_mfma_f32_16x16x32_bf16 v[188:191], v[92:95], v[76:79], v[188:191]
  v_add_f32 v97, 1.0, v97
  s_waitcnt lgkmcnt(0)
  v_mfma_f32_16x16x32_bf16 v[128:131], v[48:51], v[32:35], v[128:131]
  ds_read_b64_tr_b16 v[80:81], v4 offset:24576
  ds_read_b64_tr_b16 v[82:83], v4 offset:25600
  v_add_f32 v98, 1.0, v98
  v_add_f32 v99, 1.0, v99
  v_mfma_f32_16x16x32_bf16 v[132:135], v[48:51], v[36:39], v[132:135]
  ds_read_b128 v[64:67], v3 offset:0
  v_rcp_f32 v96, v96
  v_mfma_f32_16x16x32_bf16 v[136:139], v[48:51], v[40:43], v[136:139]
  ds_read_b128 v[68:71], v3 offset:2048
  v_rcp_f32 v97, v97
  v_mfma_f32_16x16x32_bf16 v[140:143], v[48:51], v[44:47], v[140:143]
  ds_read_b64_tr_b16 v[84:85], v5 offset:24576
  v_rcp_f32 v98, v98
  v_mfma_f32_16x16x32_bf16 v[144:147], v[52:55], v[32:35], v[144:147]
  ds_read_b64_tr_b16 v[86:87], v5 offset:25600
  v_rcp_f32 v99, v99
  v_mfma_f32_16x16x32_bf16 v[148:151], v[52:55], v[36:39], v[148:151]
  ds_read_b128 v[72:75], v3 offset:4096
  v_mul_f32 v232, v232, v96
  v_mul_f32 v233, v233, v97
  v_mfma_f32_16x16x32_bf16 v[152:155], v[52:55], v[40:43], v[152:155]
  ds_read_b64_tr_b16 v[88:89], v6 offset:24576
  v_mul_f32 v234, v234, v98
  v_mfma_f32_16x16x32_bf16 v[156:159], v[52:55], v[44:47], v[156:159]
  ds_read_b64_tr_b16 v[90:91], v6 offset:25600
  v_mul_f32 v235, v235, v99
  v_mfma_f32_16x16x32_bf16 v[160:163], v[56:59], v[32:35], v[160:163]
  ds_read_b128 v[76:79], v3 offset:6144
  v_mul_f32 v100, v236, v236
  v_mfma_f32_16x16x32_bf16 v[164:167], v[56:59], v[36:39], v[164:167]
  ds_read_b64_tr_b16 v[92:93], v7 offset:24576
  v_mul_f32 v101, v237, v237
  v_mfma_f32_16x16x32_bf16 v[168:171], v[56:59], v[40:43], v[168:171]
  ds_read_b64_tr_b16 v[94:95], v7 offset:25600
  v_mul_f32 v102, v238, v238
  v_mul_f32 v103, v239, v239
  v_mfma_f32_16x16x32_bf16 v[172:175], v[56:59], v[44:47], v[172:175]
  v_fma_f32 v100, v100, s36, v104
  v_mfma_f32_16x16x32_bf16 v[176:179], v[60:63], v[32:35], v[176:179]
  v_fma_f32 v101, v101, s36, v104
  v_mfma_f32_16x16x32_bf16 v[180:183], v[60:63], v[36:39], v[180:183]
  v_fma_f32 v102, v102, s36, v104
  v_mfma_f32_16x16x32_bf16 v[184:187], v[60:63], v[40:43], v[184:187]
  v_fma_f32 v103, v103, s36, v104
  v_mfma_f32_16x16x32_bf16 v[188:191], v[60:63], v[44:47], v[188:191]
  v_mul_f32 v100, v100, v236
  s_waitcnt lgkmcnt(0)
  s_barrier
  v_mfma_f32_16x16x32_bf16 v[128:131], v[80:83], v[64:67], v[128:131]
  ds_read_b64_tr_b16 v[48:49], v4 offset:49152
  ds_read_b64_tr_b16 v[50:51], v4 offset:50176
  v_mul_f32 v101, v101, v237
  v_mul_f32 v102, v102, v238
  v_mfma_f32_16x16x32_bf16 v[132:135], v[80:83], v[68:71], v[132:135]
  ds_read_b128 v[32:35], v2 offset:32768
  v_mul_f32 v103, v103, v239
  v_mfma_f32_16x16x32_bf16 v[136:139], v[80:83], v[72:75], v[136:139]
  ds_read_b128 v[36:39], v2 offset:34816
  v_exp_f32 v100, v100
  v_mfma_f32_16x16x32_bf16 v[140:143], v[80:83], v[76:79], v[140:143]
  ds_read_b64_tr_b16 v[52:53], v5 offset:49152
  v_exp_f32 v101, v101
  v_mfma_f32_16x16x32_bf16 v[144:147], v[84:87], v[64:67], v[144:147]
  ds_read_b64_tr_b16 v[54:55], v5 offset:50176
  v_exp_f32 v102, v102
  v_mfma_f32_16x16x32_bf16 v[148:151], v[84:87], v[68:71], v[148:151]
  ds_read_b128 v[40:43], v2 offset:36864
  v_exp_f32 v103, v103
  v_add_f32 v100, 1.0, v100
  v_mfma_f32_16x16x32_bf16 v[152:155], v[84:87], v[72:75], v[152:155]
  ds_read_b64_tr_b16 v[56:57], v6 offset:49152
  v_add_f32 v101, 1.0, v101
  v_mfma_f32_16x16x32_bf16 v[156:159], v[84:87], v[76:79], v[156:159]
  ds_read_b64_tr_b16 v[58:59], v6 offset:50176
  v_add_f32 v102, 1.0, v102
  v_mfma_f32_16x16x32_bf16 v[160:163], v[88:91], v[64:67], v[160:163]
  ds_read_b128 v[44:47], v2 offset:38912
  v_add_f32 v103, 1.0, v103
  v_mfma_f32_16x16x32_bf16 v[164:167], v[88:91], v[68:71], v[164:167]
  ds_read_b64_tr_b16 v[60:61], v7 offset:49152
  v_rcp_f32 v100, v100
  v_mfma_f32_16x16x32_bf16 v[168:171], v[88:91], v[72:75], v[168:171]
  ds_read_b64_tr_b16 v[62:63], v7 offset:50176
  v_rcp_f32 v101, v101
  v_rcp_f32 v102, v102
  v_mfma_f32_16x16x32_bf16 v[172:175], v[88:91], v[76:79], v[172:175]
  v_rcp_f32 v103, v103
  v_mfma_f32_16x16x32_bf16 v[176:179], v[92:95], v[64:67], v[176:179]
  v_mul_f32 v236, v236, v100
  v_mfma_f32_16x16x32_bf16 v[180:183], v[92:95], v[68:71], v[180:183]
  v_mul_f32 v237, v237, v101
  v_mfma_f32_16x16x32_bf16 v[184:187], v[92:95], v[72:75], v[184:187]
  v_mul_f32 v238, v238, v102
  v_mfma_f32_16x16x32_bf16 v[188:191], v[92:95], v[76:79], v[188:191]
  v_mul_f32 v239, v239, v103
  s_waitcnt lgkmcnt(0)
  v_mfma_f32_16x16x32_bf16 v[128:131], v[48:51], v[32:35], v[128:131]
  ds_read_b64_tr_b16 v[80:81], v4 offset:57344
  ds_read_b64_tr_b16 v[82:83], v4 offset:58368
  v_mul_f32 v96, v240, v240
  v_mul_f32 v97, v241, v241
  v_mfma_f32_16x16x32_bf16 v[132:135], v[48:51], v[36:39], v[132:135]
  ds_read_b128 v[64:67], v3 offset:32768
  v_mul_f32 v98, v242, v242
  v_mfma_f32_16x16x32_bf16 v[136:139], v[48:51], v[40:43], v[136:139]
  ds_read_b128 v[68:71], v3 offset:34816
  v_mul_f32 v99, v243, v243
  v_mfma_f32_16x16x32_bf16 v[140:143], v[48:51], v[44:47], v[140:143]
  ds_read_b64_tr_b16 v[84:85], v5 offset:57344
  v_fma_f32 v96, v96, s36, v104
  v_mfma_f32_16x16x32_bf16 v[144:147], v[52:55], v[32:35], v[144:147]
  ds_read_b64_tr_b16 v[86:87], v5 offset:58368
  v_fma_f32 v97, v97, s36, v104
  v_mfma_f32_16x16x32_bf16 v[148:151], v[52:55], v[36:39], v[148:151]
  ds_read_b128 v[72:75], v3 offset:36864
  v_fma_f32 v98, v98, s36, v104
  v_mfma_f32_16x16x32_bf16 v[152:155], v[52:55], v[40:43], v[152:155]
  ds_read_b64_tr_b16 v[88:89], v6 offset:57344
  v_fma_f32 v99, v99, s36, v104
  v_mfma_f32_16x16x32_bf16 v[156:159], v[52:55], v[44:47], v[156:159]
  ds_read_b64_tr_b16 v[90:91], v6 offset:58368
  v_mul_f32 v96, v96, v240
  v_mfma_f32_16x16x32_bf16 v[160:163], v[56:59], v[32:35], v[160:163]
  ds_read_b128 v[76:79], v3 offset:38912
  v_mul_f32 v97, v97, v241
  v_mul_f32 v98, v98, v242
  v_mfma_f32_16x16x32_bf16 v[164:167], v[56:59], v[36:39], v[164:167]
  ds_read_b64_tr_b16 v[92:93], v7 offset:57344
  v_mul_f32 v99, v99, v243
  v_mfma_f32_16x16x32_bf16 v[168:171], v[56:59], v[40:43], v[168:171]
  ds_read_b64_tr_b16 v[94:95], v7 offset:58368
  v_exp_f32 v96, v96
  v_mfma_f32_16x16x32_bf16 v[172:175], v[56:59], v[44:47], v[172:175]
  v_exp_f32 v97, v97
  v_mfma_f32_16x16x32_bf16 v[176:179], v[60:63], v[32:35], v[176:179]
  v_exp_f32 v98, v98
  v_mfma_f32_16x16x32_bf16 v[180:183], v[60:63], v[36:39], v[180:183]
  v_exp_f32 v99, v99
  v_mfma_f32_16x16x32_bf16 v[184:187], v[60:63], v[40:43], v[184:187]
  v_add_f32 v96, 1.0, v96
  v_mfma_f32_16x16x32_bf16 v[188:191], v[60:63], v[44:47], v[188:191]
  v_add_f32 v97, 1.0, v97
  s_waitcnt lgkmcnt(0)
  s_barrier
  v_mfma_f32_16x16x32_bf16 v[128:131], v[80:83], v[64:67], v[128:131]
  ds_read_b64_tr_b16 v[48:49], v22 offset:16384
  ds_read_b64_tr_b16 v[50:51], v22 offset:17408
  v_add_f32 v98, 1.0, v98
  v_add_f32 v99, 1.0, v99
  v_mfma_f32_16x16x32_bf16 v[132:135], v[80:83], v[68:71], v[132:135]
  ds_read_b128 v[32:35], v20 offset:0
  v_rcp_f32 v96, v96
  v_mfma_f32_16x16x32_bf16 v[136:139], v[80:83], v[72:75], v[136:139]
  ds_read_b128 v[36:39], v20 offset:2048
  v_rcp_f32 v97, v97
  v_mfma_f32_16x16x32_bf16 v[140:143], v[80:83], v[76:79], v[140:143]
  ds_read_b64_tr_b16 v[52:53], v23 offset:16384
  v_rcp_f32 v98, v98
  v_mfma_f32_16x16x32_bf16 v[144:147], v[84:87], v[64:67], v[144:147]
  ds_read_b64_tr_b16 v[54:55], v23 offset:17408
  v_rcp_f32 v99, v99
  v_mfma_f32_16x16x32_bf16 v[148:151], v[84:87], v[68:71], v[148:151]
  ds_read_b128 v[40:43], v20 offset:4096
  v_mul_f32 v240, v240, v96
  v_mul_f32 v241, v241, v97
  v_mfma_f32_16x16x32_bf16 v[152:155], v[84:87], v[72:75], v[152:155]
  ds_read_b64_tr_b16 v[56:57], v24 offset:16384
  v_mul_f32 v242, v242, v98
  v_mfma_f32_16x16x32_bf16 v[156:159], v[84:87], v[76:79], v[156:159]
  ds_read_b64_tr_b16 v[58:59], v24 offset:17408
  v_mul_f32 v243, v243, v99
  v_mfma_f32_16x16x32_bf16 v[160:163], v[88:91], v[64:67], v[160:163]
  ds_read_b128 v[44:47], v20 offset:6144
  v_mul_f32 v100, v244, v244
  v_mfma_f32_16x16x32_bf16 v[164:167], v[88:91], v[68:71], v[164:167]
  ds_read_b64_tr_b16 v[60:61], v25 offset:16384
  v_mul_f32 v101, v245, v245
  v_mfma_f32_16x16x32_bf16 v[168:171], v[88:91], v[72:75], v[168:171]
  ds_read_b64_tr_b16 v[62:63], v25 offset:17408
  v_mul_f32 v102, v246, v246
  v_mul_f32 v103, v247, v247
  v_mfma_f32_16x16x32_bf16 v[172:175], v[88:91], v[76:79], v[172:175]
  v_fma_f32 v100, v100, s36, v104
  v_mfma_f32_16x16x32_bf16 v[176:179], v[92:95], v[64:67], v[176:179]
  v_fma_f32 v101, v101, s36, v104
  v_mfma_f32_16x16x32_bf16 v[180:183], v[92:95], v[68:71], v[180:183]
  v_fma_f32 v102, v102, s36, v104
  v_mfma_f32_16x16x32_bf16 v[184:187], v[92:95], v[72:75], v[184:187]
  v_fma_f32 v103, v103, s36, v104
  v_mfma_f32_16x16x32_bf16 v[188:191], v[92:95], v[76:79], v[188:191]
  v_mul_f32 v100, v100, v244
  s_waitcnt lgkmcnt(0)
  v_mfma_f32_16x16x32_bf16 v[128:131], v[48:51], v[32:35], v[128:131]
  ds_read_b64_tr_b16 v[80:81], v22 offset:24576
  ds_read_b64_tr_b16 v[82:83], v22 offset:25600
  v_mul_f32 v101, v101, v245
  v_mul_f32 v102, v102, v246
  v_mfma_f32_16x16x32_bf16 v[132:135], v[48:51], v[36:39], v[132:135]
  ds_read_b128 v[64:67], v21 offset:0
  v_mul_f32 v103, v103, v247
  v_mfma_f32_16x16x32_bf16 v[136:139], v[48:51], v[40:43], v[136:139]
  ds_read_b128 v[68:71], v21 offset:2048
  v_exp_f32 v100, v100
  v_mfma_f32_16x16x32_bf16 v[140:143], v[48:51], v[44:47], v[140:143]
  ds_read_b64_tr_b16 v[84:85], v23 offset:24576
  v_exp_f32 v101, v101
  v_mfma_f32_16x16x32_bf16 v[144:147], v[52:55], v[32:35], v[144:147]
  ds_read_b64_tr_b16 v[86:87], v23 offset:25600
  v_exp_f32 v102, v102
  v_mfma_f32_16x16x32_bf16 v[148:151], v[52:55], v[36:39], v[148:151]
  ds_read_b128 v[72:75], v21 offset:4096
  v_exp_f32 v103, v103
  v_add_f32 v100, 1.0, v100
  v_mfma_f32_16x16x32_bf16 v[152:155], v[52:55], v[40:43], v[152:155]
  ds_read_b64_tr_b16 v[88:89], v24 offset:24576
  v_add_f32 v101, 1.0, v101
  v_mfma_f32_16x16x32_bf16 v[156:159], v[52:55], v[44:47], v[156:159]
  ds_read_b64_tr_b16 v[90:91], v24 offset:25600
  v_add_f32 v102, 1.0, v102
  v_mfma_f32_16x16x32_bf16 v[160:163], v[56:59], v[32:35], v[160:163]
  ds_read_b128 v[76:79], v21 offset:6144
  v_add_f32 v103, 1.0, v103
  v_mfma_f32_16x16x32_bf16 v[164:167], v[56:59], v[36:39], v[164:167]
  ds_read_b64_tr_b16 v[92:93], v25 offset:24576
  v_rcp_f32 v100, v100
  v_mfma_f32_16x16x32_bf16 v[168:171], v[56:59], v[40:43], v[168:171]
  ds_read_b64_tr_b16 v[94:95], v25 offset:25600
  v_rcp_f32 v101, v101
  v_rcp_f32 v102, v102
  v_mfma_f32_16x16x32_bf16 v[172:175], v[56:59], v[44:47], v[172:175]
  v_rcp_f32 v103, v103
  v_mfma_f32_16x16x32_bf16 v[176:179], v[60:63], v[32:35], v[176:179]
  v_mul_f32 v244, v244, v100
  v_mfma_f32_16x16x32_bf16 v[180:183], v[60:63], v[36:39], v[180:183]
  v_mul_f32 v245, v245, v101
  v_mfma_f32_16x16x32_bf16 v[184:187], v[60:63], v[40:43], v[184:187]
  v_mul_f32 v246, v246, v102
  v_mfma_f32_16x16x32_bf16 v[188:191], v[60:63], v[44:47], v[188:191]
  v_mul_f32 v247, v247, v103
  s_waitcnt lgkmcnt(0)
  s_barrier
  v_mfma_f32_16x16x32_bf16 v[128:131], v[80:83], v[64:67], v[128:131]
  ds_read_b64_tr_b16 v[48:49], v22 offset:49152
  ds_read_b64_tr_b16 v[50:51], v22 offset:50176
  v_mul_f32 v96, v248, v248
  v_mul_f32 v97, v249, v249
  v_mfma_f32_16x16x32_bf16 v[132:135], v[80:83], v[68:71], v[132:135]
  ds_read_b128 v[32:35], v20 offset:32768
  v_mul_f32 v98, v250, v250
  v_mfma_f32_16x16x32_bf16 v[136:139], v[80:83], v[72:75], v[136:139]
  ds_read_b128 v[36:39], v20 offset:34816
  v_mul_f32 v99, v251, v251
  v_mfma_f32_16x16x32_bf16 v[140:143], v[80:83], v[76:79], v[140:143]
  ds_read_b64_tr_b16 v[52:53], v23 offset:49152
  v_fma_f32 v96, v96, s36, v104
  v_mfma_f32_16x16x32_bf16 v[144:147], v[84:87], v[64:67], v[144:147]
  ds_read_b64_tr_b16 v[54:55], v23 offset:50176
  v_fma_f32 v97, v97, s36, v104
  v_mfma_f32_16x16x32_bf16 v[148:151], v[84:87], v[68:71], v[148:151]
  ds_read_b128 v[40:43], v20 offset:36864
  v_fma_f32 v98, v98, s36, v104
  v_mfma_f32_16x16x32_bf16 v[152:155], v[84:87], v[72:75], v[152:155]
  ds_read_b64_tr_b16 v[56:57], v24 offset:49152
  v_fma_f32 v99, v99, s36, v104
  v_mfma_f32_16x16x32_bf16 v[156:159], v[84:87], v[76:79], v[156:159]
  ds_read_b64_tr_b16 v[58:59], v24 offset:50176
  v_mul_f32 v96, v96, v248
  v_mfma_f32_16x16x32_bf16 v[160:163], v[88:91], v[64:67], v[160:163]
  ds_read_b128 v[44:47], v20 offset:38912
  v_mul_f32 v97, v97, v249
  v_mul_f32 v98, v98, v250
  v_mfma_f32_16x16x32_bf16 v[164:167], v[88:91], v[68:71], v[164:167]
  ds_read_b64_tr_b16 v[60:61], v25 offset:49152
  v_mul_f32 v99, v99, v251
  v_mfma_f32_16x16x32_bf16 v[168:171], v[88:91], v[72:75], v[168:171]
  ds_read_b64_tr_b16 v[62:63], v25 offset:50176
  v_exp_f32 v96, v96
  v_mfma_f32_16x16x32_bf16 v[172:175], v[88:91], v[76:79], v[172:175]
  v_exp_f32 v97, v97
  v_mfma_f32_16x16x32_bf16 v[176:179], v[92:95], v[64:67], v[176:179]
  v_exp_f32 v98, v98
  v_mfma_f32_16x16x32_bf16 v[180:183], v[92:95], v[68:71], v[180:183]
  v_exp_f32 v99, v99
  v_mfma_f32_16x16x32_bf16 v[184:187], v[92:95], v[72:75], v[184:187]
  v_add_f32 v96, 1.0, v96
  v_mfma_f32_16x16x32_bf16 v[188:191], v[92:95], v[76:79], v[188:191]
  v_add_f32 v97, 1.0, v97
  s_waitcnt lgkmcnt(0)
  v_mfma_f32_16x16x32_bf16 v[128:131], v[48:51], v[32:35], v[128:131]
  ds_read_b64_tr_b16 v[80:81], v22 offset:57344
  ds_read_b64_tr_b16 v[82:83], v22 offset:58368
  v_add_f32 v98, 1.0, v98
  v_add_f32 v99, 1.0, v99
  v_mfma_f32_16x16x32_bf16 v[132:135], v[48:51], v[36:39], v[132:135]
  ds_read_b128 v[64:67], v21 offset:32768
  v_rcp_f32 v96, v96
  v_mfma_f32_16x16x32_bf16 v[136:139], v[48:51], v[40:43], v[136:139]
  ds_read_b128 v[68:71], v21 offset:34816
  v_rcp_f32 v97, v97
  v_mfma_f32_16x16x32_bf16 v[140:143], v[48:51], v[44:47], v[140:143]
  ds_read_b64_tr_b16 v[84:85], v23 offset:57344
  v_rcp_f32 v98, v98
  v_mfma_f32_16x16x32_bf16 v[144:147], v[52:55], v[32:35], v[144:147]
  ds_read_b64_tr_b16 v[86:87], v23 offset:58368
  v_rcp_f32 v99, v99
  v_mfma_f32_16x16x32_bf16 v[148:151], v[52:55], v[36:39], v[148:151]
  ds_read_b128 v[72:75], v21 offset:36864
  v_mul_f32 v248, v248, v96
  v_mul_f32 v249, v249, v97
  v_mfma_f32_16x16x32_bf16 v[152:155], v[52:55], v[40:43], v[152:155]
  ds_read_b64_tr_b16 v[88:89], v24 offset:57344
  v_mul_f32 v250, v250, v98
  v_mfma_f32_16x16x32_bf16 v[156:159], v[52:55], v[44:47], v[156:159]
  ds_read_b64_tr_b16 v[90:91], v24 offset:58368
  v_mul_f32 v251, v251, v99
  v_mfma_f32_16x16x32_bf16 v[160:163], v[56:59], v[32:35], v[160:163]
  ds_read_b128 v[76:79], v21 offset:38912
  v_mul_f32 v100, v252, v252
  v_mfma_f32_16x16x32_bf16 v[164:167], v[56:59], v[36:39], v[164:167]
  ds_read_b64_tr_b16 v[92:93], v25 offset:57344
  v_mul_f32 v101, v253, v253
  v_mfma_f32_16x16x32_bf16 v[168:171], v[56:59], v[40:43], v[168:171]
  ds_read_b64_tr_b16 v[94:95], v25 offset:58368
  v_mul_f32 v102, v254, v254
  v_mul_f32 v103, v255, v255
  v_mfma_f32_16x16x32_bf16 v[172:175], v[56:59], v[44:47], v[172:175]
  v_fma_f32 v100, v100, s36, v104
  v_mfma_f32_16x16x32_bf16 v[176:179], v[60:63], v[32:35], v[176:179]
  v_fma_f32 v101, v101, s36, v104
  v_mfma_f32_16x16x32_bf16 v[180:183], v[60:63], v[36:39], v[180:183]
  v_fma_f32 v102, v102, s36, v104
  v_mfma_f32_16x16x32_bf16 v[184:187], v[60:63], v[40:43], v[184:187]
  v_fma_f32 v103, v103, s36, v104
  v_mfma_f32_16x16x32_bf16 v[188:191], v[60:63], v[44:47], v[188:191]
  v_mul_f32 v100, v100, v252
  s_waitcnt lgkmcnt(0)
  s_barrier
  v_mfma_f32_16x16x32_bf16 v[128:131], v[80:83], v[64:67], v[128:131]
  ds_read_b64_tr_b16 v[48:49], v4 offset:16384
  ds_read_b64_tr_b16 v[50:51], v4 offset:17408
  v_mul_f32 v101, v101, v253
  v_mul_f32 v102, v102, v254
  v_mfma_f32_16x16x32_bf16 v[132:135], v[80:83], v[68:71], v[132:135]
  ds_read_b128 v[32:35], v2 offset:0
  v_mul_f32 v103, v103, v255
  v_mfma_f32_16x16x32_bf16 v[136:139], v[80:83], v[72:75], v[136:139]
  ds_read_b128 v[36:39], v2 offset:2048
  v_exp_f32 v100, v100
  v_mfma_f32_16x16x32_bf16 v[140:143], v[80:83], v[76:79], v[140:143]
  ds_read_b64_tr_b16 v[52:53], v5 offset:16384
  v_exp_f32 v101, v101
  v_mfma_f32_16x16x32_bf16 v[144:147], v[84:87], v[64:67], v[144:147]
  ds_read_b64_tr_b16 v[54:55], v5 offset:17408
  v_exp_f32 v102, v102
  v_mfma_f32_16x16x32_bf16 v[148:151], v[84:87], v[68:71], v[148:151]
  ds_read_b128 v[40:43], v2 offset:4096
  v_exp_f32 v103, v103
  v_add_f32 v100, 1.0, v100
  v_mfma_f32_16x16x32_bf16 v[152:155], v[84:87], v[72:75], v[152:155]
  ds_read_b64_tr_b16 v[56:57], v6 offset:16384
  v_add_f32 v101, 1.0, v101
  v_mfma_f32_16x16x32_bf16 v[156:159], v[84:87], v[76:79], v[156:159]
  ds_read_b64_tr_b16 v[58:59], v6 offset:17408
  v_add_f32 v102, 1.0, v102
  v_mfma_f32_16x16x32_bf16 v[160:163], v[88:91], v[64:67], v[160:163]
  ds_read_b128 v[44:47], v2 offset:6144
  v_add_f32 v103, 1.0, v103
  v_mfma_f32_16x16x32_bf16 v[164:167], v[88:91], v[68:71], v[164:167]
  ds_read_b64_tr_b16 v[60:61], v7 offset:16384
  v_rcp_f32 v100, v100
  v_mfma_f32_16x16x32_bf16 v[168:171], v[88:91], v[72:75], v[168:171]
  ds_read_b64_tr_b16 v[62:63], v7 offset:17408
  v_rcp_f32 v101, v101
  v_rcp_f32 v102, v102
  v_mfma_f32_16x16x32_bf16 v[172:175], v[88:91], v[76:79], v[172:175]
  v_rcp_f32 v103, v103
  v_mfma_f32_16x16x32_bf16 v[176:179], v[92:95], v[64:67], v[176:179]
  v_mul_f32 v252, v252, v100
  v_mfma_f32_16x16x32_bf16 v[180:183], v[92:95], v[68:71], v[180:183]
  v_mul_f32 v253, v253, v101
  v_mfma_f32_16x16x32_bf16 v[184:187], v[92:95], v[72:75], v[184:187]
  v_mul_f32 v254, v254, v102
  v_mfma_f32_16x16x32_bf16 v[188:191], v[92:95], v[76:79], v[188:191]
  v_mul_f32 v255, v255, v103
  s_mov_b32 s48, s82
  s_mov_b32 s49, s83
  s_mov_b32 s50, 0x380000
  s_mov_b32 s51, 0x20000
  s_mul_i32 s37, s3, 28
  s_add_u32 s37, s37, s4
  s_lshl_b32 s37, s37, 2
  s_add_u32 s37, s37, s26
  s_lshl_b32 s37, s37, 12
  v_lshlrev_b32 v109, 4, v0
  buffer_load_dwordx4 v[120:123], v109, s[48:51], s37 offen offset:0
  buffer_load_dwordx4 v[120:123], v109, s[48:51], s37 offen offset:1024
  buffer_load_dwordx4 v[120:123], v109, s[48:51], s37 offen offset:2048
  buffer_load_dwordx4 v[120:123], v109, s[48:51], s37 offen offset:3072
  s_mov_b32 s35, 10
  s_swappc_b64 s[62:63], s[58:59]
  s_mul_i32 s37, s24, 28
  s_lshl_b32 s40, s25, 1
  s_add_u32 s37, s37, s40
  s_add_u32 s37, s37, s28
  s_lshl_b32 s37, s37, 14
  s_lshl_b32 s40, s27, 13
  s_add_u32 s37, s37, s40
  s_add_u32 s37, s37, 16777216
  s_add_u32 s40, s37, 4096
  v_and_b32 v16, 15, v0
  v_and_b32 v17, 1, v15
  v_lshlrev_b32 v17, 1, v17
  v_lshrrev_b32 v18, 1, v15
  v_add_u32 v17, v17, v18
  v_lshlrev_b32 v16, 4, v16
  v_lshl_add_u32 v16, v17, 8, v16
  s_waitcnt lgkmcnt(0)
  v_pk_mul_f32 v[128:129], v[128:129], v[192:193]
  v_pk_mul_f32 v[130:131], v[130:131], v[194:195]
  v_pk_mul_f32 v[144:145], v[144:145], v[208:209]
  v_pk_mul_f32 v[146:147], v[146:147], v[210:211]
  v_cvt_pk_bf16_f32 v32, v128, v129
  v_cvt_pk_bf16_f32 v33, v130, v131
  v_cvt_pk_bf16_f32 v34, v144, v145
  v_cvt_pk_bf16_f32 v35, v146, v147
  s_nop 1
  v_permlane16_swap_b32 v32, v34
  v_permlane16_swap_b32 v33, v35
  buffer_store_dwordx4 v[32:35], v16, s[16:19], s37 offen offset:0 sc1
  v_pk_mul_f32 v[160:161], v[160:161], v[224:225]
  v_pk_mul_f32 v[162:163], v[162:163], v[226:227]
  v_pk_mul_f32 v[176:177], v[176:177], v[240:241]
  v_pk_mul_f32 v[178:179], v[178:179], v[242:243]
  v_cvt_pk_bf16_f32 v36, v160, v161
  v_cvt_pk_bf16_f32 v37, v162, v163
  v_cvt_pk_bf16_f32 v38, v176, v177
  v_cvt_pk_bf16_f32 v39, v178, v179
  s_nop 1
  v_permlane16_swap_b32 v36, v38
  v_permlane16_swap_b32 v37, v39
  buffer_store_dwordx4 v[36:39], v16, s[16:19], s37 offen offset:2048 sc1
  v_pk_mul_f32 v[132:133], v[132:133], v[196:197]
  v_pk_mul_f32 v[134:135], v[134:135], v[198:199]
  v_pk_mul_f32 v[148:149], v[148:149], v[212:213]
  v_pk_mul_f32 v[150:151], v[150:151], v[214:215]
  v_cvt_pk_bf16_f32 v40, v132, v133
  v_cvt_pk_bf16_f32 v41, v134, v135
  v_cvt_pk_bf16_f32 v42, v148, v149
  v_cvt_pk_bf16_f32 v43, v150, v151
  s_nop 1
  v_permlane16_swap_b32 v40, v42
  v_permlane16_swap_b32 v41, v43
  buffer_store_dwordx4 v[40:43], v16, s[16:19], s37 offen offset:1024 sc1
  v_pk_mul_f32 v[164:165], v[164:165], v[228:229]
  v_pk_mul_f32 v[166:167], v[166:167], v[230:231]
  v_pk_mul_f32 v[180:181], v[180:181], v[244:245]
  v_pk_mul_f32 v[182:183], v[182:183], v[246:247]
  v_cvt_pk_bf16_f32 v44, v164, v165
  v_cvt_pk_bf16_f32 v45, v166, v167
  v_cvt_pk_bf16_f32 v46, v180, v181
  v_cvt_pk_bf16_f32 v47, v182, v183
  s_nop 1
  v_permlane16_swap_b32 v44, v46
  v_permlane16_swap_b32 v45, v47
  buffer_store_dwordx4 v[44:47], v16, s[16:19], s37 offen offset:3072 sc1
  v_pk_mul_f32 v[136:137], v[136:137], v[200:201]
  v_pk_mul_f32 v[138:139], v[138:139], v[202:203]
  v_pk_mul_f32 v[152:153], v[152:153], v[216:217]
  v_pk_mul_f32 v[154:155], v[154:155], v[218:219]
  v_cvt_pk_bf16_f32 v48, v136, v137
  v_cvt_pk_bf16_f32 v49, v138, v139
  v_cvt_pk_bf16_f32 v50, v152, v153
  v_cvt_pk_bf16_f32 v51, v154, v155
  s_nop 1
  v_permlane16_swap_b32 v48, v50
  v_permlane16_swap_b32 v49, v51
  buffer_store_dwordx4 v[48:51], v16, s[16:19], s40 offen offset:0 sc1
  v_pk_mul_f32 v[168:169], v[168:169], v[232:233]
  v_pk_mul_f32 v[170:171], v[170:171], v[234:235]
  v_pk_mul_f32 v[184:185], v[184:185], v[248:249]
  v_pk_mul_f32 v[186:187], v[186:187], v[250:251]
  v_cvt_pk_bf16_f32 v52, v168, v169
  v_cvt_pk_bf16_f32 v53, v170, v171
  v_cvt_pk_bf16_f32 v54, v184, v185
  v_cvt_pk_bf16_f32 v55, v186, v187
  s_nop 1
  v_permlane16_swap_b32 v52, v54
  v_permlane16_swap_b32 v53, v55
  buffer_store_dwordx4 v[52:55], v16, s[16:19], s40 offen offset:2048 sc1
  v_pk_mul_f32 v[140:141], v[140:141], v[204:205]
  v_pk_mul_f32 v[142:143], v[142:143], v[206:207]
  v_pk_mul_f32 v[156:157], v[156:157], v[220:221]
  v_pk_mul_f32 v[158:159], v[158:159], v[222:223]
  v_cvt_pk_bf16_f32 v56, v140, v141
  v_cvt_pk_bf16_f32 v57, v142, v143
  v_cvt_pk_bf16_f32 v58, v156, v157
  v_cvt_pk_bf16_f32 v59, v158, v159
  s_nop 1
  v_permlane16_swap_b32 v56, v58
  v_permlane16_swap_b32 v57, v59
  buffer_store_dwordx4 v[56:59], v16, s[16:19], s40 offen offset:1024 sc1
  v_pk_mul_f32 v[172:173], v[172:173], v[236:237]
  v_pk_mul_f32 v[174:175], v[174:175], v[238:239]
  v_pk_mul_f32 v[188:189], v[188:189], v[252:253]
  v_pk_mul_f32 v[190:191], v[190:191], v[254:255]
  v_cvt_pk_bf16_f32 v60, v172, v173
  v_cvt_pk_bf16_f32 v61, v174, v175
  v_cvt_pk_bf16_f32 v62, v188, v189
  v_cvt_pk_bf16_f32 v63, v190, v191
  s_nop 1
  v_permlane16_swap_b32 v60, v62
  v_permlane16_swap_b32 v61, v63
  buffer_store_dwordx4 v[60:63], v16, s[16:19], s40 offen offset:3072 sc1
  v_mov_b32 v96, 155664
  v_mov_b32 v97, 1
  s_mov_b64 exec, 1
  ds_add_u32 v96, v97
  s_mov_b64 exec, -1
  s_lshl_b32 s40, s24, 4
  s_add_u32 s40, s40, s25
  s_lshl_b32 s40, s40, 6
  s_add_u32 s40, s40, 31997952
  v_mov_b32 v96, s92
  v_mov_b32 v97, s93
  v_mov_b32 v98, s92
  v_mov_b32 v99, s93
  v_mov_b32 v100, 155652
  v_mov_b32 v101, 1
  s_mov_b64 exec, 1
  s_waitcnt vmcnt(0)
  ds_add_rtn_u32 v101, v100, v101
  s_mov_b64 exec, 15
  v_lshlrev_b32 v100, 4, v0
  s_waitcnt lgkmcnt(0)
  v_readfirstlane_b32 s36, v101
  s_cmp_lg_u32 s36, 3
  s_cbranch_scc1 L1_sf_15
  buffer_store_dwordx4 v[96:99], v100, s[16:19], s40 offen sc1
L1_sf_15:
  s_mov_b64 exec, -1
L4_cons:
  s_lshr_b32 s6, s3, 1
  s_lshl_b32 s6, s6, 2
  s_lshr_b32 s37, s4, 3
  s_add_u32 s6, s6, s37
  s_and_b32 s7, s3, 1
  s_lshl_b32 s7, s7, 3
  s_and_b32 s37, s4, 7
  s_add_u32 s7, s7, s37
  s_mov_b32 s44, s86
  s_mov_b32 s45, s87
  s_mov_b32 s46, 0x400000
  s_mov_b32 s47, 0x20000
  v_bfe_u32 v16, v0, 2, 2
  v_lshl_add_u32 v17, v15, 3, v16
  v_lshlrev_b32 v17, 7, v17
  v_and_b32 v18, 3, v0
  v_lshl_add_u32 v17, v18, 3, v17
  v_lshrrev_b32 v16, 1, v16
  v_and_b32 v18, 1, v15
  v_lshl_add_u32 v16, v18, 1, v16
  v_lshl_add_u32 v2, v16, 5, v17
  v_xor_b32 v3, 32, v2
  v_xor_b32 v4, 64, v2
  v_xor_b32 v5, 96, v2
  v_add_u32 v6, 57344, v2
  v_add_u32 v7, 57344, v3
  v_add_u32 v8, 57344, v4
  v_add_u32 v9, 57344, v5
  s_lshl_b32 s40, s26, 12
  v_lshlrev_b32 v10, 4, v0
  v_add_u32 v10, s40, v10
  s_mul_i32 s33, s6, 458752
  s_add_u32 s33, s33, 16777216
  s_mov_b32 s41, 28
  s_lshl_b32 s40, s26, 5
  v_add_u32 v16, s40, v11
  v_and_b32 v18, 1, v15
  v_lshlrev_b32 v18, 1, v18
  v_lshrrev_b32 v19, 1, v15
  v_add_u32 v18, v18, v19
  s_lshl_b32 s37, s6, 7
  v_add_u32 v24, s37, v16
  v_lshlrev_b32 v24, 11, v24
  v_lshl_add_u32 v24, v18, 4, v24
  s_lshl_b32 s40, s7, 7
  v_add_u32 v24, s40, v24
  v_sub_u32 v19, 3, v18
  s_cmp_ge_u32 s7, 8
  s_cselect_b64 vcc, -1, 0
  s_cselect_b32 s48, 1, 0
  v_cndmask_b32 v18, v18, v19, vcc
  v_mul_u32_u24 v25, 144, v16
  v_lshl_add_u32 v25, v18, 4, v25
  v_add_u32 v25, 131072, v25
  s_lshl_b32 s40, s26, 8
  s_add_u32 s40, s40, 151552
  v_lshlrev_b32 v26, 2, v11
  v_add_u32 v26, s40, v26
  s_and_b32 s32, s3, 1
  s_mul_i32 s32, s32, 14
  v_mov_b32 v208, 0
  v_mov_b32 v209, 0
  v_mov_b32 v210, 0
  v_mov_b32 v211, 0
  v_mov_b32 v212, 0
  v_mov_b32 v213, 0
  v_mov_b32 v214, 0
  v_mov_b32 v215, 0
  v_mov_b32 v216, 0
  v_mov_b32 v217, 0
  v_mov_b32 v218, 0
  v_mov_b32 v219, 0
  v_mov_b32 v220, 0
  v_mov_b32 v221, 0
  v_mov_b32 v222, 0
  v_mov_b32 v223, 0
  v_mov_b32 v224, 0
  v_mov_b32 v225, 0
  v_mov_b32 v226, 0
  v_mov_b32 v227, 0
  v_mov_b32 v228, 0
  v_mov_b32 v229, 0
  v_mov_b32 v230, 0
  v_mov_b32 v231, 0
  v_mov_b32 v232, 0
  v_mov_b32 v233, 0
  v_mov_b32 v234, 0
  v_mov_b32 v235, 0
  v_mov_b32 v236, 0
  v_mov_b32 v237, 0
  v_mov_b32 v238, 0
  v_mov_b32 v239, 0
  s_barrier
  s_lshl_b32 s34, s32, 14
  s_add_u32 s34, s34, s33
  s_sub_u32 s41, s41, 1
  s_cmp_lt_i32 s41, 0
  s_cmov_b32 s34, 0x7fff0000
  s_add_u32 s32, s32, 1
  s_cmp_eq_u32 s32, 28
  s_cselect_b32 s32, 0, s32
  buffer_load_dwordx4 v[32:35], v10, s[16:19], s34 offen offset:0 sc1
  buffer_load_dwordx4 v[36:39], v10, s[16:19], s34 offen offset:1024 sc1
  buffer_load_dwordx4 v[40:43], v10, s[16:19], s34 offen offset:2048 sc1
  buffer_load_dwordx4 v[44:47], v10, s[16:19], s34 offen offset:3072 sc1
  s_lshl_b32 s34, s32, 14
  s_add_u32 s34, s34, s33
  s_sub_u32 s41, s41, 1
  s_cmp_lt_i32 s41, 0
  s_cmov_b32 s34, 0x7fff0000
  s_add_u32 s32, s32, 1
  s_cmp_eq_u32 s32, 28
  s_cselect_b32 s32, 0, s32
  buffer_load_dwordx4 v[48:51], v10, s[16:19], s34 offen offset:0 sc1
  buffer_load_dwordx4 v[52:55], v10, s[16:19], s34 offen offset:1024 sc1
  buffer_load_dwordx4 v[56:59], v10, s[16:19], s34 offen offset:2048 sc1
  buffer_load_dwordx4 v[60:63], v10, s[16:19], s34 offen offset:3072 sc1
  s_lshl_b32 s34, s32, 14
  s_add_u32 s34, s34, s33
  s_sub_u32 s41, s41, 1
  s_cmp_lt_i32 s41, 0
  s_cmov_b32 s34, 0x7fff0000
  s_add_u32 s32, s32, 1
  s_cmp_eq_u32 s32, 28
  s_cselect_b32 s32, 0, s32
  buffer_load_dwordx4 v[64:67], v10, s[16:19], s34 offen offset:0 sc1
  buffer_load_dwordx4 v[68:71], v10, s[16:19], s34 offen offset:1024 sc1
  buffer_load_dwordx4 v[72:75], v10, s[16:19], s34 offen offset:2048 sc1
  buffer_load_dwordx4 v[76:79], v10, s[16:19], s34 offen offset:3072 sc1
  s_lshl_b32 s34, s32, 14
  s_add_u32 s34, s34, s33
  s_sub_u32 s41, s41, 1
  s_cmp_lt_i32 s41, 0
  s_cmov_b32 s34, 0x7fff0000
  s_add_u32 s32, s32, 1
  s_cmp_eq_u32 s32, 28
  s_cselect_b32 s32, 0, s32
  buffer_load_dwordx4 v[80:83], v10, s[16:19], s34 offen offset:0 sc1
  buffer_load_dwordx4 v[84:87], v10, s[16:19], s34 offen offset:1024 sc1
  buffer_load_dwordx4 v[88:91], v10, s[16:19], s34 offen offset:2048 sc1
  buffer_load_dwordx4 v[92:95], v10, s[16:19], s34 offen offset:3072 sc1
  s_lshl_b32 s34, s32, 14
  s_add_u32 s34, s34, s33
  s_sub_u32 s41, s41, 1
  s_cmp_lt_i32 s41, 0
  s_cmov_b32 s34, 0x7fff0000
  s_add_u32 s32, s32, 1
  s_cmp_eq_u32 s32, 28
  s_cselect_b32 s32, 0, s32
  buffer_load_dwordx4 v[96:99], v10, s[16:19], s34 offen offset:0 sc1
  buffer_load_dwordx4 v[100:103], v10, s[16:19], s34 offen offset:1024 sc1
  buffer_load_dwordx4 v[104:107], v10, s[16:19], s34 offen offset:2048 sc1
  buffer_load_dwordx4 v[108:111], v10, s[16:19], s34 offen offset:3072 sc1
  s_lshl_b32 s34, s32, 14
  s_add_u32 s34, s34, s33
  s_sub_u32 s41, s41, 1
  s_cmp_lt_i32 s41, 0
  s_cmov_b32 s34, 0x7fff0000
  s_add_u32 s32, s32, 1
  s_cmp_eq_u32 s32, 28
  s_cselect_b32 s32, 0, s32
  buffer_load_dwordx4 v[112:115], v10, s[16:19], s34 offen offset:0 sc1
  buffer_load_dwordx4 v[116:119], v10, s[16:19], s34 offen offset:1024 sc1
  buffer_load_dwordx4 v[120:123], v10, s[16:19], s34 offen offset:2048 sc1
  buffer_load_dwordx4 v[124:127], v10, s[16:19], s34 offen offset:3072 sc1
  s_lshl_b32 s34, s32, 14
  s_add_u32 s34, s34, s33
  s_sub_u32 s41, s41, 1
  s_cmp_lt_i32 s41, 0
  s_cmov_b32 s34, 0x7fff0000
  s_add_u32 s32, s32, 1
  s_cmp_eq_u32 s32, 28
  s_cselect_b32 s32, 0, s32
  ds_read_b64_tr_b16 v[144:145], v2 offset:0
  ds_read_b64_tr_b16 v[146:147], v2 offset:512
  ds_read_b64_tr_b16 v[148:149], v3 offset:0
  ds_read_b64_tr_b16 v[150:151], v3 offset:512
  ds_read_b64_tr_b16 v[152:153], v4 offset:0
  ds_read_b64_tr_b16 v[154:155], v4 offset:512
  ds_read_b64_tr_b16 v[156:157], v5 offset:0
  ds_read_b64_tr_b16 v[158:159], v5 offset:512
  ds_read_b64_tr_b16 v[160:161], v2 offset:4096
  ds_read_b64_tr_b16 v[162:163], v2 offset:4608
  ds_read_b64_tr_b16 v[164:165], v3 offset:4096
  ds_read_b64_tr_b16 v[166:167], v3 offset:4608
  ds_read_b64_tr_b16 v[168:169], v4 offset:4096
  ds_read_b64_tr_b16 v[170:171], v4 offset:4608
  ds_read_b64_tr_b16 v[172:173], v5 offset:4096
  ds_read_b64_tr_b16 v[174:175], v5 offset:4608
  s_mov_b32 s35, 2
  .p2align 6
L4_k:
  s_waitcnt vmcnt(20) lgkmcnt(0)
  v_mfma_f32_16x16x32_bf16 v[208:211], v[144:147], v[32:35], v[208:211]
  ds_read_b64_tr_b16 v[176:177], v2 offset:8192
  ds_read_b64_tr_b16 v[178:179], v2 offset:8704
  buffer_load_dwordx4 v[128:131], v10, s[16:19], s34 offen offset:0 sc1
  v_mfma_f32_16x16x32_bf16 v[212:215], v[144:147], v[36:39], v[212:215]
  ds_read_b64_tr_b16 v[180:181], v3 offset:8192
  v_mfma_f32_16x16x32_bf16 v[216:219], v[148:151], v[32:35], v[216:219]
  ds_read_b64_tr_b16 v[182:183], v3 offset:8704
  v_mfma_f32_16x16x32_bf16 v[220:223], v[148:151], v[36:39], v[220:223]
  ds_read_b64_tr_b16 v[184:185], v4 offset:8192
  ds_read_b64_tr_b16 v[186:187], v4 offset:8704
  v_mfma_f32_16x16x32_bf16 v[224:227], v[152:155], v[32:35], v[224:227]
  ds_read_b64_tr_b16 v[188:189], v5 offset:8192
  buffer_load_dwordx4 v[132:135], v10, s[16:19], s34 offen offset:1024 sc1
  v_mfma_f32_16x16x32_bf16 v[228:231], v[152:155], v[36:39], v[228:231]
  ds_read_b64_tr_b16 v[190:191], v5 offset:8704
  v_mfma_f32_16x16x32_bf16 v[232:235], v[156:159], v[32:35], v[232:235]
  ds_read_b64_tr_b16 v[192:193], v2 offset:12288
  ds_read_b64_tr_b16 v[194:195], v2 offset:12800
  v_mfma_f32_16x16x32_bf16 v[236:239], v[156:159], v[36:39], v[236:239]
  ds_read_b64_tr_b16 v[196:197], v3 offset:12288
  v_mfma_f32_16x16x32_bf16 v[208:211], v[160:163], v[40:43], v[208:211]
  ds_read_b64_tr_b16 v[198:199], v3 offset:12800
  buffer_load_dwordx4 v[136:139], v10, s[16:19], s34 offen offset:2048 sc1
  v_mfma_f32_16x16x32_bf16 v[212:215], v[160:163], v[44:47], v[212:215]
  ds_read_b64_tr_b16 v[200:201], v4 offset:12288
  ds_read_b64_tr_b16 v[202:203], v4 offset:12800
  v_mfma_f32_16x16x32_bf16 v[216:219], v[164:167], v[40:43], v[216:219]
  ds_read_b64_tr_b16 v[204:205], v5 offset:12288
  v_mfma_f32_16x16x32_bf16 v[220:223], v[164:167], v[44:47], v[220:223]
  ds_read_b64_tr_b16 v[206:207], v5 offset:12800
  v_mfma_f32_16x16x32_bf16 v[224:227], v[168:171], v[40:43], v[224:227]
  buffer_load_dwordx4 v[140:143], v10, s[16:19], s34 offen offset:3072 sc1
  s_lshl_b32 s34, s32, 14
  s_add_u32 s34, s34, s33
  v_mfma_f32_16x16x32_bf16 v[228:231], v[168:171], v[44:47], v[228:231]
  s_sub_u32 s41, s41, 1
  s_cmp_lt_i32 s41, 0
  s_cmov_b32 s34, 0x7fff0000
  v_mfma_f32_16x16x32_bf16 v[232:235], v[172:175], v[40:43], v[232:235]
  s_add_u32 s32, s32, 1
  s_cmp_eq_u32 s32, 28
  s_cselect_b32 s32, 0, s32
  v_mfma_f32_16x16x32_bf16 v[236:239], v[172:175], v[44:47], v[236:239]
  s_waitcnt vmcnt(20) lgkmcnt(0)
  v_mfma_f32_16x16x32_bf16 v[208:211], v[176:179], v[48:51], v[208:211]
  ds_read_b64_tr_b16 v[144:145], v2 offset:16384
  ds_read_b64_tr_b16 v[146:147], v2 offset:16896
  buffer_load_dwordx4 v[32:35], v10, s[16:19], s34 offen offset:0 sc1
  v_mfma_f32_16x16x32_bf16 v[212:215], v[176:179], v[52:55], v[212:215]
  ds_read_b64_tr_b16 v[148:149], v3 offset:16384
  v_mfma_f32_16x16x32_bf16 v[216:219], v[180:183], v[48:51], v[216:219]
  ds_read_b64_tr_b16 v[150:151], v3 offset:16896
  v_mfma_f32_16x16x32_bf16 v[220:223], v[180:183], v[52:55], v[220:223]
  ds_read_b64_tr_b16 v[152:153], v4 offset:16384
  ds_read_b64_tr_b16 v[154:155], v4 offset:16896
  v_mfma_f32_16x16x32_bf16 v[224:227], v[184:187], v[48:51], v[224:227]
  ds_read_b64_tr_b16 v[156:157], v5 offset:16384
  buffer_load_dwordx4 v[36:39], v10, s[16:19], s34 offen offset:1024 sc1
  v_mfma_f32_16x16x32_bf16 v[228:231], v[184:187], v[52:55], v[228:231]
  ds_read_b64_tr_b16 v[158:159], v5 offset:16896
  v_mfma_f32_16x16x32_bf16 v[232:235], v[188:191], v[48:51], v[232:235]
  ds_read_b64_tr_b16 v[160:161], v2 offset:20480
  ds_read_b64_tr_b16 v[162:163], v2 offset:20992
  v_mfma_f32_16x16x32_bf16 v[236:239], v[188:191], v[52:55], v[236:239]
  ds_read_b64_tr_b16 v[164:165], v3 offset:20480
  v_mfma_f32_16x16x32_bf16 v[208:211], v[192:195], v[56:59], v[208:211]
  ds_read_b64_tr_b16 v[166:167], v3 offset:20992
  buffer_load_dwordx4 v[40:43], v10, s[16:19], s34 offen offset:2048 sc1
  v_mfma_f32_16x16x32_bf16 v[212:215], v[192:195], v[60:63], v[212:215]
  ds_read_b64_tr_b16 v[168:169], v4 offset:20480
  ds_read_b64_tr_b16 v[170:171], v4 offset:20992
  v_mfma_f32_16x16x32_bf16 v[216:219], v[196:199], v[56:59], v[216:219]
  ds_read_b64_tr_b16 v[172:173], v5 offset:20480
  v_mfma_f32_16x16x32_bf16 v[220:223], v[196:199], v[60:63], v[220:223]
  ds_read_b64_tr_b16 v[174:175], v5 offset:20992
  v_mfma_f32_16x16x32_bf16 v[224:227], v[200:203], v[56:59], v[224:227]
  buffer_load_dwordx4 v[44:47], v10, s[16:19], s34 offen offset:3072 sc1
  s_lshl_b32 s34, s32, 14
  s_add_u32 s34, s34, s33
  v_mfma_f32_16x16x32_bf16 v[228:231], v[200:203], v[60:63], v[228:231]
  s_sub_u32 s41, s41, 1
  s_cmp_lt_i32 s41, 0
  s_cmov_b32 s34, 0x7fff0000
  v_mfma_f32_16x16x32_bf16 v[232:235], v[204:207], v[56:59], v[232:235]
  s_add_u32 s32, s32, 1
  s_cmp_eq_u32 s32, 28
  s_cselect_b32 s32, 0, s32
  v_mfma_f32_16x16x32_bf16 v[236:239], v[204:207], v[60:63], v[236:239]
  s_waitcnt vmcnt(20) lgkmcnt(0)
  v_mfma_f32_16x16x32_bf16 v[208:211], v[144:147], v[64:67], v[208:211]
  ds_read_b64_tr_b16 v[176:177], v2 offset:24576
  ds_read_b64_tr_b16 v[178:179], v2 offset:25088
  buffer_load_dwordx4 v[48:51], v10, s[16:19], s34 offen offset:0 sc1
  v_mfma_f32_16x16x32_bf16 v[212:215], v[144:147], v[68:71], v[212:215]
  ds_read_b64_tr_b16 v[180:181], v3 offset:24576
  v_mfma_f32_16x16x32_bf16 v[216:219], v[148:151], v[64:67], v[216:219]
  ds_read_b64_tr_b16 v[182:183], v3 offset:25088
  v_mfma_f32_16x16x32_bf16 v[220:223], v[148:151], v[68:71], v[220:223]
  ds_read_b64_tr_b16 v[184:185], v4 offset:24576
  ds_read_b64_tr_b16 v[186:187], v4 offset:25088
  v_mfma_f32_16x16x32_bf16 v[224:227], v[152:155], v[64:67], v[224:227]
  ds_read_b64_tr_b16 v[188:189], v5 offset:24576
  buffer_load_dwordx4 v[52:55], v10, s[16:19], s34 offen offset:1024 sc1
  v_mfma_f32_16x16x32_bf16 v[228:231], v[152:155], v[68:71], v[228:231]
  ds_read_b64_tr_b16 v[190:191], v5 offset:25088
  v_mfma_f32_16x16x32_bf16 v[232:235], v[156:159], v[64:67], v[232:235]
  ds_read_b64_tr_b16 v[192:193], v2 offset:28672
  ds_read_b64_tr_b16 v[194:195], v2 offset:29184
  v_mfma_f32_16x16x32_bf16 v[236:239], v[156:159], v[68:71], v[236:239]
  ds_read_b64_tr_b16 v[196:197], v3 offset:28672
  v_mfma_f32_16x16x32_bf16 v[208:211], v[160:163], v[72:75], v[208:211]
  ds_read_b64_tr_b16 v[198:199], v3 offset:29184
  buffer_load_dwordx4 v[56:59], v10, s[16:19], s34 offen offset:2048 sc1
  v_mfma_f32_16x16x32_bf16 v[212:215], v[160:163], v[76:79], v[212:215]
  ds_read_b64_tr_b16 v[200:201], v4 offset:28672
  ds_read_b64_tr_b16 v[202:203], v4 offset:29184
  v_mfma_f32_16x16x32_bf16 v[216:219], v[164:167], v[72:75], v[216:219]
  ds_read_b64_tr_b16 v[204:205], v5 offset:28672
  v_mfma_f32_16x16x32_bf16 v[220:223], v[164:167], v[76:79], v[220:223]
  ds_read_b64_tr_b16 v[206:207], v5 offset:29184
  v_mfma_f32_16x16x32_bf16 v[224:227], v[168:171], v[72:75], v[224:227]
  buffer_load_dwordx4 v[60:63], v10, s[16:19], s34 offen offset:3072 sc1
  s_lshl_b32 s34, s32, 14
  s_add_u32 s34, s34, s33
  v_mfma_f32_16x16x32_bf16 v[228:231], v[168:171], v[76:79], v[228:231]
  s_sub_u32 s41, s41, 1
  s_cmp_lt_i32 s41, 0
  s_cmov_b32 s34, 0x7fff0000
  v_mfma_f32_16x16x32_bf16 v[232:235], v[172:175], v[72:75], v[232:235]
  s_add_u32 s32, s32, 1
  s_cmp_eq_u32 s32, 28
  s_cselect_b32 s32, 0, s32
  v_mfma_f32_16x16x32_bf16 v[236:239], v[172:175], v[76:79], v[236:239]
  s_waitcnt vmcnt(20) lgkmcnt(0)
  v_mfma_f32_16x16x32_bf16 v[208:211], v[176:179], v[80:83], v[208:211]
  ds_read_b64_tr_b16 v[144:145], v2 offset:32768
  ds_read_b64_tr_b16 v[146:147], v2 offset:33280
  buffer_load_dwordx4 v[64:67], v10, s[16:19], s34 offen offset:0 sc1
  v_mfma_f32_16x16x32_bf16 v[212:215], v[176:179], v[84:87], v[212:215]
  ds_read_b64_tr_b16 v[148:149], v3 offset:32768
  v_mfma_f32_16x16x32_bf16 v[216:219], v[180:183], v[80:83], v[216:219]
  ds_read_b64_tr_b16 v[150:151], v3 offset:33280
  v_mfma_f32_16x16x32_bf16 v[220:223], v[180:183], v[84:87], v[220:223]
  ds_read_b64_tr_b16 v[152:153], v4 offset:32768
  ds_read_b64_tr_b16 v[154:155], v4 offset:33280
  v_mfma_f32_16x16x32_bf16 v[224:227], v[184:187], v[80:83], v[224:227]
  ds_read_b64_tr_b16 v[156:157], v5 offset:32768
  buffer_load_dwordx4 v[68:71], v10, s[16:19], s34 offen offset:1024 sc1
  v_mfma_f32_16x16x32_bf16 v[228:231], v[184:187], v[84:87], v[228:231]
  ds_read_b64_tr_b16 v[158:159], v5 offset:33280
  v_mfma_f32_16x16x32_bf16 v[232:235], v[188:191], v[80:83], v[232:235]
  ds_read_b64_tr_b16 v[160:161], v2 offset:36864
  ds_read_b64_tr_b16 v[162:163], v2 offset:37376
  v_mfma_f32_16x16x32_bf16 v[236:239], v[188:191], v[84:87], v[236:239]
  ds_read_b64_tr_b16 v[164:165], v3 offset:36864
  v_mfma_f32_16x16x32_bf16 v[208:211], v[192:195], v[88:91], v[208:211]
  ds_read_b64_tr_b16 v[166:167], v3 offset:37376
  buffer_load_dwordx4 v[72:75], v10, s[16:19], s34 offen offset:2048 sc1
  v_mfma_f32_16x16x32_bf16 v[212:215], v[192:195], v[92:95], v[212:215]
  ds_read_b64_tr_b16 v[168:169], v4 offset:36864
  ds_read_b64_tr_b16 v[170:171], v4 offset:37376
  v_mfma_f32_16x16x32_bf16 v[216:219], v[196:199], v[88:91], v[216:219]
  ds_read_b64_tr_b16 v[172:173], v5 offset:36864
  v_mfma_f32_16x16x32_bf16 v[220:223], v[196:199], v[92:95], v[220:223]
  ds_read_b64_tr_b16 v[174:175], v5 offset:37376
  v_mfma_f32_16x16x32_bf16 v[224:227], v[200:203], v[88:91], v[224:227]
  buffer_load_dwordx4 v[76:79], v10, s[16:19], s34 offen offset:3072 sc1
  s_lshl_b32 s34, s32, 14
  s_add_u32 s34, s34, s33
  v_mfma_f32_16x16x32_bf16 v[228:231], v[200:203], v[92:95], v[228:231]
  s_sub_u32 s41, s41, 1
  s_cmp_lt_i32 s41, 0
  s_cmov_b32 s34, 0x7fff0000
  v_mfma_f32_16x16x32_bf16 v[232:235], v[204:207], v[88:91], v[232:235]
  s_add_u32 s32, s32, 1
  s_cmp_eq_u32 s32, 28
  s_cselect_b32 s32, 0, s32
  v_mfma_f32_16x16x32_bf16 v[236:239], v[204:207], v[92:95], v[236:239]
  s_waitcnt vmcnt(20) lgkmcnt(0)
  v_mfma_f32_16x16x32_bf16 v[208:211], v[144:147], v[96:99], v[208:211]
  ds_read_b64_tr_b16 v[176:177], v2 offset:40960
  ds_read_b64_tr_b16 v[178:179], v2 offset:41472
  buffer_load_dwordx4 v[80:83], v10, s[16:19], s34 offen offset:0 sc1
  v_mfma_f32_16x16x32_bf16 v[212:215], v[144:147], v[100:103], v[212:215]
  ds_read_b64_tr_b16 v[180:181], v3 offset:40960
  v_mfma_f32_16x16x32_bf16 v[216:219], v[148:151], v[96:99], v[216:219]
  ds_read_b64_tr_b16 v[182:183], v3 offset:41472
  v_mfma_f32_16x16x32_bf16 v[220:223], v[148:151], v[100:103], v[220:223]
  ds_read_b64_tr_b16 v[184:185], v4 offset:40960
  ds_read_b64_tr_b16 v[186:187], v4 offset:41472
  v_mfma_f32_16x16x32_bf16 v[224:227], v[152:155], v[96:99], v[224:227]
  ds_read_b64_tr_b16 v[188:189], v5 offset:40960
  buffer_load_dwordx4 v[84:87], v10, s[16:19], s34 offen offset:1024 sc1
  v_mfma_f32_16x16x32_bf16 v[228:231], v[152:155], v[100:103], v[228:231]
  ds_read_b64_tr_b16 v[190:191], v5 offset:41472
  v_mfma_f32_16x16x32_bf16 v[232:235], v[156:159], v[96:99], v[232:235]
  ds_read_b64_tr_b16 v[192:193], v2 offset:45056
  ds_read_b64_tr_b16 v[194:195], v2 offset:45568
  v_mfma_f32_16x16x32_bf16 v[236:239], v[156:159], v[100:103], v[236:239]
  ds_read_b64_tr_b16 v[196:197], v3 offset:45056
  v_mfma_f32_16x16x32_bf16 v[208:211], v[160:163], v[104:107], v[208:211]
  ds_read_b64_tr_b16 v[198:199], v3 offset:45568
  buffer_load_dwordx4 v[88:91], v10, s[16:19], s34 offen offset:2048 sc1
  v_mfma_f32_16x16x32_bf16 v[212:215], v[160:163], v[108:111], v[212:215]
  ds_read_b64_tr_b16 v[200:201], v4 offset:45056
  ds_read_b64_tr_b16 v[202:203], v4 offset:45568
  v_mfma_f32_16x16x32_bf16 v[216:219], v[164:167], v[104:107], v[216:219]
  ds_read_b64_tr_b16 v[204:205], v5 offset:45056
  v_mfma_f32_16x16x32_bf16 v[220:223], v[164:167], v[108:111], v[220:223]
  ds_read_b64_tr_b16 v[206:207], v5 offset:45568
  v_mfma_f32_16x16x32_bf16 v[224:227], v[168:171], v[104:107], v[224:227]
  buffer_load_dwordx4 v[92:95], v10, s[16:19], s34 offen offset:3072 sc1
  s_lshl_b32 s34, s32, 14
  s_add_u32 s34, s34, s33
  v_mfma_f32_16x16x32_bf16 v[228:231], v[168:171], v[108:111], v[228:231]
  s_sub_u32 s41, s41, 1
  s_cmp_lt_i32 s41, 0
  s_cmov_b32 s34, 0x7fff0000
  v_mfma_f32_16x16x32_bf16 v[232:235], v[172:175], v[104:107], v[232:235]
  s_add_u32 s32, s32, 1
  s_cmp_eq_u32 s32, 28
  s_cselect_b32 s32, 0, s32
  v_mfma_f32_16x16x32_bf16 v[236:239], v[172:175], v[108:111], v[236:239]
  s_waitcnt vmcnt(20) lgkmcnt(0)
  v_mfma_f32_16x16x32_bf16 v[208:211], v[176:179], v[112:115], v[208:211]
  ds_read_b64_tr_b16 v[144:145], v2 offset:49152
  ds_read_b64_tr_b16 v[146:147], v2 offset:49664
  buffer_load_dwordx4 v[96:99], v10, s[16:19], s34 offen offset:0 sc1
  v_mfma_f32_16x16x32_bf16 v[212:215], v[176:179], v[116:119], v[212:215]
  ds_read_b64_tr_b16 v[148:149], v3 offset:49152
  v_mfma_f32_16x16x32_bf16 v[216:219], v[180:183], v[112:115], v[216:219]
  ds_read_b64_tr_b16 v[150:151], v3 offset:49664
  v_mfma_f32_16x16x32_bf16 v[220:223], v[180:183], v[116:119], v[220:223]
  ds_read_b64_tr_b16 v[152:153], v4 offset:49152
  ds_read_b64_tr_b16 v[154:155], v4 offset:49664
  v_mfma_f32_16x16x32_bf16 v[224:227], v[184:187], v[112:115], v[224:227]
  ds_read_b64_tr_b16 v[156:157], v5 offset:49152
  buffer_load_dwordx4 v[100:103], v10, s[16:19], s34 offen offset:1024 sc1
  v_mfma_f32_16x16x32_bf16 v[228:231], v[184:187], v[116:119], v[228:231]
  ds_read_b64_tr_b16 v[158:159], v5 offset:49664
  v_mfma_f32_16x16x32_bf16 v[232:235], v[188:191], v[112:115], v[232:235]
  ds_read_b64_tr_b16 v[160:161], v2 offset:53248
  ds_read_b64_tr_b16 v[162:163], v2 offset:53760
  v_mfma_f32_16x16x32_bf16 v[236:239], v[188:191], v[116:119], v[236:239]
  ds_read_b64_tr_b16 v[164:165], v3 offset:53248
  v_mfma_f32_16x16x32_bf16 v[208:211], v[192:195], v[120:123], v[208:211]
  ds_read_b64_tr_b16 v[166:167], v3 offset:53760
  buffer_load_dwordx4 v[104:107], v10, s[16:19], s34 offen offset:2048 sc1
  v_mfma_f32_16x16x32_bf16 v[212:215], v[192:195], v[124:127], v[212:215]
  ds_read_b64_tr_b16 v[168:169], v4 offset:53248
  ds_read_b64_tr_b16 v[170:171], v4 offset:53760
  v_mfma_f32_16x16x32_bf16 v[216:219], v[196:199], v[120:123], v[216:219]
  ds_read_b64_tr_b16 v[172:173], v5 offset:53248
  v_mfma_f32_16x16x32_bf16 v[220:223], v[196:199], v[124:127], v[220:223]
  ds_read_b64_tr_b16 v[174:175], v5 offset:53760
  v_mfma_f32_16x16x32_bf16 v[224:227], v[200:203], v[120:123], v[224:227]
  buffer_load_dwordx4 v[108:111], v10, s[16:19], s34 offen offset:3072 sc1
  s_lshl_b32 s34, s32, 14
  s_add_u32 s34, s34, s33
  v_mfma_f32_16x16x32_bf16 v[228:231], v[200:203], v[124:127], v[228:231]
  s_sub_u32 s41, s41, 1
  s_cmp_lt_i32 s41, 0
  s_cmov_b32 s34, 0x7fff0000
  v_mfma_f32_16x16x32_bf16 v[232:235], v[204:207], v[120:123], v[232:235]
  s_add_u32 s32, s32, 1
  s_cmp_eq_u32 s32, 28
  s_cselect_b32 s32, 0, s32
  v_mfma_f32_16x16x32_bf16 v[236:239], v[204:207], v[124:127], v[236:239]
  s_waitcnt vmcnt(20) lgkmcnt(0)
  s_barrier
  v_mfma_f32_16x16x32_bf16 v[208:211], v[144:147], v[128:131], v[208:211]
  ds_read_b64_tr_b16 v[176:177], v6 offset:0
  ds_read_b64_tr_b16 v[178:179], v6 offset:512
  buffer_load_dwordx4 v[112:115], v10, s[16:19], s34 offen offset:0 sc1
  v_mfma_f32_16x16x32_bf16 v[212:215], v[144:147], v[132:135], v[212:215]
  ds_read_b64_tr_b16 v[180:181], v7 offset:0
  v_mfma_f32_16x16x32_bf16 v[216:219], v[148:151], v[128:131], v[216:219]
  ds_read_b64_tr_b16 v[182:183], v7 offset:512
  v_mfma_f32_16x16x32_bf16 v[220:223], v[148:151], v[132:135], v[220:223]
  ds_read_b64_tr_b16 v[184:185], v8 offset:0
  ds_read_b64_tr_b16 v[186:187], v8 offset:512
  v_mfma_f32_16x16x32_bf16 v[224:227], v[152:155], v[128:131], v[224:227]
  ds_read_b64_tr_b16 v[188:189], v9 offset:0
  buffer_load_dwordx4 v[116:119], v10, s[16:19], s34 offen offset:1024 sc1
  v_mfma_f32_16x16x32_bf16 v[228:231], v[152:155], v[132:135], v[228:231]
  ds_read_b64_tr_b16 v[190:191], v9 offset:512
  v_mfma_f32_16x16x32_bf16 v[232:235], v[156:159], v[128:131], v[232:235]
  ds_read_b64_tr_b16 v[192:193], v6 offset:4096
  ds_read_b64_tr_b16 v[194:195], v6 offset:4608
  v_mfma_f32_16x16x32_bf16 v[236:239], v[156:159], v[132:135], v[236:239]
  ds_read_b64_tr_b16 v[196:197], v7 offset:4096
  v_mfma_f32_16x16x32_bf16 v[208:211], v[160:163], v[136:139], v[208:211]
  ds_read_b64_tr_b16 v[198:199], v7 offset:4608
  buffer_load_dwordx4 v[120:123], v10, s[16:19], s34 offen offset:2048 sc1
  v_mfma_f32_16x16x32_bf16 v[212:215], v[160:163], v[140:143], v[212:215]
  ds_read_b64_tr_b16 v[200:201], v8 offset:4096
  ds_read_b64_tr_b16 v[202:203], v8 offset:4608
  v_mfma_f32_16x16x32_bf16 v[216:219], v[164:167], v[136:139], v[216:219]
  ds_read_b64_tr_b16 v[204:205], v9 offset:4096
  v_mfma_f32_16x16x32_bf16 v[220:223], v[164:167], v[140:143], v[220:223]
  ds_read_b64_tr_b16 v[206:207], v9 offset:4608
  v_mfma_f32_16x16x32_bf16 v[224:227], v[168:171], v[136:139], v[224:227]
  buffer_load_dwordx4 v[124:127], v10, s[16:19], s34 offen offset:3072 sc1
  s_lshl_b32 s34, s32, 14
  s_add_u32 s34, s34, s33
  v_mfma_f32_16x16x32_bf16 v[228:231], v[168:171], v[140:143], v[228:231]
  s_sub_u32 s41, s41, 1
  s_cmp_lt_i32 s41, 0
  s_cmov_b32 s34, 0x7fff0000
  v_mfma_f32_16x16x32_bf16 v[232:235], v[172:175], v[136:139], v[232:235]
  s_add_u32 s32, s32, 1
  s_cmp_eq_u32 s32, 28
  s_cselect_b32 s32, 0, s32
  v_mfma_f32_16x16x32_bf16 v[236:239], v[172:175], v[140:143], v[236:239]
  s_waitcnt vmcnt(20) lgkmcnt(0)
  v_mfma_f32_16x16x32_bf16 v[208:211], v[176:179], v[32:35], v[208:211]
  ds_read_b64_tr_b16 v[144:145], v6 offset:8192
  ds_read_b64_tr_b16 v[146:147], v6 offset:8704
  buffer_load_dwordx4 v[128:131], v10, s[16:19], s34 offen offset:0 sc1
  v_mfma_f32_16x16x32_bf16 v[212:215], v[176:179], v[36:39], v[212:215]
  ds_read_b64_tr_b16 v[148:149], v7 offset:8192
  v_mfma_f32_16x16x32_bf16 v[216:219], v[180:183], v[32:35], v[216:219]
  ds_read_b64_tr_b16 v[150:151], v7 offset:8704
  v_mfma_f32_16x16x32_bf16 v[220:223], v[180:183], v[36:39], v[220:223]
  ds_read_b64_tr_b16 v[152:153], v8 offset:8192
  ds_read_b64_tr_b16 v[154:155], v8 offset:8704
  v_mfma_f32_16x16x32_bf16 v[224:227], v[184:187], v[32:35], v[224:227]
  ds_read_b64_tr_b16 v[156:157], v9 offset:8192
  buffer_load_dwordx4 v[132:135], v10, s[16:19], s34 offen offset:1024 sc1
  v_mfma_f32_16x16x32_bf16 v[228:231], v[184:187], v[36:39], v[228:231]
  ds_read_b64_tr_b16 v[158:159], v9 offset:8704
  v_mfma_f32_16x16x32_bf16 v[232:235], v[188:191], v[32:35], v[232:235]
  ds_read_b64_tr_b16 v[160:161], v6 offset:12288
  ds_read_b64_tr_b16 v[162:163], v6 offset:12800
  v_mfma_f32_16x16x32_bf16 v[236:239], v[188:191], v[36:39], v[236:239]
  ds_read_b64_tr_b16 v[164:165], v7 offset:12288
  v_mfma_f32_16x16x32_bf16 v[208:211], v[192:195], v[40:43], v[208:211]
  ds_read_b64_tr_b16 v[166:167], v7 offset:12800
  buffer_load_dwordx4 v[136:139], v10, s[16:19], s34 offen offset:2048 sc1
  v_mfma_f32_16x16x32_bf16 v[212:215], v[192:195], v[44:47], v[212:215]
  ds_read_b64_tr_b16 v[168:169], v8 offset:12288
  ds_read_b64_tr_b16 v[170:171], v8 offset:12800
  v_mfma_f32_16x16x32_bf16 v[216:219], v[196:199], v[40:43], v[216:219]
  ds_read_b64_tr_b16 v[172:173], v9 offset:12288
  v_mfma_f32_16x16x32_bf16 v[220:223], v[196:199], v[44:47], v[220:223]
  ds_read_b64_tr_b16 v[174:175], v9 offset:12800
  v_mfma_f32_16x16x32_bf16 v[224:227], v[200:203], v[40:43], v[224:227]
  buffer_load_dwordx4 v[140:143], v10, s[16:19], s34 offen offset:3072 sc1
  s_lshl_b32 s34, s32, 14
  s_add_u32 s34, s34, s33
  v_mfma_f32_16x16x32_bf16 v[228:231], v[200:203], v[44:47], v[228:231]
  s_sub_u32 s41, s41, 1
  s_cmp_lt_i32 s41, 0
  s_cmov_b32 s34, 0x7fff0000
  v_mfma_f32_16x16x32_bf16 v[232:235], v[204:207], v[40:43], v[232:235]
  s_add_u32 s32, s32, 1
  s_cmp_eq_u32 s32, 28
  s_cselect_b32 s32, 0, s32
  v_mfma_f32_16x16x32_bf16 v[236:239], v[204:207], v[44:47], v[236:239]
  s_waitcnt vmcnt(20) lgkmcnt(0)
  v_mfma_f32_16x16x32_bf16 v[208:211], v[144:147], v[48:51], v[208:211]
  ds_read_b64_tr_b16 v[176:177], v6 offset:16384
  ds_read_b64_tr_b16 v[178:179], v6 offset:16896
  buffer_load_dwordx4 v[32:35], v10, s[16:19], s34 offen offset:0 sc1
  v_mfma_f32_16x16x32_bf16 v[212:215], v[144:147], v[52:55], v[212:215]
  ds_read_b64_tr_b16 v[180:181], v7 offset:16384
  v_mfma_f32_16x16x32_bf16 v[216:219], v[148:151], v[48:51], v[216:219]
  ds_read_b64_tr_b16 v[182:183], v7 offset:16896
  v_mfma_f32_16x16x32_bf16 v[220:223], v[148:151], v[52:55], v[220:223]
  ds_read_b64_tr_b16 v[184:185], v8 offset:16384
  ds_read_b64_tr_b16 v[186:187], v8 offset:16896
  v_mfma_f32_16x16x32_bf16 v[224:227], v[152:155], v[48:51], v[224:227]
  ds_read_b64_tr_b16 v[188:189], v9 offset:16384
  buffer_load_dwordx4 v[36:39], v10, s[16:19], s34 offen offset:1024 sc1
  v_mfma_f32_16x16x32_bf16 v[228:231], v[152:155], v[52:55], v[228:231]
  ds_read_b64_tr_b16 v[190:191], v9 offset:16896
  v_mfma_f32_16x16x32_bf16 v[232:235], v[156:159], v[48:51], v[232:235]
  ds_read_b64_tr_b16 v[192:193], v6 offset:20480
  ds_read_b64_tr_b16 v[194:195], v6 offset:20992
  v_mfma_f32_16x16x32_bf16 v[236:239], v[156:159], v[52:55], v[236:239]
  ds_read_b64_tr_b16 v[196:197], v7 offset:20480
  v_mfma_f32_16x16x32_bf16 v[208:211], v[160:163], v[56:59], v[208:211]
  ds_read_b64_tr_b16 v[198:199], v7 offset:20992
  buffer_load_dwordx4 v[40:43], v10, s[16:19], s34 offen offset:2048 sc1
  v_mfma_f32_16x16x32_bf16 v[212:215], v[160:163], v[60:63], v[212:215]
  ds_read_b64_tr_b16 v[200:201], v8 offset:20480
  ds_read_b64_tr_b16 v[202:203], v8 offset:20992
  v_mfma_f32_16x16x32_bf16 v[216:219], v[164:167], v[56:59], v[216:219]
  ds_read_b64_tr_b16 v[204:205], v9 offset:20480
  v_mfma_f32_16x16x32_bf16 v[220:223], v[164:167], v[60:63], v[220:223]
  ds_read_b64_tr_b16 v[206:207], v9 offset:20992
  v_mfma_f32_16x16x32_bf16 v[224:227], v[168:171], v[56:59], v[224:227]
  buffer_load_dwordx4 v[44:47], v10, s[16:19], s34 offen offset:3072 sc1
  s_lshl_b32 s34, s32, 14
  s_add_u32 s34, s34, s33
  v_mfma_f32_16x16x32_bf16 v[228:231], v[168:171], v[60:63], v[228:231]
  s_sub_u32 s41, s41, 1
  s_cmp_lt_i32 s41, 0
  s_cmov_b32 s34, 0x7fff0000
  v_mfma_f32_16x16x32_bf16 v[232:235], v[172:175], v[56:59], v[232:235]
  s_add_u32 s32, s32, 1
  s_cmp_eq_u32 s32, 28
  s_cselect_b32 s32, 0, s32
  v_mfma_f32_16x16x32_bf16 v[236:239], v[172:175], v[60:63], v[236:239]
  s_waitcnt vmcnt(20) lgkmcnt(0)
  v_mfma_f32_16x16x32_bf16 v[208:211], v[176:179], v[64:67], v[208:211]
  ds_read_b64_tr_b16 v[144:145], v6 offset:24576
  ds_read_b64_tr_b16 v[146:147], v6 offset:25088
  buffer_load_dwordx4 v[48:51], v10, s[16:19], s34 offen offset:0 sc1
  v_mfma_f32_16x16x32_bf16 v[212:215], v[176:179], v[68:71], v[212:215]
  ds_read_b64_tr_b16 v[148:149], v7 offset:24576
  v_mfma_f32_16x16x32_bf16 v[216:219], v[180:183], v[64:67], v[216:219]
  ds_read_b64_tr_b16 v[150:151], v7 offset:25088
  v_mfma_f32_16x16x32_bf16 v[220:223], v[180:183], v[68:71], v[220:223]
  ds_read_b64_tr_b16 v[152:153], v8 offset:24576
  ds_read_b64_tr_b16 v[154:155], v8 offset:25088
  v_mfma_f32_16x16x32_bf16 v[224:227], v[184:187], v[64:67], v[224:227]
  ds_read_b64_tr_b16 v[156:157], v9 offset:24576
  buffer_load_dwordx4 v[52:55], v10, s[16:19], s34 offen offset:1024 sc1
  v_mfma_f32_16x16x32_bf16 v[228:231], v[184:187], v[68:71], v[228:231]
  ds_read_b64_tr_b16 v[158:159], v9 offset:25088
  v_mfma_f32_16x16x32_bf16 v[232:235], v[188:191], v[64:67], v[232:235]
  ds_read_b64_tr_b16 v[160:161], v6 offset:28672
  ds_read_b64_tr_b16 v[162:163], v6 offset:29184
  v_mfma_f32_16x16x32_bf16 v[236:239], v[188:191], v[68:71], v[236:239]
  ds_read_b64_tr_b16 v[164:165], v7 offset:28672
  v_mfma_f32_16x16x32_bf16 v[208:211], v[192:195], v[72:75], v[208:211]
  ds_read_b64_tr_b16 v[166:167], v7 offset:29184
  buffer_load_dwordx4 v[56:59], v10, s[16:19], s34 offen offset:2048 sc1
  v_mfma_f32_16x16x32_bf16 v[212:215], v[192:195], v[76:79], v[212:215]
  ds_read_b64_tr_b16 v[168:169], v8 offset:28672
  ds_read_b64_tr_b16 v[170:171], v8 offset:29184
  v_mfma_f32_16x16x32_bf16 v[216:219], v[196:199], v[72:75], v[216:219]
  ds_read_b64_tr_b16 v[172:173], v9 offset:28672
  v_mfma_f32_16x16x32_bf16 v[220:223], v[196:199], v[76:79], v[220:223]
  ds_read_b64_tr_b16 v[174:175], v9 offset:29184
  v_mfma_f32_16x16x32_bf16 v[224:227], v[200:203], v[72:75], v[224:227]
  buffer_load_dwordx4 v[60:63], v10, s[16:19], s34 offen offset:3072 sc1
  s_lshl_b32 s34, s32, 14
  s_add_u32 s34, s34, s33
  v_mfma_f32_16x16x32_bf16 v[228:231], v[200:203], v[76:79], v[228:231]
  s_sub_u32 s41, s41, 1
  s_cmp_lt_i32 s41, 0
  s_cmov_b32 s34, 0x7fff0000
  v_mfma_f32_16x16x32_bf16 v[232:235], v[204:207], v[72:75], v[232:235]
  s_add_u32 s32, s32, 1
  s_cmp_eq_u32 s32, 28
  s_cselect_b32 s32, 0, s32
  v_mfma_f32_16x16x32_bf16 v[236:239], v[204:207], v[76:79], v[236:239]
  s_waitcnt vmcnt(20) lgkmcnt(0)
  v_mfma_f32_16x16x32_bf16 v[208:211], v[144:147], v[80:83], v[208:211]
  ds_read_b64_tr_b16 v[176:177], v6 offset:32768
  ds_read_b64_tr_b16 v[178:179], v6 offset:33280
  buffer_load_dwordx4 v[64:67], v10, s[16:19], s34 offen offset:0 sc1
  v_mfma_f32_16x16x32_bf16 v[212:215], v[144:147], v[84:87], v[212:215]
  ds_read_b64_tr_b16 v[180:181], v7 offset:32768
  v_mfma_f32_16x16x32_bf16 v[216:219], v[148:151], v[80:83], v[216:219]
  ds_read_b64_tr_b16 v[182:183], v7 offset:33280
  v_mfma_f32_16x16x32_bf16 v[220:223], v[148:151], v[84:87], v[220:223]
  ds_read_b64_tr_b16 v[184:185], v8 offset:32768
  ds_read_b64_tr_b16 v[186:187], v8 offset:33280
  v_mfma_f32_16x16x32_bf16 v[224:227], v[152:155], v[80:83], v[224:227]
  ds_read_b64_tr_b16 v[188:189], v9 offset:32768
  buffer_load_dwordx4 v[68:71], v10, s[16:19], s34 offen offset:1024 sc1
  v_mfma_f32_16x16x32_bf16 v[228:231], v[152:155], v[84:87], v[228:231]
  ds_read_b64_tr_b16 v[190:191], v9 offset:33280
  v_mfma_f32_16x16x32_bf16 v[232:235], v[156:159], v[80:83], v[232:235]
  ds_read_b64_tr_b16 v[192:193], v6 offset:36864
  ds_read_b64_tr_b16 v[194:195], v6 offset:37376
  v_mfma_f32_16x16x32_bf16 v[236:239], v[156:159], v[84:87], v[236:239]
  ds_read_b64_tr_b16 v[196:197], v7 offset:36864
  v_mfma_f32_16x16x32_bf16 v[208:211], v[160:163], v[88:91], v[208:211]
  ds_read_b64_tr_b16 v[198:199], v7 offset:37376
  buffer_load_dwordx4 v[72:75], v10, s[16:19], s34 offen offset:2048 sc1
  v_mfma_f32_16x16x32_bf16 v[212:215], v[160:163], v[92:95], v[212:215]
  ds_read_b64_tr_b16 v[200:201], v8 offset:36864
  ds_read_b64_tr_b16 v[202:203], v8 offset:37376
  v_mfma_f32_16x16x32_bf16 v[216:219], v[164:167], v[88:91], v[216:219]
  ds_read_b64_tr_b16 v[204:205], v9 offset:36864
  v_mfma_f32_16x16x32_bf16 v[220:223], v[164:167], v[92:95], v[220:223]
  ds_read_b64_tr_b16 v[206:207], v9 offset:37376
  v_mfma_f32_16x16x32_bf16 v[224:227], v[168:171], v[88:91], v[224:227]
  buffer_load_dwordx4 v[76:79], v10, s[16:19], s34 offen offset:3072 sc1
  s_lshl_b32 s34, s32, 14
  s_add_u32 s34, s34, s33
  v_mfma_f32_16x16x32_bf16 v[228:231], v[168:171], v[92:95], v[228:231]
  s_sub_u32 s41, s41, 1
  s_cmp_lt_i32 s41, 0
  s_cmov_b32 s34, 0x7fff0000
  v_mfma_f32_16x16x32_bf16 v[232:235], v[172:175], v[88:91], v[232:235]
  s_add_u32 s32, s32, 1
  s_cmp_eq_u32 s32, 28
  s_cselect_b32 s32, 0, s32
  v_mfma_f32_16x16x32_bf16 v[236:239], v[172:175], v[92:95], v[236:239]
  s_waitcnt vmcnt(20) lgkmcnt(0)
  v_mfma_f32_16x16x32_bf16 v[208:211], v[176:179], v[96:99], v[208:211]
  ds_read_b64_tr_b16 v[144:145], v6 offset:40960
  ds_read_b64_tr_b16 v[146:147], v6 offset:41472
  buffer_load_dwordx4 v[80:83], v10, s[16:19], s34 offen offset:0 sc1
  v_mfma_f32_16x16x32_bf16 v[212:215], v[176:179], v[100:103], v[212:215]
  ds_read_b64_tr_b16 v[148:149], v7 offset:40960
  v_mfma_f32_16x16x32_bf16 v[216:219], v[180:183], v[96:99], v[216:219]
  ds_read_b64_tr_b16 v[150:151], v7 offset:41472
  v_mfma_f32_16x16x32_bf16 v[220:223], v[180:183], v[100:103], v[220:223]
  ds_read_b64_tr_b16 v[152:153], v8 offset:40960
  ds_read_b64_tr_b16 v[154:155], v8 offset:41472
  v_mfma_f32_16x16x32_bf16 v[224:227], v[184:187], v[96:99], v[224:227]
  ds_read_b64_tr_b16 v[156:157], v9 offset:40960
  buffer_load_dwordx4 v[84:87], v10, s[16:19], s34 offen offset:1024 sc1
  v_mfma_f32_16x16x32_bf16 v[228:231], v[184:187], v[100:103], v[228:231]
  ds_read_b64_tr_b16 v[158:159], v9 offset:41472
  v_mfma_f32_16x16x32_bf16 v[232:235], v[188:191], v[96:99], v[232:235]
  ds_read_b64_tr_b16 v[160:161], v6 offset:45056
  ds_read_b64_tr_b16 v[162:163], v6 offset:45568
  v_mfma_f32_16x16x32_bf16 v[236:239], v[188:191], v[100:103], v[236:239]
  ds_read_b64_tr_b16 v[164:165], v7 offset:45056
  v_mfma_f32_16x16x32_bf16 v[208:211], v[192:195], v[104:107], v[208:211]
  ds_read_b64_tr_b16 v[166:167], v7 offset:45568
  buffer_load_dwordx4 v[88:91], v10, s[16:19], s34 offen offset:2048 sc1
  v_mfma_f32_16x16x32_bf16 v[212:215], v[192:195], v[108:111], v[212:215]
  ds_read_b64_tr_b16 v[168:169], v8 offset:45056
  ds_read_b64_tr_b16 v[170:171], v8 offset:45568
  v_mfma_f32_16x16x32_bf16 v[216:219], v[196:199], v[104:107], v[216:219]
  ds_read_b64_tr_b16 v[172:173], v9 offset:45056
  v_mfma_f32_16x16x32_bf16 v[220:223], v[196:199], v[108:111], v[220:223]
  ds_read_b64_tr_b16 v[174:175], v9 offset:45568
  v_mfma_f32_16x16x32_bf16 v[224:227], v[200:203], v[104:107], v[224:227]
  buffer_load_dwordx4 v[92:95], v10, s[16:19], s34 offen offset:3072 sc1
  s_lshl_b32 s34, s32, 14
  s_add_u32 s34, s34, s33
  v_mfma_f32_16x16x32_bf16 v[228:231], v[200:203], v[108:111], v[228:231]
  s_sub_u32 s41, s41, 1
  s_cmp_lt_i32 s41, 0
  s_cmov_b32 s34, 0x7fff0000
  v_mfma_f32_16x16x32_bf16 v[232:235], v[204:207], v[104:107], v[232:235]
  s_add_u32 s32, s32, 1
  s_cmp_eq_u32 s32, 28
  s_cselect_b32 s32, 0, s32
  v_mfma_f32_16x16x32_bf16 v[236:239], v[204:207], v[108:111], v[236:239]
  s_waitcnt vmcnt(20) lgkmcnt(0)
  v_mfma_f32_16x16x32_bf16 v[208:211], v[144:147], v[112:115], v[208:211]
  ds_read_b64_tr_b16 v[176:177], v6 offset:49152
  ds_read_b64_tr_b16 v[178:179], v6 offset:49664
  buffer_load_dwordx4 v[96:99], v10, s[16:19], s34 offen offset:0 sc1
  v_mfma_f32_16x16x32_bf16 v[212:215], v[144:147], v[116:119], v[212:215]
  ds_read_b64_tr_b16 v[180:181], v7 offset:49152
  v_mfma_f32_16x16x32_bf16 v[216:219], v[148:151], v[112:115], v[216:219]
  ds_read_b64_tr_b16 v[182:183], v7 offset:49664
  v_mfma_f32_16x16x32_bf16 v[220:223], v[148:151], v[116:119], v[220:223]
  ds_read_b64_tr_b16 v[184:185], v8 offset:49152
  ds_read_b64_tr_b16 v[186:187], v8 offset:49664
  v_mfma_f32_16x16x32_bf16 v[224:227], v[152:155], v[112:115], v[224:227]
  ds_read_b64_tr_b16 v[188:189], v9 offset:49152
  buffer_load_dwordx4 v[100:103], v10, s[16:19], s34 offen offset:1024 sc1
  v_mfma_f32_16x16x32_bf16 v[228:231], v[152:155], v[116:119], v[228:231]
  ds_read_b64_tr_b16 v[190:191], v9 offset:49664
  v_mfma_f32_16x16x32_bf16 v[232:235], v[156:159], v[112:115], v[232:235]
  ds_read_b64_tr_b16 v[192:193], v6 offset:53248
  ds_read_b64_tr_b16 v[194:195], v6 offset:53760
  v_mfma_f32_16x16x32_bf16 v[236:239], v[156:159], v[116:119], v[236:239]
  ds_read_b64_tr_b16 v[196:197], v7 offset:53248
  v_mfma_f32_16x16x32_bf16 v[208:211], v[160:163], v[120:123], v[208:211]
  ds_read_b64_tr_b16 v[198:199], v7 offset:53760
  buffer_load_dwordx4 v[104:107], v10, s[16:19], s34 offen offset:2048 sc1
  v_mfma_f32_16x16x32_bf16 v[212:215], v[160:163], v[124:127], v[212:215]
  ds_read_b64_tr_b16 v[200:201], v8 offset:53248
  ds_read_b64_tr_b16 v[202:203], v8 offset:53760
  v_mfma_f32_16x16x32_bf16 v[216:219], v[164:167], v[120:123], v[216:219]
  ds_read_b64_tr_b16 v[204:205], v9 offset:53248
  v_mfma_f32_16x16x32_bf16 v[220:223], v[164:167], v[124:127], v[220:223]
  ds_read_b64_tr_b16 v[206:207], v9 offset:53760
  v_mfma_f32_16x16x32_bf16 v[224:227], v[168:171], v[120:123], v[224:227]
  buffer_load_dwordx4 v[108:111], v10, s[16:19], s34 offen offset:3072 sc1
  s_lshl_b32 s34, s32, 14
  s_add_u32 s34, s34, s33
  v_mfma_f32_16x16x32_bf16 v[228:231], v[168:171], v[124:127], v[228:231]
  s_sub_u32 s41, s41, 1
  s_cmp_lt_i32 s41, 0
  s_cmov_b32 s34, 0x7fff0000
  v_mfma_f32_16x16x32_bf16 v[232:235], v[172:175], v[120:123], v[232:235]
  s_add_u32 s32, s32, 1
  s_cmp_eq_u32 s32, 28
  s_cselect_b32 s32, 0, s32
  v_mfma_f32_16x16x32_bf16 v[236:239], v[172:175], v[124:127], v[236:239]
  s_waitcnt vmcnt(20) lgkmcnt(0)
  s_barrier
  v_mfma_f32_16x16x32_bf16 v[208:211], v[176:179], v[128:131], v[208:211]
  ds_read_b64_tr_b16 v[144:145], v2 offset:0
  ds_read_b64_tr_b16 v[146:147], v2 offset:512
  buffer_load_dwordx4 v[112:115], v10, s[16:19], s34 offen offset:0 sc1
  v_mfma_f32_16x16x32_bf16 v[212:215], v[176:179], v[132:135], v[212:215]
  ds_read_b64_tr_b16 v[148:149], v3 offset:0
  v_mfma_f32_16x16x32_bf16 v[216:219], v[180:183], v[128:131], v[216:219]
  ds_read_b64_tr_b16 v[150:151], v3 offset:512
  v_mfma_f32_16x16x32_bf16 v[220:223], v[180:183], v[132:135], v[220:223]
  ds_read_b64_tr_b16 v[152:153], v4 offset:0
  ds_read_b64_tr_b16 v[154:155], v4 offset:512
  v_mfma_f32_16x16x32_bf16 v[224:227], v[184:187], v[128:131], v[224:227]
  ds_read_b64_tr_b16 v[156:157], v5 offset:0
  buffer_load_dwordx4 v[116:119], v10, s[16:19], s34 offen offset:1024 sc1
  v_mfma_f32_16x16x32_bf16 v[228:231], v[184:187], v[132:135], v[228:231]
  ds_read_b64_tr_b16 v[158:159], v5 offset:512
  v_mfma_f32_16x16x32_bf16 v[232:235], v[188:191], v[128:131], v[232:235]
  ds_read_b64_tr_b16 v[160:161], v2 offset:4096
  ds_read_b64_tr_b16 v[162:163], v2 offset:4608
  v_mfma_f32_16x16x32_bf16 v[236:239], v[188:191], v[132:135], v[236:239]
  ds_read_b64_tr_b16 v[164:165], v3 offset:4096
  v_mfma_f32_16x16x32_bf16 v[208:211], v[192:195], v[136:139], v[208:211]
  ds_read_b64_tr_b16 v[166:167], v3 offset:4608
  buffer_load_dwordx4 v[120:123], v10, s[16:19], s34 offen offset:2048 sc1
  v_mfma_f32_16x16x32_bf16 v[212:215], v[192:195], v[140:143], v[212:215]
  ds_read_b64_tr_b16 v[168:169], v4 offset:4096
  ds_read_b64_tr_b16 v[170:171], v4 offset:4608
  v_mfma_f32_16x16x32_bf16 v[216:219], v[196:199], v[136:139], v[216:219]
  ds_read_b64_tr_b16 v[172:173], v5 offset:4096
  v_mfma_f32_16x16x32_bf16 v[220:223], v[196:199], v[140:143], v[220:223]
  ds_read_b64_tr_b16 v[174:175], v5 offset:4608
  v_mfma_f32_16x16x32_bf16 v[224:227], v[200:203], v[136:139], v[224:227]
  buffer_load_dwordx4 v[124:127], v10, s[16:19], s34 offen offset:3072 sc1
  s_lshl_b32 s34, s32, 14
  s_add_u32 s34, s34, s33
  v_mfma_f32_16x16x32_bf16 v[228:231], v[200:203], v[140:143], v[228:231]
  s_sub_u32 s41, s41, 1
  s_cmp_lt_i32 s41, 0
  s_cmov_b32 s34, 0x7fff0000
  v_mfma_f32_16x16x32_bf16 v[232:235], v[204:207], v[136:139], v[232:235]
  s_add_u32 s32, s32, 1
  s_cmp_eq_u32 s32, 28
  s_cselect_b32 s32, 0, s32
  v_mfma_f32_16x16x32_bf16 v[236:239], v[204:207], v[140:143], v[236:239]
  s_sub_u32 s35, s35, 1
  s_cmp_lg_u32 s35, 0
  s_cbranch_scc1 L4_k
  s_waitcnt vmcnt(0)
  ds_read_b32 v20, v26 offset:0
  ds_read_b32 v21, v26 offset:16
  s_cmp_lg_u32 s48, 0
  s_cbranch_scc1 L4_mir
  ds_read_b128 v[32:35], v25 offset:0
  ds_read_b128 v[36:39], v25 offset:576
  ds_read_b128 v[40:43], v25 offset:64
  ds_read_b128 v[44:47], v25 offset:640
  s_nop 1
  v_permlane16_swap_b32 v208, v216
  v_permlane16_swap_b32 v209, v217
  v_permlane16_swap_b32 v210, v218
  v_permlane16_swap_b32 v211, v219
  v_permlane16_swap_b32 v212, v220
  v_permlane16_swap_b32 v213, v221
  v_permlane16_swap_b32 v214, v222
  v_permlane16_swap_b32 v215, v223
  v_permlane16_swap_b32 v224, v232
  v_permlane16_swap_b32 v225, v233
  v_permlane16_swap_b32 v226, v234
  v_permlane16_swap_b32 v227, v235
  v_permlane16_swap_b32 v228, v236
  v_permlane16_swap_b32 v229, v237
  v_permlane16_swap_b32 v230, v238
  v_permlane16_swap_b32 v231, v239
  s_waitcnt lgkmcnt(0)
  v_sub_f32 v28, 1.0, v20
  v_sub_f32 v29, 1.0, v21
  v_lshlrev_b32 v64, 16, v32
  v_and_b32 v65, 0xffff0000, v32
  v_lshlrev_b32 v66, 16, v33
  v_and_b32 v67, 0xffff0000, v33
  v_lshlrev_b32 v68, 16, v34
  v_and_b32 v69, 0xffff0000, v34
  v_lshlrev_b32 v70, 16, v35
  v_and_b32 v71, 0xffff0000, v35
  v_mul_f32 v208, v28, v208
  v_fmac_f32 v208, v20, v64
  v_mul_f32 v209, v28, v209
  v_fmac_f32 v209, v20, v65
  v_mul_f32 v210, v28, v210
  v_fmac_f32 v210, v20, v66
  v_mul_f32 v211, v28, v211
  v_fmac_f32 v211, v20, v67
  v_mul_f32 v216, v28, v216
  v_fmac_f32 v216, v20, v68
  v_mul_f32 v217, v28, v217
  v_fmac_f32 v217, v20, v69
  v_mul_f32 v218, v28, v218
  v_fmac_f32 v218, v20, v70
  v_mul_f32 v219, v28, v219
  v_fmac_f32 v219, v20, v71
  v_cvt_pk_bf16_f32 v72, v208, v209
  v_cvt_pk_bf16_f32 v73, v210, v211
  v_cvt_pk_bf16_f32 v74, v216, v217
  v_cvt_pk_bf16_f32 v75, v218, v219
  s_mov_b32 s40, 0
  buffer_store_dwordx4 v[72:75], v24, s[44:47], s40 offen offset:0 sc1 nt
  v_lshlrev_b32 v80, 16, v36
  v_and_b32 v81, 0xffff0000, v36
  v_lshlrev_b32 v82, 16, v37
  v_and_b32 v83, 0xffff0000, v37
  v_lshlrev_b32 v84, 16, v38
  v_and_b32 v85, 0xffff0000, v38
  v_lshlrev_b32 v86, 16, v39
  v_and_b32 v87, 0xffff0000, v39
  v_mul_f32 v212, v29, v212
  v_fmac_f32 v212, v21, v80
  v_mul_f32 v213, v29, v213
  v_fmac_f32 v213, v21, v81
  v_mul_f32 v214, v29, v214
  v_fmac_f32 v214, v21, v82
  v_mul_f32 v215, v29, v215
  v_fmac_f32 v215, v21, v83
  v_mul_f32 v220, v29, v220
  v_fmac_f32 v220, v21, v84
  v_mul_f32 v221, v29, v221
  v_fmac_f32 v221, v21, v85
  v_mul_f32 v222, v29, v222
  v_fmac_f32 v222, v21, v86
  v_mul_f32 v223, v29, v223
  v_fmac_f32 v223, v21, v87
  v_cvt_pk_bf16_f32 v88, v212, v213
  v_cvt_pk_bf16_f32 v89, v214, v215
  v_cvt_pk_bf16_f32 v90, v220, v221
  v_cvt_pk_bf16_f32 v91, v222, v223
  s_mov_b32 s40, 8192
  buffer_store_dwordx4 v[88:91], v24, s[44:47], s40 offen offset:0 sc1 nt
  v_lshlrev_b32 v96, 16, v40
  v_and_b32 v97, 0xffff0000, v40
  v_lshlrev_b32 v98, 16, v41
  v_and_b32 v99, 0xffff0000, v41
  v_lshlrev_b32 v100, 16, v42
  v_and_b32 v101, 0xffff0000, v42
  v_lshlrev_b32 v102, 16, v43
  v_and_b32 v103, 0xffff0000, v43
  v_mul_f32 v224, v28, v224
  v_fmac_f32 v224, v20, v96
  v_mul_f32 v225, v28, v225
  v_fmac_f32 v225, v20, v97
  v_mul_f32 v226, v28, v226
  v_fmac_f32 v226, v20, v98
  v_mul_f32 v227, v28, v227
  v_fmac_f32 v227, v20, v99
  v_mul_f32 v232, v28, v232
  v_fmac_f32 v232, v20, v100
  v_mul_f32 v233, v28, v233
  v_fmac_f32 v233, v20, v101
  v_mul_f32 v234, v28, v234
  v_fmac_f32 v234, v20, v102
  v_mul_f32 v235, v28, v235
  v_fmac_f32 v235, v20, v103
  v_cvt_pk_bf16_f32 v104, v224, v225
  v_cvt_pk_bf16_f32 v105, v226, v227
  v_cvt_pk_bf16_f32 v106, v232, v233
  v_cvt_pk_bf16_f32 v107, v234, v235
  s_mov_b32 s40, 0
  buffer_store_dwordx4 v[104:107], v24, s[44:47], s40 offen offset:64 sc1 nt
  v_lshlrev_b32 v112, 16, v44
  v_and_b32 v113, 0xffff0000, v44
  v_lshlrev_b32 v114, 16, v45
  v_and_b32 v115, 0xffff0000, v45
  v_lshlrev_b32 v116, 16, v46
  v_and_b32 v117, 0xffff0000, v46
  v_lshlrev_b32 v118, 16, v47
  v_and_b32 v119, 0xffff0000, v47
  v_mul_f32 v228, v29, v228
  v_fmac_f32 v228, v21, v112
  v_mul_f32 v229, v29, v229
  v_fmac_f32 v229, v21, v113
  v_mul_f32 v230, v29, v230
  v_fmac_f32 v230, v21, v114
  v_mul_f32 v231, v29, v231
  v_fmac_f32 v231, v21, v115
  v_mul_f32 v236, v29, v236
  v_fmac_f32 v236, v21, v116
  v_mul_f32 v237, v29, v237
  v_fmac_f32 v237, v21, v117
  v_mul_f32 v238, v29, v238
  v_fmac_f32 v238, v21, v118
  v_mul_f32 v239, v29, v239
  v_fmac_f32 v239, v21, v119
  v_cvt_pk_bf16_f32 v120, v228, v229
  v_cvt_pk_bf16_f32 v121, v230, v231
  v_cvt_pk_bf16_f32 v122, v236, v237
  v_cvt_pk_bf16_f32 v123, v238, v239
  s_mov_b32 s40, 8192
  buffer_store_dwordx4 v[120:123], v24, s[44:47], s40 offen offset:64 sc1 nt
  s_endpgm
L4_mir:
  ds_read_b128 v[32:35], v25 offset:64
  ds_read_b32 v48, v25 offset:80
  ds_read_b128 v[36:39], v25 offset:640
  ds_read_b32 v49, v25 offset:656
  ds_read_b128 v[40:43], v25 offset:0
  ds_read_b32 v50, v25 offset:16
  ds_read_b128 v[44:47], v25 offset:576
  ds_read_b32 v51, v25 offset:592
  s_nop 1
  v_permlane16_swap_b32 v208, v216
  v_permlane16_swap_b32 v209, v217
  v_permlane16_swap_b32 v210, v218
  v_permlane16_swap_b32 v211, v219
  v_permlane16_swap_b32 v212, v220
  v_permlane16_swap_b32 v213, v221
  v_permlane16_swap_b32 v214, v222
  v_permlane16_swap_b32 v215, v223
  v_permlane16_swap_b32 v224, v232
  v_permlane16_swap_b32 v225, v233
  v_permlane16_swap_b32 v226, v234
  v_permlane16_swap_b32 v227, v235
  v_permlane16_swap_b32 v228, v236
  v_permlane16_swap_b32 v229, v237
  v_permlane16_swap_b32 v230, v238
  v_permlane16_swap_b32 v231, v239
  s_waitcnt lgkmcnt(0)
  v_sub_f32 v28, 1.0, v20
  v_sub_f32 v29, 1.0, v21
  v_lshlrev_b32 v64, 16, v48
  v_and_b32 v65, 0xffff0000, v35
  v_lshlrev_b32 v66, 16, v35
  v_and_b32 v67, 0xffff0000, v34
  v_lshlrev_b32 v68, 16, v34
  v_and_b32 v69, 0xffff0000, v33
  v_lshlrev_b32 v70, 16, v33
  v_and_b32 v71, 0xffff0000, v32
  v_mul_f32 v208, v28, v208
  v_fmac_f32 v208, v20, v64
  v_mul_f32 v209, v28, v209
  v_fmac_f32 v209, v20, v65
  v_mul_f32 v210, v28, v210
  v_fmac_f32 v210, v20, v66
  v_mul_f32 v211, v28, v211
  v_fmac_f32 v211, v20, v67
  v_mul_f32 v216, v28, v216
  v_fmac_f32 v216, v20, v68
  v_mul_f32 v217, v28, v217
  v_fmac_f32 v217, v20, v69
  v_mul_f32 v218, v28, v218
  v_fmac_f32 v218, v20, v70
  v_mul_f32 v219, v28, v219
  v_fmac_f32 v219, v20, v71
  v_cvt_pk_bf16_f32 v72, v208, v209
  v_cvt_pk_bf16_f32 v73, v210, v211
  v_cvt_pk_bf16_f32 v74, v216, v217
  v_cvt_pk_bf16_f32 v75, v218, v219
  s_mov_b32 s40, 0
  buffer_store_dwordx4 v[72:75], v24, s[44:47], s40 offen offset:0 sc1 nt
  v_lshlrev_b32 v80, 16, v49
  v_and_b32 v81, 0xffff0000, v39
  v_lshlrev_b32 v82, 16, v39
  v_and_b32 v83, 0xffff0000, v38
  v_lshlrev_b32 v84, 16, v38
  v_and_b32 v85, 0xffff0000, v37
  v_lshlrev_b32 v86, 16, v37
  v_and_b32 v87, 0xffff0000, v36
  v_mul_f32 v212, v29, v212
  v_fmac_f32 v212, v21, v80
  v_mul_f32 v213, v29, v213
  v_fmac_f32 v213, v21, v81
  v_mul_f32 v214, v29, v214
  v_fmac_f32 v214, v21, v82
  v_mul_f32 v215, v29, v215
  v_fmac_f32 v215, v21, v83
  v_mul_f32 v220, v29, v220
  v_fmac_f32 v220, v21, v84
  v_mul_f32 v221, v29, v221
  v_fmac_f32 v221, v21, v85
  v_mul_f32 v222, v29, v222
  v_fmac_f32 v222, v21, v86
  v_mul_f32 v223, v29, v223
  v_fmac_f32 v223, v21, v87
  v_cvt_pk_bf16_f32 v88, v212, v213
  v_cvt_pk_bf16_f32 v89, v214, v215
  v_cvt_pk_bf16_f32 v90, v220, v221
  v_cvt_pk_bf16_f32 v91, v222, v223
  s_mov_b32 s40, 8192
  buffer_store_dwordx4 v[88:91], v24, s[44:47], s40 offen offset:0 sc1 nt
  v_lshlrev_b32 v96, 16, v50
  v_and_b32 v97, 0xffff0000, v43
  v_lshlrev_b32 v98, 16, v43
  v_and_b32 v99, 0xffff0000, v42
  v_lshlrev_b32 v100, 16, v42
  v_and_b32 v101, 0xffff0000, v41
  v_lshlrev_b32 v102, 16, v41
  v_and_b32 v103, 0xffff0000, v40
  v_mul_f32 v224, v28, v224
  v_fmac_f32 v224, v20, v96
  v_mul_f32 v225, v28, v225
  v_fmac_f32 v225, v20, v97
  v_mul_f32 v226, v28, v226
  v_fmac_f32 v226, v20, v98
  v_mul_f32 v227, v28, v227
  v_fmac_f32 v227, v20, v99
  v_mul_f32 v232, v28, v232
  v_fmac_f32 v232, v20, v100
  v_mul_f32 v233, v28, v233
  v_fmac_f32 v233, v20, v101
  v_mul_f32 v234, v28, v234
  v_fmac_f32 v234, v20, v102
  v_mul_f32 v235, v28, v235
  v_fmac_f32 v235, v20, v103
  v_cvt_pk_bf16_f32 v104, v224, v225
  v_cvt_pk_bf16_f32 v105, v226, v227
  v_cvt_pk_bf16_f32 v106, v232, v233
  v_cvt_pk_bf16_f32 v107, v234, v235
  s_mov_b32 s40, 0
  buffer_store_dwordx4 v[104:107], v24, s[44:47], s40 offen offset:64 sc1 nt
  v_lshlrev_b32 v112, 16, v51
  v_and_b32 v113, 0xffff0000, v47
  v_lshlrev_b32 v114, 16, v47
  v_and_b32 v115, 0xffff0000, v46
  v_lshlrev_b32 v116, 16, v46
  v_and_b32 v117, 0xffff0000, v45
  v_lshlrev_b32 v118, 16, v45
  v_and_b32 v119, 0xffff0000, v44
  v_mul_f32 v228, v29, v228
  v_fmac_f32 v228, v21, v112
  v_mul_f32 v229, v29, v229
  v_fmac_f32 v229, v21, v113
  v_mul_f32 v230, v29, v230
  v_fmac_f32 v230, v21, v114
  v_mul_f32 v231, v29, v231
  v_fmac_f32 v231, v21, v115
  v_mul_f32 v236, v29, v236
  v_fmac_f32 v236, v21, v116
  v_mul_f32 v237, v29, v237
  v_fmac_f32 v237, v21, v117
  v_mul_f32 v238, v29, v238
  v_fmac_f32 v238, v21, v118
  v_mul_f32 v239, v29, v239
  v_fmac_f32 v239, v21, v119
  v_cvt_pk_bf16_f32 v120, v228, v229
  v_cvt_pk_bf16_f32 v121, v230, v231
  v_cvt_pk_bf16_f32 v122, v236, v237
  v_cvt_pk_bf16_f32 v123, v238, v239
  s_mov_b32 s40, 8192
  buffer_store_dwordx4 v[120:123], v24, s[44:47], s40 offen offset:64 sc1 nt
  s_endpgm
  .p2align 6
L_b4:
  s_waitcnt lgkmcnt(0)
  v_mfma_f32_16x16x32_bf16 v[128:131], v[48:51], v[32:35], v[128:131]
  ds_read_b64_tr_b16 v[80:81], v4 offset:24576
  ds_read_b64_tr_b16 v[82:83], v4 offset:25600
  v_mfma_f32_16x16x32_bf16 v[132:135], v[48:51], v[36:39], v[132:135]
  ds_read_b128 v[64:67], v3 offset:0
  v_mfma_f32_16x16x32_bf16 v[136:139], v[48:51], v[40:43], v[136:139]
  ds_read_b128 v[68:71], v3 offset:2048
  v_mfma_f32_16x16x32_bf16 v[140:143], v[48:51], v[44:47], v[140:143]
  ds_read_b64_tr_b16 v[84:85], v5 offset:24576
  v_mfma_f32_16x16x32_bf16 v[144:147], v[52:55], v[32:35], v[144:147]
  ds_read_b64_tr_b16 v[86:87], v5 offset:25600
  v_mfma_f32_16x16x32_bf16 v[148:151], v[52:55], v[36:39], v[148:151]
  ds_read_b128 v[72:75], v3 offset:4096
  v_mfma_f32_16x16x32_bf16 v[152:155], v[52:55], v[40:43], v[152:155]
  ds_read_b64_tr_b16 v[88:89], v6 offset:24576
  v_mfma_f32_16x16x32_bf16 v[156:159], v[52:55], v[44:47], v[156:159]
  ds_read_b64_tr_b16 v[90:91], v6 offset:25600
  v_mfma_f32_16x16x32_bf16 v[160:163], v[56:59], v[32:35], v[160:163]
  ds_read_b128 v[76:79], v3 offset:6144
  v_mfma_f32_16x16x32_bf16 v[164:167], v[56:59], v[36:39], v[164:167]
  ds_read_b64_tr_b16 v[92:93], v7 offset:24576
  v_mfma_f32_16x16x32_bf16 v[168:171], v[56:59], v[40:43], v[168:171]
  ds_read_b64_tr_b16 v[94:95], v7 offset:25600
  v_mfma_f32_16x16x32_bf16 v[172:175], v[56:59], v[44:47], v[172:175]
  v_mfma_f32_16x16x32_bf16 v[176:179], v[60:63], v[32:35], v[176:179]
  v_mfma_f32_16x16x32_bf16 v[180:183], v[60:63], v[36:39], v[180:183]
  v_mfma_f32_16x16x32_bf16 v[184:187], v[60:63], v[40:43], v[184:187]
  v_mfma_f32_16x16x32_bf16 v[188:191], v[60:63], v[44:47], v[188:191]
  s_waitcnt lgkmcnt(0)
  s_barrier
  v_mfma_f32_16x16x32_bf16 v[128:131], v[80:83], v[64:67], v[128:131]
  ds_read_b64_tr_b16 v[48:49], v4 offset:49152
  ds_read_b64_tr_b16 v[50:51], v4 offset:50176
  v_mfma_f32_16x16x32_bf16 v[132:135], v[80:83], v[68:71], v[132:135]
  ds_read_b128 v[32:35], v2 offset:32768
  v_mfma_f32_16x16x32_bf16 v[136:139], v[80:83], v[72:75], v[136:139]
  ds_read_b128 v[36:39], v2 offset:34816
  v_mfma_f32_16x16x32_bf16 v[140:143], v[80:83], v[76:79], v[140:143]
  ds_read_b64_tr_b16 v[52:53], v5 offset:49152
  v_mfma_f32_16x16x32_bf16 v[144:147], v[84:87], v[64:67], v[144:147]
  ds_read_b64_tr_b16 v[54:55], v5 offset:50176
  v_mfma_f32_16x16x32_bf16 v[148:151], v[84:87], v[68:71], v[148:151]
  ds_read_b128 v[40:43], v2 offset:36864
  v_mfma_f32_16x16x32_bf16 v[152:155], v[84:87], v[72:75], v[152:155]
  ds_read_b64_tr_b16 v[56:57], v6 offset:49152
  v_mfma_f32_16x16x32_bf16 v[156:159], v[84:87], v[76:79], v[156:159]
  ds_read_b64_tr_b16 v[58:59], v6 offset:50176
  v_mfma_f32_16x16x32_bf16 v[160:163], v[88:91], v[64:67], v[160:163]
  ds_read_b128 v[44:47], v2 offset:38912
  v_mfma_f32_16x16x32_bf16 v[164:167], v[88:91], v[68:71], v[164:167]
  ds_read_b64_tr_b16 v[60:61], v7 offset:49152
  v_mfma_f32_16x16x32_bf16 v[168:171], v[88:91], v[72:75], v[168:171]
  ds_read_b64_tr_b16 v[62:63], v7 offset:50176
  v_mfma_f32_16x16x32_bf16 v[172:175], v[88:91], v[76:79], v[172:175]
  v_mfma_f32_16x16x32_bf16 v[176:179], v[92:95], v[64:67], v[176:179]
  v_mfma_f32_16x16x32_bf16 v[180:183], v[92:95], v[68:71], v[180:183]
  v_mfma_f32_16x16x32_bf16 v[184:187], v[92:95], v[72:75], v[184:187]
  v_mfma_f32_16x16x32_bf16 v[188:191], v[92:95], v[76:79], v[188:191]
  s_waitcnt lgkmcnt(0)
  v_mfma_f32_16x16x32_bf16 v[128:131], v[48:51], v[32:35], v[128:131]
  ds_read_b64_tr_b16 v[80:81], v4 offset:57344
  ds_read_b64_tr_b16 v[82:83], v4 offset:58368
  v_mfma_f32_16x16x32_bf16 v[132:135], v[48:51], v[36:39], v[132:135]
  ds_read_b128 v[64:67], v3 offset:32768
  v_mfma_f32_16x16x32_bf16 v[136:139], v[48:51], v[40:43], v[136:139]
  ds_read_b128 v[68:71], v3 offset:34816
  v_mfma_f32_16x16x32_bf16 v[140:143], v[48:51], v[44:47], v[140:143]
  ds_read_b64_tr_b16 v[84:85], v5 offset:57344
  v_mfma_f32_16x16x32_bf16 v[144:147], v[52:55], v[32:35], v[144:147]
  ds_read_b64_tr_b16 v[86:87], v5 offset:58368
  v_mfma_f32_16x16x32_bf16 v[148:151], v[52:55], v[36:39], v[148:151]
  ds_read_b128 v[72:75], v3 offset:36864
  v_mfma_f32_16x16x32_bf16 v[152:155], v[52:55], v[40:43], v[152:155]
  ds_read_b64_tr_b16 v[88:89], v6 offset:57344
  v_mfma_f32_16x16x32_bf16 v[156:159], v[52:55], v[44:47], v[156:159]
  ds_read_b64_tr_b16 v[90:91], v6 offset:58368
  v_mfma_f32_16x16x32_bf16 v[160:163], v[56:59], v[32:35], v[160:163]
  ds_read_b128 v[76:79], v3 offset:38912
  v_mfma_f32_16x16x32_bf16 v[164:167], v[56:59], v[36:39], v[164:167]
  ds_read_b64_tr_b16 v[92:93], v7 offset:57344
  v_mfma_f32_16x16x32_bf16 v[168:171], v[56:59], v[40:43], v[168:171]
  ds_read_b64_tr_b16 v[94:95], v7 offset:58368
  v_mfma_f32_16x16x32_bf16 v[172:175], v[56:59], v[44:47], v[172:175]
  v_mfma_f32_16x16x32_bf16 v[176:179], v[60:63], v[32:35], v[176:179]
  v_mfma_f32_16x16x32_bf16 v[180:183], v[60:63], v[36:39], v[180:183]
  v_mfma_f32_16x16x32_bf16 v[184:187], v[60:63], v[40:43], v[184:187]
  v_mfma_f32_16x16x32_bf16 v[188:191], v[60:63], v[44:47], v[188:191]
  s_waitcnt lgkmcnt(0)
  s_barrier
  v_mfma_f32_16x16x32_bf16 v[128:131], v[80:83], v[64:67], v[128:131]
  ds_read_b64_tr_b16 v[48:49], v22 offset:16384
  ds_read_b64_tr_b16 v[50:51], v22 offset:17408
  v_mfma_f32_16x16x32_bf16 v[132:135], v[80:83], v[68:71], v[132:135]
  ds_read_b128 v[32:35], v20 offset:0
  v_mfma_f32_16x16x32_bf16 v[136:139], v[80:83], v[72:75], v[136:139]
  ds_read_b128 v[36:39], v20 offset:2048
  v_mfma_f32_16x16x32_bf16 v[140:143], v[80:83], v[76:79], v[140:143]
  ds_read_b64_tr_b16 v[52:53], v23 offset:16384
  v_mfma_f32_16x16x32_bf16 v[144:147], v[84:87], v[64:67], v[144:147]
  ds_read_b64_tr_b16 v[54:55], v23 offset:17408
  v_mfma_f32_16x16x32_bf16 v[148:151], v[84:87], v[68:71], v[148:151]
  ds_read_b128 v[40:43], v20 offset:4096
  v_mfma_f32_16x16x32_bf16 v[152:155], v[84:87], v[72:75], v[152:155]
  ds_read_b64_tr_b16 v[56:57], v24 offset:16384
  v_mfma_f32_16x16x32_bf16 v[156:159], v[84:87], v[76:79], v[156:159]
  ds_read_b64_tr_b16 v[58:59], v24 offset:17408
  v_mfma_f32_16x16x32_bf16 v[160:163], v[88:91], v[64:67], v[160:163]
  ds_read_b128 v[44:47], v20 offset:6144
  v_mfma_f32_16x16x32_bf16 v[164:167], v[88:91], v[68:71], v[164:167]
  ds_read_b64_tr_b16 v[60:61], v25 offset:16384
  v_mfma_f32_16x16x32_bf16 v[168:171], v[88:91], v[72:75], v[168:171]
  ds_read_b64_tr_b16 v[62:63], v25 offset:17408
  v_mfma_f32_16x16x32_bf16 v[172:175], v[88:91], v[76:79], v[172:175]
  v_mfma_f32_16x16x32_bf16 v[176:179], v[92:95], v[64:67], v[176:179]
  v_mfma_f32_16x16x32_bf16 v[180:183], v[92:95], v[68:71], v[180:183]
  v_mfma_f32_16x16x32_bf16 v[184:187], v[92:95], v[72:75], v[184:187]
  s_sub_u32 s35, s35, 1
  s_cmp_lg_u32 s35, 0
  v_mfma_f32_16x16x32_bf16 v[188:191], v[92:95], v[76:79], v[188:191]
  s_cbranch_scc0 L_b4r
L_b4m:
  s_waitcnt lgkmcnt(0)
  v_mfma_f32_16x16x32_bf16 v[128:131], v[48:51], v[32:35], v[128:131]
  ds_read_b64_tr_b16 v[80:81], v22 offset:24576
  ds_read_b64_tr_b16 v[82:83], v22 offset:25600
  v_mfma_f32_16x16x32_bf16 v[132:135], v[48:51], v[36:39], v[132:135]
  ds_read_b128 v[64:67], v21 offset:0
  v_mfma_f32_16x16x32_bf16 v[136:139], v[48:51], v[40:43], v[136:139]
  ds_read_b128 v[68:71], v21 offset:2048
  v_mfma_f32_16x16x32_bf16 v[140:143], v[48:51], v[44:47], v[140:143]
  ds_read_b64_tr_b16 v[84:85], v23 offset:24576
  v_mfma_f32_16x16x32_bf16 v[144:147], v[52:55], v[32:35], v[144:147]
  ds_read_b64_tr_b16 v[86:87], v23 offset:25600
  v_mfma_f32_16x16x32_bf16 v[148:151], v[52:55], v[36:39], v[148:151]
  ds_read_b128 v[72:75], v21 offset:4096
  v_mfma_f32_16x16x32_bf16 v[152:155], v[52:55], v[40:43], v[152:155]
  ds_read_b64_tr_b16 v[88:89], v24 offset:24576
  v_mfma_f32_16x16x32_bf16 v[156:159], v[52:55], v[44:47], v[156:159]
  ds_read_b64_tr_b16 v[90:91], v24 offset:25600
  v_mfma_f32_16x16x32_bf16 v[160:163], v[56:59], v[32:35], v[160:163]
  ds_read_b128 v[76:79], v21 offset:6144
  v_mfma_f32_16x16x32_bf16 v[164:167], v[56:59], v[36:39], v[164:167]
  ds_read_b64_tr_b16 v[92:93], v25 offset:24576
  v_mfma_f32_16x16x32_bf16 v[168:171], v[56:59], v[40:43], v[168:171]
  ds_read_b64_tr_b16 v[94:95], v25 offset:25600
  v_mfma_f32_16x16x32_bf16 v[172:175], v[56:59], v[44:47], v[172:175]
  v_mfma_f32_16x16x32_bf16 v[176:179], v[60:63], v[32:35], v[176:179]
  v_mfma_f32_16x16x32_bf16 v[180:183], v[60:63], v[36:39], v[180:183]
  v_mfma_f32_16x16x32_bf16 v[184:187], v[60:63], v[40:43], v[184:187]
  v_mfma_f32_16x16x32_bf16 v[188:191], v[60:63], v[44:47], v[188:191]
  s_waitcnt lgkmcnt(0)
  s_barrier
  v_mfma_f32_16x16x32_bf16 v[128:131], v[80:83], v[64:67], v[128:131]
  ds_read_b64_tr_b16 v[48:49], v22 offset:49152
  ds_read_b64_tr_b16 v[50:51], v22 offset:50176
  v_mfma_f32_16x16x32_bf16 v[132:135], v[80:83], v[68:71], v[132:135]
  ds_read_b128 v[32:35], v20 offset:32768
  v_mfma_f32_16x16x32_bf16 v[136:139], v[80:83], v[72:75], v[136:139]
  ds_read_b128 v[36:39], v20 offset:34816
  v_mfma_f32_16x16x32_bf16 v[140:143], v[80:83], v[76:79], v[140:143]
  ds_read_b64_tr_b16 v[52:53], v23 offset:49152
  v_mfma_f32_16x16x32_bf16 v[144:147], v[84:87], v[64:67], v[144:147]
  ds_read_b64_tr_b16 v[54:55], v23 offset:50176
  v_mfma_f32_16x16x32_bf16 v[148:151], v[84:87], v[68:71], v[148:151]
  ds_read_b128 v[40:43], v20 offset:36864
  v_mfma_f32_16x16x32_bf16 v[152:155], v[84:87], v[72:75], v[152:155]
  ds_read_b64_tr_b16 v[56:57], v24 offset:49152
  v_mfma_f32_16x16x32_bf16 v[156:159], v[84:87], v[76:79], v[156:159]
  ds_read_b64_tr_b16 v[58:59], v24 offset:50176
  v_mfma_f32_16x16x32_bf16 v[160:163], v[88:91], v[64:67], v[160:163]
  ds_read_b128 v[44:47], v20 offset:38912
  v_mfma_f32_16x16x32_bf16 v[164:167], v[88:91], v[68:71], v[164:167]
  ds_read_b64_tr_b16 v[60:61], v25 offset:49152
  v_mfma_f32_16x16x32_bf16 v[168:171], v[88:91], v[72:75], v[168:171]
  ds_read_b64_tr_b16 v[62:63], v25 offset:50176
  v_mfma_f32_16x16x32_bf16 v[172:175], v[88:91], v[76:79], v[172:175]
  v_mfma_f32_16x16x32_bf16 v[176:179], v[92:95], v[64:67], v[176:179]
  v_mfma_f32_16x16x32_bf16 v[180:183], v[92:95], v[68:71], v[180:183]
  v_mfma_f32_16x16x32_bf16 v[184:187], v[92:95], v[72:75], v[184:187]
  v_mfma_f32_16x16x32_bf16 v[188:191], v[92:95], v[76:79], v[188:191]
  s_waitcnt lgkmcnt(0)
  v_mfma_f32_16x16x32_bf16 v[128:131], v[48:51], v[32:35], v[128:131]
  ds_read_b64_tr_b16 v[80:81], v22 offset:57344
  ds_read_b64_tr_b16 v[82:83], v22 offset:58368
  v_mfma_f32_16x16x32_bf16 v[132:135], v[48:51], v[36:39], v[132:135]
  ds_read_b128 v[64:67], v21 offset:32768
  v_mfma_f32_16x16x32_bf16 v[136:139], v[48:51], v[40:43], v[136:139]
  ds_read_b128 v[68:71], v21 offset:34816
  v_mfma_f32_16x16x32_bf16 v[140:143], v[48:51], v[44:47], v[140:143]
  ds_read_b64_tr_b16 v[84:85], v23 offset:57344
  v_mfma_f32_16x16x32_bf16 v[144:147], v[52:55], v[32:35], v[144:147]
  ds_read_b64_tr_b16 v[86:87], v23 offset:58368
  v_mfma_f32_16x16x32_bf16 v[148:151], v[52:55], v[36:39], v[148:151]
  ds_read_b128 v[72:75], v21 offset:36864
  v_mfma_f32_16x16x32_bf16 v[152:155], v[52:55], v[40:43], v[152:155]
  ds_read_b64_tr_b16 v[88:89], v24 offset:57344
  v_mfma_f32_16x16x32_bf16 v[156:159], v[52:55], v[44:47], v[156:159]
  ds_read_b64_tr_b16 v[90:91], v24 offset:58368
  v_mfma_f32_16x16x32_bf16 v[160:163], v[56:59], v[32:35], v[160:163]
  ds_read_b128 v[76:79], v21 offset:38912
  v_mfma_f32_16x16x32_bf16 v[164:167], v[56:59], v[36:39], v[164:167]
  ds_read_b64_tr_b16 v[92:93], v25 offset:57344
  v_mfma_f32_16x16x32_bf16 v[168:171], v[56:59], v[40:43], v[168:171]
  ds_read_b64_tr_b16 v[94:95], v25 offset:58368
  v_mfma_f32_16x16x32_bf16 v[172:175], v[56:59], v[44:47], v[172:175]
  v_mfma_f32_16x16x32_bf16 v[176:179], v[60:63], v[32:35], v[176:179]
  v_mfma_f32_16x16x32_bf16 v[180:183], v[60:63], v[36:39], v[180:183]
  v_mfma_f32_16x16x32_bf16 v[184:187], v[60:63], v[40:43], v[184:187]
  v_mfma_f32_16x16x32_bf16 v[188:191], v[60:63], v[44:47], v[188:191]
  s_waitcnt lgkmcnt(0)
  s_barrier
  v_mfma_f32_16x16x32_bf16 v[128:131], v[80:83], v[64:67], v[128:131]
  ds_read_b64_tr_b16 v[48:49], v4 offset:16384
  ds_read_b64_tr_b16 v[50:51], v4 offset:17408
  v_mfma_f32_16x16x32_bf16 v[132:135], v[80:83], v[68:71], v[132:135]
  ds_read_b128 v[32:35], v2 offset:0
  v_mfma_f32_16x16x32_bf16 v[136:139], v[80:83], v[72:75], v[136:139]
  ds_read_b128 v[36:39], v2 offset:2048
  v_mfma_f32_16x16x32_bf16 v[140:143], v[80:83], v[76:79], v[140:143]
  ds_read_b64_tr_b16 v[52:53], v5 offset:16384
  v_mfma_f32_16x16x32_bf16 v[144:147], v[84:87], v[64:67], v[144:147]
  ds_read_b64_tr_b16 v[54:55], v5 offset:17408
  v_mfma_f32_16x16x32_bf16 v[148:151], v[84:87], v[68:71], v[148:151]
  ds_read_b128 v[40:43], v2 offset:4096
  v_mfma_f32_16x16x32_bf16 v[152:155], v[84:87], v[72:75], v[152:155]
  ds_read_b64_tr_b16 v[56:57], v6 offset:16384
  v_mfma_f32_16x16x32_bf16 v[156:159], v[84:87], v[76:79], v[156:159]
  ds_read_b64_tr_b16 v[58:59], v6 offset:17408
  v_mfma_f32_16x16x32_bf16 v[160:163], v[88:91], v[64:67], v[160:163]
  ds_read_b128 v[44:47], v2 offset:6144
  v_mfma_f32_16x16x32_bf16 v[164:167], v[88:91], v[68:71], v[164:167]
  ds_read_b64_tr_b16 v[60:61], v7 offset:16384
  v_mfma_f32_16x16x32_bf16 v[168:171], v[88:91], v[72:75], v[168:171]
  ds_read_b64_tr_b16 v[62:63], v7 offset:17408
  v_mfma_f32_16x16x32_bf16 v[172:175], v[88:91], v[76:79], v[172:175]
  v_mfma_f32_16x16x32_bf16 v[176:179], v[92:95], v[64:67], v[176:179]
  v_mfma_f32_16x16x32_bf16 v[180:183], v[92:95], v[68:71], v[180:183]
  v_mfma_f32_16x16x32_bf16 v[184:187], v[92:95], v[72:75], v[184:187]
  s_sub_u32 s35, s35, 1
  s_cmp_lg_u32 s35, 0
  v_mfma_f32_16x16x32_bf16 v[188:191], v[92:95], v[76:79], v[188:191]
  s_cbranch_scc1 L_b4
L_b4r:
  s_setpc_b64 s[62:63]
L_gelu:
L_gelu2:
  v_mov_b32 v80, 0xc0135761
  v_mov_b32 v81, 0xc0135761
  v_mov_b32 v82, 0xbdd2d3e8
  v_mov_b32 v83, 0xbdd2d3e8
  v_mov_b32 v84, 1.0
  v_mov_b32 v85, 1.0
  s_nop 1
  s_setpc_b64 s[62:63]
L_side0:
  s_waitcnt lgkmcnt(0)
  s_mov_b32 s16, s90
  s_mov_b32 s17, s91
  s_mov_b32 s18, 0x4000000
  s_mov_b32 s19, 0x20000
  s_mov_b32 s20, s64
  s_mov_b32 s21, s65
  s_mov_b32 s22, 0x400000
  s_mov_b32 s23, 0x20000
  v_mov_b32 v2, 155648
  v_mov_b32 v4, 0
  v_mov_b32 v5, 0
  v_mov_b32 v6, 0
  v_mov_b32 v7, 0
  ds_write_b128 v2, v[4:7]
  ds_write_b128 v2, v[4:7] offset:16
L_side:
  s_lshl_b32 s57, s3, 2
  s_add_u32 s57, s57, s4
  s_sub_u32 s57, s57, 28
  s_lshr_b32 s58, s5, 1
  s_and_b32 s59, s5, 1
  s_mov_b32 s48, s84
  s_mov_b32 s49, s85
  s_mov_b32 s50, 0x800
  s_mov_b32 s51, 0x20000
  v_and_b32 v6, 31, v0
  v_lshrrev_b32 v7, 5, v0
  s_mov_b32 s62, 1
  s_mov_b32 s63, 1
  v_lshlrev_b32 v2, 4, v6
  v_add_u32 v3, 1536, v2
  v_add_u32 v4, 512, v2
  v_add_u32 v5, 1024, v2
  v_mov_b32 v8, 0xffff
  v_cndmask_b32 v8, v8, 0, s[62:63]
  s_mov_b32 s6, 0x80000000
  s_mov_b32 s7, 0x80000000
  v_mov_b32 v10, 0
  s_lshl_b32 s40, s57, 4
  s_lshl_b32 s41, s5, 1
  s_add_u32 s29, s40, s41
  v_add_u32 v16, s29, v7
  v_mov_b32 v20, v16
  v_sub_u32 v21, 2048, v16
  v_sub_u32 v22, 1024, v16
  v_add_u32 v23, 1024, v16
  v_cmp_eq_u32 vcc, 0, v16
  v_mov_b32 v9, 2048
  s_nop 0
  v_cndmask_b32 v23, v23, v9, vcc
  buffer_load_dwordx4 v[96:99], v2, s[48:51], 0 offen
  buffer_load_dwordx4 v[100:103], v3, s[48:51], 0 offen
  buffer_load_dwordx4 v[104:107], v4, s[48:51], 0 offen
  buffer_load_dwordx4 v[108:111], v5, s[48:51], 0 offen
  v_lshlrev_b32 v24, 11, v20
  v_add_u32 v128, v24, v2
  buffer_load_dwordx4 v[32:35], v128, s[20:23], 0 offen
  v_add_u32 v129, v24, v3
  buffer_load_dwordx4 v[36:39], v129, s[20:23], 0 offen
  v_add_u32 v130, v24, v4
  buffer_load_dwordx4 v[40:43], v130, s[20:23], 0 offen
  v_add_u32 v131, v24, v5
  buffer_load_dwordx4 v[44:47], v131, s[20:23], 0 offen
  v_lshlrev_b32 v25, 11, v21
  v_add_u32 v128, v25, v2
  buffer_load_dwordx4 v[48:51], v128, s[20:23], 0 offen
  v_add_u32 v129, v25, v3
  buffer_load_dwordx4 v[52:55], v129, s[20:23], 0 offen
  v_add_u32 v130, v25, v4
  buffer_load_dwordx4 v[56:59], v130, s[20:23], 0 offen
  v_add_u32 v131, v25, v5
  buffer_load_dwordx4 v[60:63], v131, s[20:23], 0 offen
  v_lshlrev_b32 v26, 11, v22
  v_add_u32 v128, v26, v2
  buffer_load_dwordx4 v[64:67], v128, s[20:23], 0 offen
  v_add_u32 v129, v26, v3
  buffer_load_dwordx4 v[68:71], v129, s[20:23], 0 offen
  v_add_u32 v130, v26, v4
  buffer_load_dwordx4 v[72:75], v130, s[20:23], 0 offen
  v_add_u32 v131, v26, v5
  buffer_load_dwordx4 v[76:79], v131, s[20:23], 0 offen
  v_lshlrev_b32 v27, 11, v23
  v_add_u32 v128, v27, v2
  buffer_load_dwordx4 v[80:83], v128, s[20:23], 0 offen
  v_add_u32 v129, v27, v3
  buffer_load_dwordx4 v[84:87], v129, s[20:23], 0 offen
  v_add_u32 v130, v27, v4
  buffer_load_dwordx4 v[88:91], v130, s[20:23], 0 offen
  v_add_u32 v131, v27, v5
  buffer_load_dwordx4 v[92:95], v131, s[20:23], 0 offen
  s_cmp_lt_u32 s58, 2
  s_cselect_b32 s44, s70, s72
  s_cselect_b32 s45, s71, s73
  s_mov_b32 s46, 2097152
  s_mov_b32 s47, 0x20000
  v_add_u32 v9, 0, v7
  v_xor_b32 v11, v6, v9
  v_lshlrev_b32 v11, 4, v11
  v_lshl_add_u32 v11, v9, 12, v11
  v_subrev_u32 v20, 0, v11
  v_add_u32 v9, 2, v7
  v_xor_b32 v11, v6, v9
  v_lshlrev_b32 v11, 4, v11
  v_lshl_add_u32 v11, v9, 12, v11
  v_subrev_u32 v21, 1024, v11
  v_add_u32 v9, 4, v7
  v_xor_b32 v11, v6, v9
  v_lshlrev_b32 v11, 4, v11
  v_lshl_add_u32 v11, v9, 12, v11
  v_subrev_u32 v22, 2048, v11
  v_add_u32 v9, 6, v7
  v_xor_b32 v11, v6, v9
  v_lshlrev_b32 v11, 4, v11
  v_lshl_add_u32 v11, v9, 12, v11
  v_subrev_u32 v23, 3072, v11
  v_add_u32 v9, 8, v7
  v_xor_b32 v11, v6, v9
  v_lshlrev_b32 v11, 4, v11
  v_lshl_add_u32 v11, v9, 12, v11
  v_subrev_u32 v24, 0, v11
  v_add_u32 v9, 10, v7
  v_xor_b32 v11, v6, v9
  v_lshlrev_b32 v11, 4, v11
  v_lshl_add_u32 v11, v9, 12, v11
  v_subrev_u32 v25, 1024, v11
  v_add_u32 v9, 12, v7
  v_xor_b32 v11, v6, v9
  v_lshlrev_b32 v11, 4, v11
  v_lshl_add_u32 v11, v9, 12, v11
  v_subrev_u32 v26, 2048, v11
  v_add_u32 v9, 14, v7
  v_xor_b32 v11, v6, v9
  v_lshlrev_b32 v11, 4, v11
  v_lshl_add_u32 v11, v9, 12, v11
  v_subrev_u32 v27, 3072, v11
  s_lshl_b32 s30, s59, 7
  s_and_b32 s40, s58, 1
  s_add_u32 s30, s30, s40
  s_lshl_b32 s30, s30, 11
  s_lshl_b32 s31, s5, 13
  s_add_u32 s31, s31, 65536
  s_add_u32 m0, s31, 0
  s_nop 0
  buffer_load_dwordx4 v20, s[44:47], s30 offen offset:0 lds
  buffer_load_dwordx4 v21, s[44:47], s30 offen offset:1024 lds
  buffer_load_dwordx4 v22, s[44:47], s30 offen offset:2048 lds
  buffer_load_dwordx4 v23, s[44:47], s30 offen offset:3072 lds
  s_add_u32 m0, s31, 4096
  s_nop 0
  buffer_load_dwordx4 v24, s[44:47], s30 offen offset:0 lds
  buffer_load_dwordx4 v25, s[44:47], s30 offen offset:1024 lds
  buffer_load_dwordx4 v26, s[44:47], s30 offen offset:2048 lds
  buffer_load_dwordx4 v27, s[44:47], s30 offen offset:3072 lds
  s_add_u32 s30, s30, 65536
  s_xor_b32 s31, s31, 65536
  s_lshl_b32 s40, s5, 10
  s_add_u32 m0, s40, 131072
  s_add_u32 s40, s30, 196608
  buffer_load_dwordx4 v20, s[44:47], s40 offen lds
  s_waitcnt vmcnt(9)
  v_lshrrev_b32 v9, 2, v0
  v_and_b32 v11, 3, v0
  v_lshlrev_b32 v9, 12, v9
  v_lshl_add_u32 v9, v11, 7, v9
  s_and_b32 s40, s57, 3
  s_min_u32 s40, s40, 2
  s_lshl_b32 s40, s40, 16
  s_add_u32 s40, s40, s30
  buffer_load_dword v204, v9, s[44:47], s40 offen
  s_mov_b32 s8, s66
  s_mov_b32 s9, s67
  s_mov_b32 s10, 0x800000
  s_mov_b32 s11, 0x20000
  s_bfe_u32 s40, s57, 0x20001
  s_lshl_b32 s40, s40, 7
  s_lshr_b32 s41, s57, 3
  s_lshl_b32 s41, s41, 5
  s_add_u32 s40, s40, s41
  s_lshl_b32 s41, s5, 2
  s_add_u32 s40, s40, s41
  s_lshl_b32 s40, s40, 13
  s_and_b32 s41, s57, 1
  s_lshl_b32 s41, s41, 12
  s_add_u32 s40, s40, s41
  v_lshlrev_b32 v9, 4, v0
  s_add_u32 s41, s40, 0
  buffer_load_dwordx4 v[196:199], v9, s[8:11], s41 offen
  s_add_u32 s41, s40, 8192
  buffer_load_dwordx4 v[196:199], v9, s[8:11], s41 offen
  s_add_u32 s41, s40, 16384
  buffer_load_dwordx4 v[196:199], v9, s[8:11], s41 offen
  s_add_u32 s41, s40, 24576
  buffer_load_dwordx4 v[196:199], v9, s[8:11], s41 offen
  s_mov_b32 s8, s68
  s_mov_b32 s9, s69
  s_add_u32 s41, s40, 0
  buffer_load_dwordx4 v[196:199], v9, s[8:11], s41 offen
  s_add_u32 s41, s40, 8192
  buffer_load_dwordx4 v[196:199], v9, s[8:11], s41 offen
  s_add_u32 s41, s40, 16384
  buffer_load_dwordx4 v[196:199], v9, s[8:11], s41 offen
  s_add_u32 s41, s40, 24576
  buffer_load_dwordx4 v[196:199], v9, s[8:11], s41 offen
  s_mov_b32 s8, s68
  s_mov_b32 s9, s69
  v_dot2_f32_bf16 v252, v32, v96, 0
  v_dot2_f32_bf16 v252, v33, v97, v252
  v_dot2_f32_bf16 v252, v34, v98, v252
  v_dot2_f32_bf16 v252, v35, v99, v252
  v_dot2_f32_bf16 v252, v36, v100, v252
  v_dot2_f32_bf16 v252, v37, v101, v252
  v_dot2_f32_bf16 v252, v38, v102, v252
  v_dot2_f32_bf16 v252, v39, v103, v252
  v_dot2_f32_bf16 v252, v40, v104, v252
  v_dot2_f32_bf16 v252, v41, v105, v252
  v_dot2_f32_bf16 v252, v42, v106, v252
  v_dot2_f32_bf16 v252, v43, v107, v252
  v_dot2_f32_bf16 v252, v44, v108, v252
  v_dot2_f32_bf16 v252, v45, v109, v252
  v_dot2_f32_bf16 v252, v46, v110, v252
  v_dot2_f32_bf16 v252, v47, v111, v252
  ds_swizzle_b32 v36, v36 offset:0x7c1f
  ds_swizzle_b32 v37, v37 offset:0x7c1f
  ds_swizzle_b32 v38, v38 offset:0x7c1f
  ds_swizzle_b32 v39, v39 offset:0x7c1f
  ds_swizzle_b32 v40, v40 offset:0x7c1f
  ds_swizzle_b32 v41, v41 offset:0x7c1f
  ds_swizzle_b32 v42, v42 offset:0x7c1f
  ds_swizzle_b32 v43, v43 offset:0x7c1f
  v_dot2_f32_bf16 v253, v48, v96, 0
  v_dot2_f32_bf16 v253, v49, v97, v253
  v_dot2_f32_bf16 v253, v50, v98, v253
  v_dot2_f32_bf16 v253, v51, v99, v253
  v_dot2_f32_bf16 v253, v52, v100, v253
  v_dot2_f32_bf16 v253, v53, v101, v253
  v_dot2_f32_bf16 v253, v54, v102, v253
  v_dot2_f32_bf16 v253, v55, v103, v253
  v_dot2_f32_bf16 v253, v56, v104, v253
  v_dot2_f32_bf16 v253, v57, v105, v253
  v_dot2_f32_bf16 v253, v58, v106, v253
  v_dot2_f32_bf16 v253, v59, v107, v253
  v_dot2_f32_bf16 v253, v60, v108, v253
  v_dot2_f32_bf16 v253, v61, v109, v253
  v_dot2_f32_bf16 v253, v62, v110, v253
  v_dot2_f32_bf16 v253, v63, v111, v253
  ds_swizzle_b32 v52, v52 offset:0x7c1f
  ds_swizzle_b32 v53, v53 offset:0x7c1f
  ds_swizzle_b32 v54, v54 offset:0x7c1f
  ds_swizzle_b32 v55, v55 offset:0x7c1f
  ds_swizzle_b32 v56, v56 offset:0x7c1f
  ds_swizzle_b32 v57, v57 offset:0x7c1f
  ds_swizzle_b32 v58, v58 offset:0x7c1f
  ds_swizzle_b32 v59, v59 offset:0x7c1f
  v_dot2_f32_bf16 v254, v64, v96, 0
  v_dot2_f32_bf16 v254, v65, v97, v254
  v_dot2_f32_bf16 v254, v66, v98, v254
  v_dot2_f32_bf16 v254, v67, v99, v254
  v_dot2_f32_bf16 v254, v68, v100, v254
  v_dot2_f32_bf16 v254, v69, v101, v254
  v_dot2_f32_bf16 v254, v70, v102, v254
  v_dot2_f32_bf16 v254, v71, v103, v254
  v_dot2_f32_bf16 v254, v72, v104, v254
  v_dot2_f32_bf16 v254, v73, v105, v254
  v_dot2_f32_bf16 v254, v74, v106, v254
  v_dot2_f32_bf16 v254, v75, v107, v254
  v_dot2_f32_bf16 v254, v76, v108, v254
  v_dot2_f32_bf16 v254, v77, v109, v254
  v_dot2_f32_bf16 v254, v78, v110, v254
  v_dot2_f32_bf16 v254, v79, v111, v254
  ds_swizzle_b32 v68, v68 offset:0x7c1f
  ds_swizzle_b32 v69, v69 offset:0x7c1f
  ds_swizzle_b32 v70, v70 offset:0x7c1f
  ds_swizzle_b32 v71, v71 offset:0x7c1f
  ds_swizzle_b32 v72, v72 offset:0x7c1f
  ds_swizzle_b32 v73, v73 offset:0x7c1f
  ds_swizzle_b32 v74, v74 offset:0x7c1f
  ds_swizzle_b32 v75, v75 offset:0x7c1f
  v_dot2_f32_bf16 v255, v80, v96, 0
  v_dot2_f32_bf16 v255, v81, v97, v255
  v_dot2_f32_bf16 v255, v82, v98, v255
  v_dot2_f32_bf16 v255, v83, v99, v255
  v_dot2_f32_bf16 v255, v84, v100, v255
  v_dot2_f32_bf16 v255, v85, v101, v255
  v_dot2_f32_bf16 v255, v86, v102, v255
  v_dot2_f32_bf16 v255, v87, v103, v255
  v_dot2_f32_bf16 v255, v88, v104, v255
  v_dot2_f32_bf16 v255, v89, v105, v255
  v_dot2_f32_bf16 v255, v90, v106, v255
  v_dot2_f32_bf16 v255, v91, v107, v255
  v_dot2_f32_bf16 v255, v92, v108, v255
  v_dot2_f32_bf16 v255, v93, v109, v255
  v_dot2_f32_bf16 v255, v94, v110, v255
  v_dot2_f32_bf16 v255, v95, v111, v255
  ds_swizzle_b32 v84, v84 offset:0x7c1f
  ds_swizzle_b32 v85, v85 offset:0x7c1f
  ds_swizzle_b32 v86, v86 offset:0x7c1f
  ds_swizzle_b32 v87, v87 offset:0x7c1f
  ds_swizzle_b32 v88, v88 offset:0x7c1f
  ds_swizzle_b32 v89, v89 offset:0x7c1f
  ds_swizzle_b32 v90, v90 offset:0x7c1f
  ds_swizzle_b32 v91, v91 offset:0x7c1f
  s_waitcnt lgkmcnt(0)
  v_mov_b32_dpp v120, v36 wave_shr:1 row_mask:0xf bank_mask:0xf bound_ctrl:0
  v_mov_b32_dpp v121, v40 wave_shr:1 row_mask:0xf bank_mask:0xf bound_ctrl:0
  v_lshlrev_b32 v112, 16, v40
  v_lshlrev_b32 v113, 16, v36
  v_and_b32 v120, v8, v120
  v_and_b32 v121, v8, v121
  v_cndmask_b32 v112, 0, v112, s[6:7]
  v_cndmask_b32 v113, 0, v113, s[6:7]
  v_mov_b32_dpp v122, v52 wave_shr:1 row_mask:0xf bank_mask:0xf bound_ctrl:0
  v_mov_b32_dpp v123, v56 wave_shr:1 row_mask:0xf bank_mask:0xf bound_ctrl:0
  v_lshlrev_b32 v114, 16, v56
  v_lshlrev_b32 v115, 16, v52
  v_and_b32 v122, v8, v122
  v_and_b32 v123, v8, v123
  v_cndmask_b32 v114, 0, v114, s[6:7]
  v_cndmask_b32 v115, 0, v115, s[6:7]
  v_mov_b32_dpp v206, v68 wave_shr:1 row_mask:0xf bank_mask:0xf bound_ctrl:0
  v_mov_b32_dpp v207, v72 wave_shr:1 row_mask:0xf bank_mask:0xf bound_ctrl:0
  v_lshlrev_b32 v116, 16, v72
  v_lshlrev_b32 v117, 16, v68
  v_and_b32 v206, v8, v206
  v_and_b32 v207, v8, v207
  v_cndmask_b32 v116, 0, v116, s[6:7]
  v_cndmask_b32 v117, 0, v117, s[6:7]
  v_mov_b32_dpp v248, v84 wave_shr:1 row_mask:0xf bank_mask:0xf bound_ctrl:0
  v_mov_b32_dpp v249, v88 wave_shr:1 row_mask:0xf bank_mask:0xf bound_ctrl:0
  v_lshlrev_b32 v118, 16, v88
  v_lshlrev_b32 v119, 16, v84
  v_and_b32 v248, v8, v248
  v_and_b32 v249, v8, v249
  v_cndmask_b32 v118, 0, v118, s[6:7]
  v_cndmask_b32 v119, 0, v119, s[6:7]
  v_mov_b32 v200, 0
  v_mov_b32 v201, 0
  v_mov_b32 v202, 0
  v_mov_b32 v203, 0
  v_lshlrev_b32 v132, 16, v32
  v_and_b32 v133, 0xffff0000, v32
  v_lshlrev_b32 v134, 16, v120
  v_and_b32 v135, 0xffff0000, v39
  v_lshlrev_b32 v136, 16, v121
  v_and_b32 v137, 0xffff0000, v43
  v_lshlrev_b32 v138, 16, v44
  v_and_b32 v139, 0xffff0000, v44
  v_lshlrev_b32 v140, 16, v48
  v_and_b32 v141, 0xffff0000, v48
  v_lshlrev_b32 v142, 16, v122
  v_and_b32 v143, 0xffff0000, v55
  v_lshlrev_b32 v144, 16, v123
  v_and_b32 v145, 0xffff0000, v59
  v_lshlrev_b32 v146, 16, v60
  v_and_b32 v147, 0xffff0000, v60
  v_lshlrev_b32 v148, 16, v64
  v_and_b32 v149, 0xffff0000, v64
  v_lshlrev_b32 v150, 16, v206
  v_and_b32 v151, 0xffff0000, v71
  v_lshlrev_b32 v152, 16, v207
  v_and_b32 v153, 0xffff0000, v75
  v_lshlrev_b32 v154, 16, v76
  v_and_b32 v155, 0xffff0000, v76
  v_lshlrev_b32 v156, 16, v80
  v_and_b32 v157, 0xffff0000, v80
  v_lshlrev_b32 v158, 16, v248
  v_and_b32 v159, 0xffff0000, v87
  v_lshlrev_b32 v160, 16, v249
  v_and_b32 v161, 0xffff0000, v91
  v_lshlrev_b32 v162, 16, v92
  v_and_b32 v163, 0xffff0000, v92
  v_pk_add_f32 v[124:125], v[132:133], v[140:141]
  v_pk_add_f32 v[140:141], v[132:133], v[140:141] neg_lo:[0,1] neg_hi:[0,1]
  v_pk_add_f32 v[132:133], v[148:149], v[156:157]
  v_pk_add_f32 v[156:157], v[148:149], v[156:157] neg_lo:[0,1] neg_hi:[0,1]
  v_pk_add_f32 v[148:149], v[124:125], v[132:133] neg_lo:[0,1] neg_hi:[0,1]
  v_pk_add_f32 v[132:133], v[124:125], v[132:133]
  v_pk_add_f32 v[124:125], v[140:141], v[156:157] neg_lo:[0,1] neg_hi:[0,1]
  v_pk_add_f32 v[156:157], v[140:141], v[156:157]
  v_pk_add_f32 v[126:127], v[134:135], v[142:143]
  v_pk_add_f32 v[142:143], v[134:135], v[142:143] neg_lo:[0,1] neg_hi:[0,1]
  v_pk_add_f32 v[134:135], v[150:151], v[158:159]
  v_pk_add_f32 v[158:159], v[150:151], v[158:159] neg_lo:[0,1] neg_hi:[0,1]
  v_pk_add_f32 v[150:151], v[126:127], v[134:135] neg_lo:[0,1] neg_hi:[0,1]
  v_pk_add_f32 v[134:135], v[126:127], v[134:135]
  v_pk_add_f32 v[126:127], v[142:143], v[158:159] neg_lo:[0,1] neg_hi:[0,1]
  v_pk_add_f32 v[158:159], v[142:143], v[158:159]
  v_pk_add_f32 v[128:129], v[136:137], v[144:145]
  v_pk_add_f32 v[144:145], v[136:137], v[144:145] neg_lo:[0,1] neg_hi:[0,1]
  v_pk_add_f32 v[136:137], v[152:153], v[160:161]
  v_pk_add_f32 v[160:161], v[152:153], v[160:161] neg_lo:[0,1] neg_hi:[0,1]
  v_pk_add_f32 v[152:153], v[128:129], v[136:137] neg_lo:[0,1] neg_hi:[0,1]
  v_pk_add_f32 v[136:137], v[128:129], v[136:137]
  v_pk_add_f32 v[128:129], v[144:145], v[160:161] neg_lo:[0,1] neg_hi:[0,1]
  v_pk_add_f32 v[160:161], v[144:145], v[160:161]
  v_pk_add_f32 v[130:131], v[138:139], v[146:147]
  v_pk_add_f32 v[146:147], v[138:139], v[146:147] neg_lo:[0,1] neg_hi:[0,1]
  v_pk_add_f32 v[138:139], v[154:155], v[162:163]
  v_pk_add_f32 v[162:163], v[154:155], v[162:163] neg_lo:[0,1] neg_hi:[0,1]
  v_pk_add_f32 v[154:155], v[130:131], v[138:139] neg_lo:[0,1] neg_hi:[0,1]
  v_pk_add_f32 v[138:139], v[130:131], v[138:139]
  v_pk_add_f32 v[130:131], v[146:147], v[162:163] neg_lo:[0,1] neg_hi:[0,1]
  v_pk_add_f32 v[162:163], v[146:147], v[162:163]
  v_pk_add_f32 v[140:141], v[132:133], v[134:135]
  v_pk_add_f32 v[142:143], v[136:137], v[138:139]
  v_pk_add_f32 v[144:145], v[140:141], v[142:143]
  v_pk_add_f32 v[146:147], v[140:141], v[142:143] neg_lo:[0,1] neg_hi:[0,1]
  v_pk_add_f32 v[200:201], v[200:201], v[144:145]
  v_cvt_pk_bf16_f32 v164, v144, v145
  v_cvt_pk_bf16_f32 v172, v146, v147
  v_pk_add_f32 v[140:141], v[148:149], v[150:151]
  v_pk_add_f32 v[142:143], v[152:153], v[154:155]
  v_pk_add_f32 v[144:145], v[140:141], v[142:143]
  v_pk_add_f32 v[146:147], v[140:141], v[142:143] neg_lo:[0,1] neg_hi:[0,1]
  v_pk_add_f32 v[202:203], v[202:203], v[144:145]
  v_cvt_pk_bf16_f32 v168, v144, v145
  v_cvt_pk_bf16_f32 v176, v146, v147
  v_pk_add_f32 v[140:141], v[124:125], v[126:127] neg_lo:[0,1] neg_hi:[0,1]
  v_pk_add_f32 v[142:143], v[128:129], v[130:131] neg_lo:[0,1] neg_hi:[0,1]
  v_pk_add_f32 v[144:145], v[140:141], v[142:143] neg_lo:[0,1] neg_hi:[0,1]
  v_pk_add_f32 v[146:147], v[140:141], v[142:143]
  v_cvt_pk_bf16_f32 v180, v144, v145
  v_cvt_pk_bf16_f32 v188, v146, v147
  v_pk_add_f32 v[140:141], v[156:157], v[158:159] neg_lo:[0,1] neg_hi:[0,1]
  v_pk_add_f32 v[142:143], v[160:161], v[162:163] neg_lo:[0,1] neg_hi:[0,1]
  v_pk_add_f32 v[144:145], v[140:141], v[142:143] neg_lo:[0,1] neg_hi:[0,1]
  v_pk_add_f32 v[146:147], v[140:141], v[142:143]
  v_cvt_pk_bf16_f32 v184, v144, v145
  v_cvt_pk_bf16_f32 v192, v146, v147
  v_lshlrev_b32 v132, 16, v33
  v_and_b32 v133, 0xffff0000, v33
  v_lshlrev_b32 v134, 16, v39
  v_and_b32 v135, 0xffff0000, v38
  v_lshlrev_b32 v136, 16, v43
  v_and_b32 v137, 0xffff0000, v42
  v_lshlrev_b32 v138, 16, v45
  v_and_b32 v139, 0xffff0000, v45
  v_lshlrev_b32 v140, 16, v49
  v_and_b32 v141, 0xffff0000, v49
  v_lshlrev_b32 v142, 16, v55
  v_and_b32 v143, 0xffff0000, v54
  v_lshlrev_b32 v144, 16, v59
  v_and_b32 v145, 0xffff0000, v58
  v_lshlrev_b32 v146, 16, v61
  v_and_b32 v147, 0xffff0000, v61
  v_lshlrev_b32 v148, 16, v65
  v_and_b32 v149, 0xffff0000, v65
  v_lshlrev_b32 v150, 16, v71
  v_and_b32 v151, 0xffff0000, v70
  v_lshlrev_b32 v152, 16, v75
  v_and_b32 v153, 0xffff0000, v74
  v_lshlrev_b32 v154, 16, v77
  v_and_b32 v155, 0xffff0000, v77
  v_lshlrev_b32 v156, 16, v81
  v_and_b32 v157, 0xffff0000, v81
  v_lshlrev_b32 v158, 16, v87
  v_and_b32 v159, 0xffff0000, v86
  v_lshlrev_b32 v160, 16, v91
  v_and_b32 v161, 0xffff0000, v90
  v_lshlrev_b32 v162, 16, v93
  v_and_b32 v163, 0xffff0000, v93
  v_pk_add_f32 v[124:125], v[132:133], v[140:141]
  v_pk_add_f32 v[140:141], v[132:133], v[140:141] neg_lo:[0,1] neg_hi:[0,1]
  v_pk_add_f32 v[132:133], v[148:149], v[156:157]
  v_pk_add_f32 v[156:157], v[148:149], v[156:157] neg_lo:[0,1] neg_hi:[0,1]
  v_pk_add_f32 v[148:149], v[124:125], v[132:133] neg_lo:[0,1] neg_hi:[0,1]
  v_pk_add_f32 v[132:133], v[124:125], v[132:133]
  v_pk_add_f32 v[124:125], v[140:141], v[156:157] neg_lo:[0,1] neg_hi:[0,1]
  v_pk_add_f32 v[156:157], v[140:141], v[156:157]
  v_pk_add_f32 v[126:127], v[134:135], v[142:143]
  v_pk_add_f32 v[142:143], v[134:135], v[142:143] neg_lo:[0,1] neg_hi:[0,1]
  v_pk_add_f32 v[134:135], v[150:151], v[158:159]
  v_pk_add_f32 v[158:159], v[150:151], v[158:159] neg_lo:[0,1] neg_hi:[0,1]
  v_pk_add_f32 v[150:151], v[126:127], v[134:135] neg_lo:[0,1] neg_hi:[0,1]
  v_pk_add_f32 v[134:135], v[126:127], v[134:135]
  v_pk_add_f32 v[126:127], v[142:143], v[158:159] neg_lo:[0,1] neg_hi:[0,1]
  v_pk_add_f32 v[158:159], v[142:143], v[158:159]
  v_pk_add_f32 v[128:129], v[136:137], v[144:145]
  v_pk_add_f32 v[144:145], v[136:137], v[144:145] neg_lo:[0,1] neg_hi:[0,1]
  v_pk_add_f32 v[136:137], v[152:153], v[160:161]
  v_pk_add_f32 v[160:161], v[152:153], v[160:161] neg_lo:[0,1] neg_hi:[0,1]
  v_pk_add_f32 v[152:153], v[128:129], v[136:137] neg_lo:[0,1] neg_hi:[0,1]
  v_pk_add_f32 v[136:137], v[128:129], v[136:137]
  v_pk_add_f32 v[128:129], v[144:145], v[160:161] neg_lo:[0,1] neg_hi:[0,1]
  v_pk_add_f32 v[160:161], v[144:145], v[160:161]
  v_pk_add_f32 v[130:131], v[138:139], v[146:147]
  v_pk_add_f32 v[146:147], v[138:139], v[146:147] neg_lo:[0,1] neg_hi:[0,1]
  v_pk_add_f32 v[138:139], v[154:155], v[162:163]
  v_pk_add_f32 v[162:163], v[154:155], v[162:163] neg_lo:[0,1] neg_hi:[0,1]
  v_pk_add_f32 v[154:155], v[130:131], v[138:139] neg_lo:[0,1] neg_hi:[0,1]
  v_pk_add_f32 v[138:139], v[130:131], v[138:139]
  v_pk_add_f32 v[130:131], v[146:147], v[162:163] neg_lo:[0,1] neg_hi:[0,1]
  v_pk_add_f32 v[162:163], v[146:147], v[162:163]
  v_pk_add_f32 v[140:141], v[132:133], v[134:135]
  v_pk_add_f32 v[142:143], v[136:137], v[138:139]
  v_pk_add_f32 v[144:145], v[140:141], v[142:143]
  v_pk_add_f32 v[146:147], v[140:141], v[142:143] neg_lo:[0,1] neg_hi:[0,1]
  v_pk_add_f32 v[200:201], v[200:201], v[144:145]
  v_cvt_pk_bf16_f32 v165, v144, v145
  v_cvt_pk_bf16_f32 v173, v146, v147
  v_pk_add_f32 v[140:141], v[148:149], v[150:151]
  v_pk_add_f32 v[142:143], v[152:153], v[154:155]
  v_pk_add_f32 v[144:145], v[140:141], v[142:143]
  v_pk_add_f32 v[146:147], v[140:141], v[142:143] neg_lo:[0,1] neg_hi:[0,1]
  v_pk_add_f32 v[202:203], v[202:203], v[144:145]
  v_cvt_pk_bf16_f32 v169, v144, v145
  v_cvt_pk_bf16_f32 v177, v146, v147
  v_pk_add_f32 v[140:141], v[124:125], v[126:127] neg_lo:[0,1] neg_hi:[0,1]
  v_pk_add_f32 v[142:143], v[128:129], v[130:131] neg_lo:[0,1] neg_hi:[0,1]
  v_pk_add_f32 v[144:145], v[140:141], v[142:143] neg_lo:[0,1] neg_hi:[0,1]
  v_pk_add_f32 v[146:147], v[140:141], v[142:143]
  v_cvt_pk_bf16_f32 v181, v144, v145
  v_cvt_pk_bf16_f32 v189, v146, v147
  v_pk_add_f32 v[140:141], v[156:157], v[158:159] neg_lo:[0,1] neg_hi:[0,1]
  v_pk_add_f32 v[142:143], v[160:161], v[162:163] neg_lo:[0,1] neg_hi:[0,1]
  v_pk_add_f32 v[144:145], v[140:141], v[142:143] neg_lo:[0,1] neg_hi:[0,1]
  v_pk_add_f32 v[146:147], v[140:141], v[142:143]
  v_cvt_pk_bf16_f32 v185, v144, v145
  v_cvt_pk_bf16_f32 v193, v146, v147
  v_lshlrev_b32 v132, 16, v34
  v_and_b32 v133, 0xffff0000, v34
  v_lshlrev_b32 v134, 16, v38
  v_and_b32 v135, 0xffff0000, v37
  v_lshlrev_b32 v136, 16, v42
  v_and_b32 v137, 0xffff0000, v41
  v_lshlrev_b32 v138, 16, v46
  v_and_b32 v139, 0xffff0000, v46
  v_lshlrev_b32 v140, 16, v50
  v_and_b32 v141, 0xffff0000, v50
  v_lshlrev_b32 v142, 16, v54
  v_and_b32 v143, 0xffff0000, v53
  v_lshlrev_b32 v144, 16, v58
  v_and_b32 v145, 0xffff0000, v57
  v_lshlrev_b32 v146, 16, v62
  v_and_b32 v147, 0xffff0000, v62
  v_lshlrev_b32 v148, 16, v66
  v_and_b32 v149, 0xffff0000, v66
  v_lshlrev_b32 v150, 16, v70
  v_and_b32 v151, 0xffff0000, v69
  v_lshlrev_b32 v152, 16, v74
  v_and_b32 v153, 0xffff0000, v73
  v_lshlrev_b32 v154, 16, v78
  v_and_b32 v155, 0xffff0000, v78
  v_lshlrev_b32 v156, 16, v82
  v_and_b32 v157, 0xffff0000, v82
  v_lshlrev_b32 v158, 16, v86
  v_and_b32 v159, 0xffff0000, v85
  v_lshlrev_b32 v160, 16, v90
  v_and_b32 v161, 0xffff0000, v89
  v_lshlrev_b32 v162, 16, v94
  v_and_b32 v163, 0xffff0000, v94
  v_pk_add_f32 v[124:125], v[132:133], v[140:141]
  v_pk_add_f32 v[140:141], v[132:133], v[140:141] neg_lo:[0,1] neg_hi:[0,1]
  v_pk_add_f32 v[132:133], v[148:149], v[156:157]
  v_pk_add_f32 v[156:157], v[148:149], v[156:157] neg_lo:[0,1] neg_hi:[0,1]
  v_pk_add_f32 v[148:149], v[124:125], v[132:133] neg_lo:[0,1] neg_hi:[0,1]
  v_pk_add_f32 v[132:133], v[124:125], v[132:133]
  v_pk_add_f32 v[124:125], v[140:141], v[156:157] neg_lo:[0,1] neg_hi:[0,1]
  v_pk_add_f32 v[156:157], v[140:141], v[156:157]
  v_pk_add_f32 v[126:127], v[134:135], v[142:143]
  v_pk_add_f32 v[142:143], v[134:135], v[142:143] neg_lo:[0,1] neg_hi:[0,1]
  v_pk_add_f32 v[134:135], v[150:151], v[158:159]
  v_pk_add_f32 v[158:159], v[150:151], v[158:159] neg_lo:[0,1] neg_hi:[0,1]
  v_pk_add_f32 v[150:151], v[126:127], v[134:135] neg_lo:[0,1] neg_hi:[0,1]
  v_pk_add_f32 v[134:135], v[126:127], v[134:135]
  v_pk_add_f32 v[126:127], v[142:143], v[158:159] neg_lo:[0,1] neg_hi:[0,1]
  v_pk_add_f32 v[158:159], v[142:143], v[158:159]
  v_pk_add_f32 v[128:129], v[136:137], v[144:145]
  v_pk_add_f32 v[144:145], v[136:137], v[144:145] neg_lo:[0,1] neg_hi:[0,1]
  v_pk_add_f32 v[136:137], v[152:153], v[160:161]
  v_pk_add_f32 v[160:161], v[152:153], v[160:161] neg_lo:[0,1] neg_hi:[0,1]
  v_pk_add_f32 v[152:153], v[128:129], v[136:137] neg_lo:[0,1] neg_hi:[0,1]
  v_pk_add_f32 v[136:137], v[128:129], v[136:137]
  v_pk_add_f32 v[128:129], v[144:145], v[160:161] neg_lo:[0,1] neg_hi:[0,1]
  v_pk_add_f32 v[160:161], v[144:145], v[160:161]
  v_pk_add_f32 v[130:131], v[138:139], v[146:147]
  v_pk_add_f32 v[146:147], v[138:139], v[146:147] neg_lo:[0,1] neg_hi:[0,1]
  v_pk_add_f32 v[138:139], v[154:155], v[162:163]
  v_pk_add_f32 v[162:163], v[154:155], v[162:163] neg_lo:[0,1] neg_hi:[0,1]
  v_pk_add_f32 v[154:155], v[130:131], v[138:139] neg_lo:[0,1] neg_hi:[0,1]
  v_pk_add_f32 v[138:139], v[130:131], v[138:139]
  v_pk_add_f32 v[130:131], v[146:147], v[162:163] neg_lo:[0,1] neg_hi:[0,1]
  v_pk_add_f32 v[162:163], v[146:147], v[162:163]
  v_pk_add_f32 v[140:141], v[132:133], v[134:135]
  v_pk_add_f32 v[142:143], v[136:137], v[138:139]
  v_pk_add_f32 v[144:145], v[140:141], v[142:143]
  v_pk_add_f32 v[146:147], v[140:141], v[142:143] neg_lo:[0,1] neg_hi:[0,1]
  v_pk_add_f32 v[200:201], v[200:201], v[144:145]
  v_cvt_pk_bf16_f32 v166, v144, v145
  v_cvt_pk_bf16_f32 v174, v146, v147
  v_pk_add_f32 v[140:141], v[148:149], v[150:151]
  v_pk_add_f32 v[142:143], v[152:153], v[154:155]
  v_pk_add_f32 v[144:145], v[140:141], v[142:143]
  v_pk_add_f32 v[146:147], v[140:141], v[142:143] neg_lo:[0,1] neg_hi:[0,1]
  v_pk_add_f32 v[202:203], v[202:203], v[144:145]
  v_cvt_pk_bf16_f32 v170, v144, v145
  v_cvt_pk_bf16_f32 v178, v146, v147
  v_pk_add_f32 v[140:141], v[124:125], v[126:127] neg_lo:[0,1] neg_hi:[0,1]
  v_pk_add_f32 v[142:143], v[128:129], v[130:131] neg_lo:[0,1] neg_hi:[0,1]
  v_pk_add_f32 v[144:145], v[140:141], v[142:143] neg_lo:[0,1] neg_hi:[0,1]
  v_pk_add_f32 v[146:147], v[140:141], v[142:143]
  v_cvt_pk_bf16_f32 v182, v144, v145
  v_cvt_pk_bf16_f32 v190, v146, v147
  v_pk_add_f32 v[140:141], v[156:157], v[158:159] neg_lo:[0,1] neg_hi:[0,1]
  v_pk_add_f32 v[142:143], v[160:161], v[162:163] neg_lo:[0,1] neg_hi:[0,1]
  v_pk_add_f32 v[144:145], v[140:141], v[142:143] neg_lo:[0,1] neg_hi:[0,1]
  v_pk_add_f32 v[146:147], v[140:141], v[142:143]
  v_cvt_pk_bf16_f32 v186, v144, v145
  v_cvt_pk_bf16_f32 v194, v146, v147
  v_lshlrev_b32 v132, 16, v35
  v_and_b32 v133, 0xffff0000, v35
  v_lshlrev_b32 v134, 16, v37
  v_and_b32 v135, 0xffff0000, v36
  v_lshlrev_b32 v136, 16, v41
  v_and_b32 v137, 0xffff0000, v40
  v_lshlrev_b32 v138, 16, v47
  v_and_b32 v139, 0xffff0000, v47
  v_lshlrev_b32 v140, 16, v51
  v_and_b32 v141, 0xffff0000, v51
  v_lshlrev_b32 v142, 16, v53
  v_and_b32 v143, 0xffff0000, v52
  v_lshlrev_b32 v144, 16, v57
  v_and_b32 v145, 0xffff0000, v56
  v_lshlrev_b32 v146, 16, v63
  v_and_b32 v147, 0xffff0000, v63
  v_lshlrev_b32 v148, 16, v67
  v_and_b32 v149, 0xffff0000, v67
  v_lshlrev_b32 v150, 16, v69
  v_and_b32 v151, 0xffff0000, v68
  v_lshlrev_b32 v152, 16, v73
  v_and_b32 v153, 0xffff0000, v72
  v_lshlrev_b32 v154, 16, v79
  v_and_b32 v155, 0xffff0000, v79
  v_lshlrev_b32 v156, 16, v83
  v_and_b32 v157, 0xffff0000, v83
  v_lshlrev_b32 v158, 16, v85
  v_and_b32 v159, 0xffff0000, v84
  v_lshlrev_b32 v160, 16, v89
  v_and_b32 v161, 0xffff0000, v88
  v_lshlrev_b32 v162, 16, v95
  v_and_b32 v163, 0xffff0000, v95
  v_pk_add_f32 v[124:125], v[132:133], v[140:141]
  v_pk_add_f32 v[140:141], v[132:133], v[140:141] neg_lo:[0,1] neg_hi:[0,1]
  v_pk_add_f32 v[132:133], v[148:149], v[156:157]
  v_pk_add_f32 v[156:157], v[148:149], v[156:157] neg_lo:[0,1] neg_hi:[0,1]
  v_pk_add_f32 v[148:149], v[124:125], v[132:133] neg_lo:[0,1] neg_hi:[0,1]
  v_pk_add_f32 v[132:133], v[124:125], v[132:133]
  v_pk_add_f32 v[124:125], v[140:141], v[156:157] neg_lo:[0,1] neg_hi:[0,1]
  v_pk_add_f32 v[156:157], v[140:141], v[156:157]
  v_pk_add_f32 v[126:127], v[134:135], v[142:143]
  v_pk_add_f32 v[142:143], v[134:135], v[142:143] neg_lo:[0,1] neg_hi:[0,1]
  v_pk_add_f32 v[134:135], v[150:151], v[158:159]
  v_pk_add_f32 v[158:159], v[150:151], v[158:159] neg_lo:[0,1] neg_hi:[0,1]
  v_pk_add_f32 v[150:151], v[126:127], v[134:135] neg_lo:[0,1] neg_hi:[0,1]
  v_pk_add_f32 v[134:135], v[126:127], v[134:135]
  v_pk_add_f32 v[126:127], v[142:143], v[158:159] neg_lo:[0,1] neg_hi:[0,1]
  v_pk_add_f32 v[158:159], v[142:143], v[158:159]
  v_pk_add_f32 v[128:129], v[136:137], v[144:145]
  v_pk_add_f32 v[144:145], v[136:137], v[144:145] neg_lo:[0,1] neg_hi:[0,1]
  v_pk_add_f32 v[136:137], v[152:153], v[160:161]
  v_pk_add_f32 v[160:161], v[152:153], v[160:161] neg_lo:[0,1] neg_hi:[0,1]
  v_pk_add_f32 v[152:153], v[128:129], v[136:137] neg_lo:[0,1] neg_hi:[0,1]
  v_pk_add_f32 v[136:137], v[128:129], v[136:137]
  v_pk_add_f32 v[128:129], v[144:145], v[160:161] neg_lo:[0,1] neg_hi:[0,1]
  v_pk_add_f32 v[160:161], v[144:145], v[160:161]
  v_pk_add_f32 v[130:131], v[138:139], v[146:147]
  v_pk_add_f32 v[146:147], v[138:139], v[146:147] neg_lo:[0,1] neg_hi:[0,1]
  v_pk_add_f32 v[138:139], v[154:155], v[162:163]
  v_pk_add_f32 v[162:163], v[154:155], v[162:163] neg_lo:[0,1] neg_hi:[0,1]
  v_pk_add_f32 v[154:155], v[130:131], v[138:139] neg_lo:[0,1] neg_hi:[0,1]
  v_pk_add_f32 v[138:139], v[130:131], v[138:139]
  v_pk_add_f32 v[130:131], v[146:147], v[162:163] neg_lo:[0,1] neg_hi:[0,1]
  v_pk_add_f32 v[162:163], v[146:147], v[162:163]
  v_pk_add_f32 v[140:141], v[132:133], v[134:135]
  v_pk_add_f32 v[142:143], v[136:137], v[138:139]
  v_pk_add_f32 v[144:145], v[140:141], v[142:143]
  v_pk_add_f32 v[146:147], v[140:141], v[142:143] neg_lo:[0,1] neg_hi:[0,1]
  v_pk_add_f32 v[200:201], v[200:201], v[144:145]
  v_cvt_pk_bf16_f32 v167, v144, v145
  v_cvt_pk_bf16_f32 v175, v146, v147
  v_pk_add_f32 v[140:141], v[148:149], v[150:151]
  v_pk_add_f32 v[142:143], v[152:153], v[154:155]
  v_pk_add_f32 v[144:145], v[140:141], v[142:143]
  v_pk_add_f32 v[146:147], v[140:141], v[142:143] neg_lo:[0,1] neg_hi:[0,1]
  v_pk_add_f32 v[202:203], v[202:203], v[144:145]
  v_cvt_pk_bf16_f32 v171, v144, v145
  v_cvt_pk_bf16_f32 v179, v146, v147
  v_pk_add_f32 v[140:141], v[124:125], v[126:127] neg_lo:[0,1] neg_hi:[0,1]
  v_pk_add_f32 v[142:143], v[128:129], v[130:131] neg_lo:[0,1] neg_hi:[0,1]
  v_pk_add_f32 v[144:145], v[140:141], v[142:143] neg_lo:[0,1] neg_hi:[0,1]
  v_pk_add_f32 v[146:147], v[140:141], v[142:143]
  v_cvt_pk_bf16_f32 v183, v144, v145
  v_cvt_pk_bf16_f32 v191, v146, v147
  v_pk_add_f32 v[140:141], v[156:157], v[158:159] neg_lo:[0,1] neg_hi:[0,1]
  v_pk_add_f32 v[142:143], v[160:161], v[162:163] neg_lo:[0,1] neg_hi:[0,1]
  v_pk_add_f32 v[144:145], v[140:141], v[142:143] neg_lo:[0,1] neg_hi:[0,1]
  v_pk_add_f32 v[146:147], v[140:141], v[142:143]
  v_cvt_pk_bf16_f32 v187, v144, v145
  v_cvt_pk_bf16_f32 v195, v146, v147
  s_lshl_b32 s40, s5, 1
  v_add_u32 v17, s40, v7
  v_xor_b32 v9, v6, v17
  v_lshlrev_b32 v9, 4, v9
  v_lshl_add_u32 v9, v17, 9, v9
  ds_write_b128 v9, v[164:167] offset:0
  ds_write_b128 v9, v[168:171] offset:8192
  ds_write_b128 v9, v[172:175] offset:16384
  ds_write_b128 v9, v[176:179] offset:24576
  ds_write_b128 v9, v[180:183] offset:32768
  ds_write_b128 v9, v[184:187] offset:40960
  ds_write_b128 v9, v[188:191] offset:49152
  ds_write_b128 v9, v[192:195] offset:57344
  v_add_f32 v132, v112, v113
  v_sub_f32 v136, v112, v113
  v_add_f32 v133, v114, v115
  v_sub_f32 v137, v114, v115
  v_add_f32 v134, v116, v117
  v_sub_f32 v138, v116, v117
  v_add_f32 v135, v118, v119
  v_sub_f32 v139, v118, v119
  v_add_f32 v132, v132, v133
  v_add_f32 v134, v134, v135
  v_sub_f32 v136, v136, v137
  v_sub_f32 v138, v138, v139
  v_add_f32 v140, v132, v134
  v_sub_f32 v141, v132, v134
  v_sub_f32 v142, v136, v138
  v_add_f32 v143, v136, v138
  v_lshlrev_b32 v9, 2, v17
  v_add_u32 v9, 147712, v9
  v_add_f32 v200, v200, v140
  v_add_f32 v202, v202, v141
  s_mov_b64 exec, s[6:7]
  ds_write_b32 v9, v140 offset:0
  ds_write_b32 v9, v141 offset:64
  ds_write_b32 v9, v142 offset:128
  ds_write_b32 v9, v143 offset:192
  s_mov_b64 exec, -1
  s_waitcnt lgkmcnt(0)
  s_barrier
  v_and_b32 v18, 15, v0
  v_lshrrev_b32 v19, 4, v0
  v_xor_b32 v9, v18, v19
  v_lshlrev_b32 v9, 4, v9
  v_lshl_add_u32 v9, v18, 9, v9
  s_lshl_b32 s40, s58, 14
  v_add_u32 v9, s40, v9
  v_xor_b32 v12, 0, v9
  v_xor_b32 v13, 64, v9
  v_xor_b32 v14, 128, v9
  v_xor_b32 v15, 192, v9
  ds_read_b128 v[32:35], v12 offset:0
  ds_read_b128 v[36:39], v13 offset:0
  ds_read_b128 v[40:43], v14 offset:0
  ds_read_b128 v[44:47], v15 offset:0
  ds_read_b128 v[48:51], v12 offset:256
  ds_read_b128 v[52:55], v13 offset:256
  ds_read_b128 v[56:59], v14 offset:256
  ds_read_b128 v[60:63], v15 offset:256
  ds_read_b128 v[64:67], v12 offset:8192
  ds_read_b128 v[68:71], v13 offset:8192
  ds_read_b128 v[72:75], v14 offset:8192
  ds_read_b128 v[76:79], v15 offset:8192
  ds_read_b128 v[80:83], v12 offset:8448
  ds_read_b128 v[84:87], v13 offset:8448
  ds_read_b128 v[88:91], v14 offset:8448
  ds_read_b128 v[92:95], v15 offset:8448
  s_and_b32 s40, s58, 2
  s_lshl_b32 s40, s40, 6
  s_add_u32 s40, s40, 147712
  v_lshlrev_b32 v11, 4, v19
  v_add_u32 v11, s40, v11
  ds_read_b128 v[208:211], v11
  ds_read_b128 v[212:215], v11 offset:64
  s_waitcnt lgkmcnt(0)
  s_barrier
  s_add_u32 m0, s31, 0
  s_nop 0
  buffer_load_dwordx4 v20, s[44:47], s30 offen offset:0 lds
  buffer_load_dwordx4 v21, s[44:47], s30 offen offset:1024 lds
  buffer_load_dwordx4 v22, s[44:47], s30 offen offset:2048 lds
  buffer_load_dwordx4 v23, s[44:47], s30 offen offset:3072 lds
  s_add_u32 m0, s31, 4096
  s_nop 0
  buffer_load_dwordx4 v24, s[44:47], s30 offen offset:0 lds
  buffer_load_dwordx4 v25, s[44:47], s30 offen offset:1024 lds
  buffer_load_dwordx4 v26, s[44:47], s30 offen offset:2048 lds
  buffer_load_dwordx4 v27, s[44:47], s30 offen offset:3072 lds
  s_add_u32 s30, s30, 65536
  s_xor_b32 s31, s31, 65536
  v_sub_f32 v200, v200, v201
  v_sub_f32 v201, v202, v203
  s_nop 2
  v_add_f32_dpp v252, v252, v252 row_ror:8 row_mask:0xf bank_mask:0xf
  v_add_f32_dpp v253, v253, v253 row_ror:8 row_mask:0xf bank_mask:0xf
  v_add_f32_dpp v254, v254, v254 row_ror:8 row_mask:0xf bank_mask:0xf
  v_add_f32_dpp v255, v255, v255 row_ror:8 row_mask:0xf bank_mask:0xf
  v_add_f32_dpp v200, v200, v200 row_ror:8 row_mask:0xf bank_mask:0xf
  v_add_f32_dpp v201, v201, v201 row_ror:8 row_mask:0xf bank_mask:0xf
  v_add_f32_dpp v252, v252, v252 row_ror:4 row_mask:0xf bank_mask:0xf
  v_add_f32_dpp v253, v253, v253 row_ror:4 row_mask:0xf bank_mask:0xf
  v_add_f32_dpp v254, v254, v254 row_ror:4 row_mask:0xf bank_mask:0xf
  v_add_f32_dpp v255, v255, v255 row_ror:4 row_mask:0xf bank_mask:0xf
  v_add_f32_dpp v200, v200, v200 row_ror:4 row_mask:0xf bank_mask:0xf
  v_add_f32_dpp v201, v201, v201 row_ror:4 row_mask:0xf bank_mask:0xf
  v_add_f32_dpp v252, v252, v252 row_ror:2 row_mask:0xf bank_mask:0xf
  v_add_f32_dpp v253, v253, v253 row_ror:2 row_mask:0xf bank_mask:0xf
  v_add_f32_dpp v254, v254, v254 row_ror:2 row_mask:0xf bank_mask:0xf
  v_add_f32_dpp v255, v255, v255 row_ror:2 row_mask:0xf bank_mask:0xf
  v_add_f32_dpp v200, v200, v200 row_ror:2 row_mask:0xf bank_mask:0xf
  v_add_f32_dpp v201, v201, v201 row_ror:2 row_mask:0xf bank_mask:0xf
  v_add_f32_dpp v252, v252, v252 row_ror:1 row_mask:0xf bank_mask:0xf
  v_add_f32_dpp v253, v253, v253 row_ror:1 row_mask:0xf bank_mask:0xf
  v_add_f32_dpp v254, v254, v254 row_ror:1 row_mask:0xf bank_mask:0xf
  v_add_f32_dpp v255, v255, v255 row_ror:1 row_mask:0xf bank_mask:0xf
  v_add_f32_dpp v200, v200, v200 row_ror:1 row_mask:0xf bank_mask:0xf
  v_add_f32_dpp v201, v201, v201 row_ror:1 row_mask:0xf bank_mask:0xf
  v_mov_b32 v160, v252
  v_mov_b32 v161, v253
  v_mov_b32 v162, v254
  v_mov_b32 v163, v255
  v_mov_b32 v164, v200
  v_mov_b32 v165, v201
  s_nop 1
  v_permlane16_swap_b32 v252, v160
  v_permlane16_swap_b32 v253, v161
  v_permlane16_swap_b32 v254, v162
  v_permlane16_swap_b32 v255, v163
  v_permlane16_swap_b32 v200, v164
  v_permlane16_swap_b32 v201, v165
  v_add_f32 v252, v252, v160
  v_add_f32 v253, v253, v161
  v_add_f32 v254, v254, v162
  v_add_f32 v255, v255, v163
  v_add_f32 v200, v200, v164
  v_add_f32 v201, v201, v165
  v_cvt_pk_bf16_f32 v200, v200, v200
  v_cvt_pk_bf16_f32 v201, v201, v201
  v_mul_f32 v252, 0xbfb8aa3b, v252
  v_mul_f32 v253, 0xbfb8aa3b, v253
  v_mul_f32 v254, 0xbfb8aa3b, v254
  v_mul_f32 v255, 0xbfb8aa3b, v255
  v_exp_f32 v252, v252
  v_exp_f32 v253, v253
  v_exp_f32 v254, v254
  v_exp_f32 v255, v255
  s_nop 0
  v_add_f32 v252, 1.0, v252
  v_add_f32 v253, 1.0, v253
  v_add_f32 v254, 1.0, v254
  v_add_f32 v255, 1.0, v255
  v_rcp_f32 v252, v252
  v_rcp_f32 v253, v253
  v_rcp_f32 v254, v254
  v_rcp_f32 v255, v255
  s_nop 0
  v_lshlrev_b32 v9, 2, v17
  v_add_u32 v9, 147968, v9
  v_lshlrev_b32 v11, 1, v17
  v_add_u32 v11, 148224, v11
  s_mov_b64 exec, s[62:63]
  ds_write_b32 v9, v252 offset:0
  ds_write_b32 v9, v253 offset:64
  ds_write_b32 v9, v254 offset:128
  ds_write_b32 v9, v255 offset:192
  ds_write_b16 v11, v200 offset:0
  ds_write_b16 v11, v201 offset:32
  s_mov_b64 exec, -1
  s_mov_b32 s40, 0
  s_cmp_eq_u32 s58, 0
  s_cmov_b32 s40, 1.0
  s_mov_b32 s41, s40
  s_cmp_eq_u32 s58, 3
  s_cmov_b32 s40, -1.0
  s_cmov_b32 s41, 1.0
  v_and_b32 v11, 1, v0
  v_lshlrev_b32 v11, 31, v11
  v_or_b32 v11, 0x3f800000, v11
  v_mul_f32 v9, s41, v11
  v_mul_f32 v11, s40, v11
  s_lshl_b32 s40, s58, 14
  s_lshl_b32 s41, s5, 13
  s_add_u32 s41, s41, 65536
  s_sub_u32 s40, s41, s40
  s_cmp_lt_u32 s58, 2
  s_mov_b32 s42, 0x8000
  s_cmov_b32 s42, 0x80000000
  v_add_u32 v12, s40, v12
  v_add_u32 v13, s40, v13
  v_add_u32 v14, s40, v14
  v_add_u32 v15, s40, v15
  v_mul_f32 v216, v9, v208
  v_mul_f32 v208, v11, v208
  v_mul_f32 v217, v9, v209
  v_mul_f32 v209, v11, v209
  v_mul_f32 v218, v9, v210
  v_mul_f32 v210, v11, v210
  v_mul_f32 v219, v9, v211
  v_mul_f32 v211, v11, v211
  v_mul_f32 v220, v9, v212
  v_mul_f32 v212, v11, v212
  v_mul_f32 v221, v9, v213
  v_mul_f32 v213, v11, v213
  v_mul_f32 v222, v9, v214
  v_mul_f32 v214, v11, v214
  v_mul_f32 v223, v9, v215
  v_mul_f32 v215, v11, v215
  v_xor_b32 v96, s42, v32
  v_xor_b32 v97, s42, v33
  v_xor_b32 v98, s42, v34
  v_xor_b32 v99, s42, v35
  v_xor_b32 v100, s42, v36
  v_xor_b32 v101, s42, v37
  v_xor_b32 v102, s42, v38
  v_xor_b32 v103, s42, v39
  v_xor_b32 v104, s42, v40
  v_xor_b32 v105, s42, v41
  v_xor_b32 v106, s42, v42
  v_xor_b32 v107, s42, v43
  v_xor_b32 v108, s42, v44
  v_xor_b32 v109, s42, v45
  v_xor_b32 v110, s42, v46
  v_xor_b32 v111, s42, v47
  v_xor_b32 v112, s42, v48
  v_xor_b32 v113, s42, v49
  v_xor_b32 v114, s42, v50
  v_xor_b32 v115, s42, v51
  v_xor_b32 v116, s42, v52
  v_xor_b32 v117, s42, v53
  v_xor_b32 v118, s42, v54
  v_xor_b32 v119, s42, v55
  v_xor_b32 v120, s42, v56
  v_xor_b32 v121, s42, v57
  v_xor_b32 v122, s42, v58
  v_xor_b32 v123, s42, v59
  v_xor_b32 v124, s42, v60
  v_xor_b32 v125, s42, v61
  v_xor_b32 v126, s42, v62
  v_xor_b32 v127, s42, v63
  v_xor_b32 v128, s42, v64
  v_xor_b32 v129, s42, v65
  v_xor_b32 v130, s42, v66
  v_xor_b32 v131, s42, v67
  v_xor_b32 v132, s42, v68
  v_xor_b32 v133, s42, v69
  v_xor_b32 v134, s42, v70
  v_xor_b32 v135, s42, v71
  v_xor_b32 v136, s42, v72
  v_xor_b32 v137, s42, v73
  v_xor_b32 v138, s42, v74
  v_xor_b32 v139, s42, v75
  v_xor_b32 v140, s42, v76
  v_xor_b32 v141, s42, v77
  v_xor_b32 v142, s42, v78
  v_xor_b32 v143, s42, v79
  v_xor_b32 v144, s42, v80
  v_xor_b32 v145, s42, v81
  v_xor_b32 v146, s42, v82
  v_xor_b32 v147, s42, v83
  v_xor_b32 v148, s42, v84
  v_xor_b32 v149, s42, v85
  v_xor_b32 v150, s42, v86
  v_xor_b32 v151, s42, v87
  v_xor_b32 v152, s42, v88
  v_xor_b32 v153, s42, v89
  v_xor_b32 v154, s42, v90
  v_xor_b32 v155, s42, v91
  v_xor_b32 v156, s42, v92
  v_xor_b32 v157, s42, v93
  v_xor_b32 v158, s42, v94
  v_xor_b32 v159, s42, v95
  s_and_b32 s40, s58, 1
  s_lshl_b32 s40, s40, 1
  v_xor_b32 v16, s40, v18
  v_lshlrev_b32 v16, 5, v16
  v_lshrrev_b32 v9, 1, v19
  v_lshl_add_u32 v16, v9, 4, v16
  v_and_b32 v9, 1, v19
  v_lshl_add_u32 v16, v9, 19, v16
  v_xor_b32 v17, 480, v16
  s_lshr_b32 s32, s58, 1
  s_lshl_b32 s32, s32, 20
  s_lshl_b32 s40, s57, 12
  s_add_u32 s32, s32, s40
  s_and_b32 s40, s58, 1
  s_lshl_b32 s40, s40, 11
  s_add_u32 s32, s32, s40
  s_add_u32 s32, s32, 26214400
  s_lshl_b32 s40, s59, 17
  s_sub_u32 s33, s32, s40
  s_add_u32 s33, s33, 393216
  s_add_u32 s32, s32, s40
  s_waitcnt vmcnt(8)
  ds_read_b128 v[160:163], v12 offset:0
  ds_read_b128 v[164:167], v13 offset:0
  ds_read_b128 v[168:171], v14 offset:0
  ds_read_b128 v[172:175], v15 offset:0
  ds_read_b128 v[176:179], v12 offset:256
  ds_read_b128 v[180:183], v13 offset:256
  ds_read_b128 v[184:187], v14 offset:256
  ds_read_b128 v[188:191], v15 offset:256
  s_waitcnt lgkmcnt(0)
  s_add_u32 m0, s31, 0
  s_nop 0
  buffer_load_dwordx4 v20, s[44:47], s30 offen offset:0 lds
  buffer_load_dwordx4 v21, s[44:47], s30 offen offset:1024 lds
  buffer_load_dwordx4 v22, s[44:47], s30 offen offset:2048 lds
  buffer_load_dwordx4 v23, s[44:47], s30 offen offset:3072 lds
  s_add_u32 m0, s31, 4096
  s_nop 0
  buffer_load_dwordx4 v24, s[44:47], s30 offen offset:0 lds
  buffer_load_dwordx4 v25, s[44:47], s30 offen offset:1024 lds
  buffer_load_dwordx4 v26, s[44:47], s30 offen offset:2048 lds
  buffer_load_dwordx4 v27, s[44:47], s30 offen offset:3072 lds
  s_add_u32 s30, s30, 65536
  s_xor_b32 s31, s31, 65536
  v_mfma_f32_16x16x32_bf16 v[192:195], v[32:35], v[160:163], v[208:211]
  v_mfma_f32_16x16x32_bf16 v[200:203], v[96:99], v[160:163], v[216:219]
  v_mfma_f32_16x16x32_bf16 v[196:199], v[64:67], v[160:163], v[212:215]
  v_mfma_f32_16x16x32_bf16 v[204:207], v[128:131], v[160:163], v[220:223]
  v_mfma_f32_16x16x32_bf16 v[192:195], v[36:39], v[164:167], v[192:195]
  v_mfma_f32_16x16x32_bf16 v[200:203], v[100:103], v[164:167], v[200:203]
  v_mfma_f32_16x16x32_bf16 v[196:199], v[68:71], v[164:167], v[196:199]
  v_mfma_f32_16x16x32_bf16 v[204:207], v[132:135], v[164:167], v[204:207]
  v_mfma_f32_16x16x32_bf16 v[192:195], v[40:43], v[168:171], v[192:195]
  v_mfma_f32_16x16x32_bf16 v[200:203], v[104:107], v[168:171], v[200:203]
  v_mfma_f32_16x16x32_bf16 v[196:199], v[72:75], v[168:171], v[196:199]
  v_mfma_f32_16x16x32_bf16 v[204:207], v[136:139], v[168:171], v[204:207]
  v_mfma_f32_16x16x32_bf16 v[192:195], v[44:47], v[172:175], v[192:195]
  v_mfma_f32_16x16x32_bf16 v[200:203], v[108:111], v[172:175], v[200:203]
  v_mfma_f32_16x16x32_bf16 v[196:199], v[76:79], v[172:175], v[196:199]
  v_mfma_f32_16x16x32_bf16 v[204:207], v[140:143], v[172:175], v[204:207]
  v_mfma_f32_16x16x32_bf16 v[192:195], v[48:51], v[176:179], v[192:195]
  v_mfma_f32_16x16x32_bf16 v[200:203], v[112:115], v[176:179], v[200:203]
  v_mfma_f32_16x16x32_bf16 v[196:199], v[80:83], v[176:179], v[196:199]
  v_mfma_f32_16x16x32_bf16 v[204:207], v[144:147], v[176:179], v[204:207]
  v_mfma_f32_16x16x32_bf16 v[192:195], v[52:55], v[180:183], v[192:195]
  v_mfma_f32_16x16x32_bf16 v[200:203], v[116:119], v[180:183], v[200:203]
  v_mfma_f32_16x16x32_bf16 v[196:199], v[84:87], v[180:183], v[196:199]
  v_mfma_f32_16x16x32_bf16 v[204:207], v[148:151], v[180:183], v[204:207]
  v_mfma_f32_16x16x32_bf16 v[192:195], v[56:59], v[184:187], v[192:195]
  v_mfma_f32_16x16x32_bf16 v[200:203], v[120:123], v[184:187], v[200:203]
  v_mfma_f32_16x16x32_bf16 v[196:199], v[88:91], v[184:187], v[196:199]
  v_mfma_f32_16x16x32_bf16 v[204:207], v[152:155], v[184:187], v[204:207]
  v_mfma_f32_16x16x32_bf16 v[192:195], v[60:63], v[188:191], v[192:195]
  v_mfma_f32_16x16x32_bf16 v[200:203], v[124:127], v[188:191], v[200:203]
  v_mfma_f32_16x16x32_bf16 v[196:199], v[92:95], v[188:191], v[196:199]
  v_mfma_f32_16x16x32_bf16 v[204:207], v[156:159], v[188:191], v[204:207]
  v_xor_b32 v12, 0x10000, v12
  v_xor_b32 v13, 0x10000, v13
  v_xor_b32 v14, 0x10000, v14
  v_xor_b32 v15, 0x10000, v15
  s_waitcnt vmcnt(8)
  s_nop 7
  v_cvt_pk_bf16_f32 v224, v192, v193
  v_cvt_pk_bf16_f32 v240, v200, v201
  v_cvt_pk_bf16_f32 v225, v194, v195
  v_cvt_pk_bf16_f32 v241, v202, v203
  v_cvt_pk_bf16_f32 v226, v196, v197
  v_cvt_pk_bf16_f32 v242, v204, v205
  v_cvt_pk_bf16_f32 v227, v198, v199
  v_cvt_pk_bf16_f32 v243, v206, v207
  ds_read_b128 v[160:163], v12 offset:0
  ds_read_b128 v[164:167], v13 offset:0
  ds_read_b128 v[168:171], v14 offset:0
  ds_read_b128 v[172:175], v15 offset:0
  ds_read_b128 v[176:179], v12 offset:256
  ds_read_b128 v[180:183], v13 offset:256
  ds_read_b128 v[184:187], v14 offset:256
  ds_read_b128 v[188:191], v15 offset:256
  s_waitcnt lgkmcnt(0)
  s_add_u32 m0, s31, 0
  s_nop 0
  buffer_load_dwordx4 v20, s[44:47], s30 offen offset:0 lds
  buffer_load_dwordx4 v21, s[44:47], s30 offen offset:1024 lds
  buffer_load_dwordx4 v22, s[44:47], s30 offen offset:2048 lds
  buffer_load_dwordx4 v23, s[44:47], s30 offen offset:3072 lds
  s_add_u32 m0, s31, 4096
  s_nop 0
  buffer_load_dwordx4 v24, s[44:47], s30 offen offset:0 lds
  buffer_load_dwordx4 v25, s[44:47], s30 offen offset:1024 lds
  buffer_load_dwordx4 v26, s[44:47], s30 offen offset:2048 lds
  buffer_load_dwordx4 v27, s[44:47], s30 offen offset:3072 lds
  s_add_u32 s30, s30, 65536
  s_xor_b32 s31, s31, 65536
  v_mfma_f32_16x16x32_bf16 v[192:195], v[32:35], v[160:163], v[208:211]
  v_mfma_f32_16x16x32_bf16 v[200:203], v[96:99], v[160:163], v[216:219]
  v_mfma_f32_16x16x32_bf16 v[196:199], v[64:67], v[160:163], v[212:215]
  v_mfma_f32_16x16x32_bf16 v[204:207], v[128:131], v[160:163], v[220:223]
  v_mfma_f32_16x16x32_bf16 v[192:195], v[36:39], v[164:167], v[192:195]
  v_mfma_f32_16x16x32_bf16 v[200:203], v[100:103], v[164:167], v[200:203]
  v_mfma_f32_16x16x32_bf16 v[196:199], v[68:71], v[164:167], v[196:199]
  v_mfma_f32_16x16x32_bf16 v[204:207], v[132:135], v[164:167], v[204:207]
  v_mfma_f32_16x16x32_bf16 v[192:195], v[40:43], v[168:171], v[192:195]
  v_mfma_f32_16x16x32_bf16 v[200:203], v[104:107], v[168:171], v[200:203]
  v_mfma_f32_16x16x32_bf16 v[196:199], v[72:75], v[168:171], v[196:199]
  v_mfma_f32_16x16x32_bf16 v[204:207], v[136:139], v[168:171], v[204:207]
  v_mfma_f32_16x16x32_bf16 v[192:195], v[44:47], v[172:175], v[192:195]
  v_mfma_f32_16x16x32_bf16 v[200:203], v[108:111], v[172:175], v[200:203]
  v_mfma_f32_16x16x32_bf16 v[196:199], v[76:79], v[172:175], v[196:199]
  v_mfma_f32_16x16x32_bf16 v[204:207], v[140:143], v[172:175], v[204:207]
  v_mfma_f32_16x16x32_bf16 v[192:195], v[48:51], v[176:179], v[192:195]
  v_mfma_f32_16x16x32_bf16 v[200:203], v[112:115], v[176:179], v[200:203]
  v_mfma_f32_16x16x32_bf16 v[196:199], v[80:83], v[176:179], v[196:199]
  v_mfma_f32_16x16x32_bf16 v[204:207], v[144:147], v[176:179], v[204:207]
  v_mfma_f32_16x16x32_bf16 v[192:195], v[52:55], v[180:183], v[192:195]
  v_mfma_f32_16x16x32_bf16 v[200:203], v[116:119], v[180:183], v[200:203]
  v_mfma_f32_16x16x32_bf16 v[196:199], v[84:87], v[180:183], v[196:199]
  v_mfma_f32_16x16x32_bf16 v[204:207], v[148:151], v[180:183], v[204:207]
  v_mfma_f32_16x16x32_bf16 v[192:195], v[56:59], v[184:187], v[192:195]
  v_mfma_f32_16x16x32_bf16 v[200:203], v[120:123], v[184:187], v[200:203]
  v_mfma_f32_16x16x32_bf16 v[196:199], v[88:91], v[184:187], v[196:199]
  v_mfma_f32_16x16x32_bf16 v[204:207], v[152:155], v[184:187], v[204:207]
  v_mfma_f32_16x16x32_bf16 v[192:195], v[60:63], v[188:191], v[192:195]
  v_mfma_f32_16x16x32_bf16 v[200:203], v[124:127], v[188:191], v[200:203]
  v_mfma_f32_16x16x32_bf16 v[196:199], v[92:95], v[188:191], v[196:199]
  v_mfma_f32_16x16x32_bf16 v[204:207], v[156:159], v[188:191], v[204:207]
  v_xor_b32 v12, 0x10000, v12
  v_xor_b32 v13, 0x10000, v13
  v_xor_b32 v14, 0x10000, v14
  v_xor_b32 v15, 0x10000, v15
  s_waitcnt vmcnt(8)
  s_nop 7
  v_cvt_pk_bf16_f32 v228, v192, v193
  v_cvt_pk_bf16_f32 v244, v200, v201
  v_cvt_pk_bf16_f32 v229, v194, v195
  v_cvt_pk_bf16_f32 v245, v202, v203
  v_cvt_pk_bf16_f32 v230, v196, v197
  v_cvt_pk_bf16_f32 v246, v204, v205
  v_cvt_pk_bf16_f32 v231, v198, v199
  v_cvt_pk_bf16_f32 v247, v206, v207
  ds_read_b128 v[160:163], v12 offset:0
  ds_read_b128 v[164:167], v13 offset:0
  ds_read_b128 v[168:171], v14 offset:0
  ds_read_b128 v[172:175], v15 offset:0
  ds_read_b128 v[176:179], v12 offset:256
  ds_read_b128 v[180:183], v13 offset:256
  ds_read_b128 v[184:187], v14 offset:256
  ds_read_b128 v[188:191], v15 offset:256
  s_waitcnt lgkmcnt(0)
  v_mfma_f32_16x16x32_bf16 v[192:195], v[32:35], v[160:163], v[208:211]
  v_mfma_f32_16x16x32_bf16 v[200:203], v[96:99], v[160:163], v[216:219]
  v_mfma_f32_16x16x32_bf16 v[196:199], v[64:67], v[160:163], v[212:215]
  v_mfma_f32_16x16x32_bf16 v[204:207], v[128:131], v[160:163], v[220:223]
  v_mfma_f32_16x16x32_bf16 v[192:195], v[36:39], v[164:167], v[192:195]
  v_mfma_f32_16x16x32_bf16 v[200:203], v[100:103], v[164:167], v[200:203]
  v_mfma_f32_16x16x32_bf16 v[196:199], v[68:71], v[164:167], v[196:199]
  v_mfma_f32_16x16x32_bf16 v[204:207], v[132:135], v[164:167], v[204:207]
  v_mfma_f32_16x16x32_bf16 v[192:195], v[40:43], v[168:171], v[192:195]
  v_mfma_f32_16x16x32_bf16 v[200:203], v[104:107], v[168:171], v[200:203]
  v_mfma_f32_16x16x32_bf16 v[196:199], v[72:75], v[168:171], v[196:199]
  v_mfma_f32_16x16x32_bf16 v[204:207], v[136:139], v[168:171], v[204:207]
  v_mfma_f32_16x16x32_bf16 v[192:195], v[44:47], v[172:175], v[192:195]
  v_mfma_f32_16x16x32_bf16 v[200:203], v[108:111], v[172:175], v[200:203]
  v_mfma_f32_16x16x32_bf16 v[196:199], v[76:79], v[172:175], v[196:199]
  v_mfma_f32_16x16x32_bf16 v[204:207], v[140:143], v[172:175], v[204:207]
  v_mfma_f32_16x16x32_bf16 v[192:195], v[48:51], v[176:179], v[192:195]
  v_mfma_f32_16x16x32_bf16 v[200:203], v[112:115], v[176:179], v[200:203]
  v_mfma_f32_16x16x32_bf16 v[196:199], v[80:83], v[176:179], v[196:199]
  v_mfma_f32_16x16x32_bf16 v[204:207], v[144:147], v[176:179], v[204:207]
  v_mfma_f32_16x16x32_bf16 v[192:195], v[52:55], v[180:183], v[192:195]
  v_mfma_f32_16x16x32_bf16 v[200:203], v[116:119], v[180:183], v[200:203]
  v_mfma_f32_16x16x32_bf16 v[196:199], v[84:87], v[180:183], v[196:199]
  v_mfma_f32_16x16x32_bf16 v[204:207], v[148:151], v[180:183], v[204:207]
  v_mfma_f32_16x16x32_bf16 v[192:195], v[56:59], v[184:187], v[192:195]
  v_mfma_f32_16x16x32_bf16 v[200:203], v[120:123], v[184:187], v[200:203]
  v_mfma_f32_16x16x32_bf16 v[196:199], v[88:91], v[184:187], v[196:199]
  v_mfma_f32_16x16x32_bf16 v[204:207], v[152:155], v[184:187], v[204:207]
  v_mfma_f32_16x16x32_bf16 v[192:195], v[60:63], v[188:191], v[192:195]
  v_mfma_f32_16x16x32_bf16 v[200:203], v[124:127], v[188:191], v[200:203]
  v_mfma_f32_16x16x32_bf16 v[196:199], v[92:95], v[188:191], v[196:199]
  v_mfma_f32_16x16x32_bf16 v[204:207], v[156:159], v[188:191], v[204:207]
  v_xor_b32 v12, 0x10000, v12
  v_xor_b32 v13, 0x10000, v13
  v_xor_b32 v14, 0x10000, v14
  v_xor_b32 v15, 0x10000, v15
  s_waitcnt vmcnt(0)
  s_nop 7
  v_cvt_pk_bf16_f32 v232, v192, v193
  v_cvt_pk_bf16_f32 v248, v200, v201
  v_cvt_pk_bf16_f32 v233, v194, v195
  v_cvt_pk_bf16_f32 v249, v202, v203
  v_cvt_pk_bf16_f32 v234, v196, v197
  v_cvt_pk_bf16_f32 v250, v204, v205
  v_cvt_pk_bf16_f32 v235, v198, v199
  v_cvt_pk_bf16_f32 v251, v206, v207
  ds_read_b128 v[160:163], v12 offset:0
  ds_read_b128 v[164:167], v13 offset:0
  ds_read_b128 v[168:171], v14 offset:0
  ds_read_b128 v[172:175], v15 offset:0
  ds_read_b128 v[176:179], v12 offset:256
  ds_read_b128 v[180:183], v13 offset:256
  ds_read_b128 v[184:187], v14 offset:256
  ds_read_b128 v[188:191], v15 offset:256
  s_waitcnt lgkmcnt(0)
  v_mfma_f32_16x16x32_bf16 v[192:195], v[32:35], v[160:163], v[208:211]
  v_mfma_f32_16x16x32_bf16 v[200:203], v[96:99], v[160:163], v[216:219]
  v_mfma_f32_16x16x32_bf16 v[196:199], v[64:67], v[160:163], v[212:215]
  v_mfma_f32_16x16x32_bf16 v[204:207], v[128:131], v[160:163], v[220:223]
  v_mfma_f32_16x16x32_bf16 v[192:195], v[36:39], v[164:167], v[192:195]
  v_mfma_f32_16x16x32_bf16 v[200:203], v[100:103], v[164:167], v[200:203]
  v_mfma_f32_16x16x32_bf16 v[196:199], v[68:71], v[164:167], v[196:199]
  v_mfma_f32_16x16x32_bf16 v[204:207], v[132:135], v[164:167], v[204:207]
  v_mfma_f32_16x16x32_bf16 v[192:195], v[40:43], v[168:171], v[192:195]
  v_mfma_f32_16x16x32_bf16 v[200:203], v[104:107], v[168:171], v[200:203]
  v_mfma_f32_16x16x32_bf16 v[196:199], v[72:75], v[168:171], v[196:199]
  v_mfma_f32_16x16x32_bf16 v[204:207], v[136:139], v[168:171], v[204:207]
  v_mfma_f32_16x16x32_bf16 v[192:195], v[44:47], v[172:175], v[192:195]
  v_mfma_f32_16x16x32_bf16 v[200:203], v[108:111], v[172:175], v[200:203]
  v_mfma_f32_16x16x32_bf16 v[196:199], v[76:79], v[172:175], v[196:199]
  v_mfma_f32_16x16x32_bf16 v[204:207], v[140:143], v[172:175], v[204:207]
  v_mfma_f32_16x16x32_bf16 v[192:195], v[48:51], v[176:179], v[192:195]
  v_mfma_f32_16x16x32_bf16 v[200:203], v[112:115], v[176:179], v[200:203]
  v_mfma_f32_16x16x32_bf16 v[196:199], v[80:83], v[176:179], v[196:199]
  v_mfma_f32_16x16x32_bf16 v[204:207], v[144:147], v[176:179], v[204:207]
  v_mfma_f32_16x16x32_bf16 v[192:195], v[52:55], v[180:183], v[192:195]
  v_mfma_f32_16x16x32_bf16 v[200:203], v[116:119], v[180:183], v[200:203]
  v_mfma_f32_16x16x32_bf16 v[196:199], v[84:87], v[180:183], v[196:199]
  v_mfma_f32_16x16x32_bf16 v[204:207], v[148:151], v[180:183], v[204:207]
  v_mfma_f32_16x16x32_bf16 v[192:195], v[56:59], v[184:187], v[192:195]
  v_mfma_f32_16x16x32_bf16 v[200:203], v[120:123], v[184:187], v[200:203]
  v_mfma_f32_16x16x32_bf16 v[196:199], v[88:91], v[184:187], v[196:199]
  v_mfma_f32_16x16x32_bf16 v[204:207], v[152:155], v[184:187], v[204:207]
  v_mfma_f32_16x16x32_bf16 v[192:195], v[60:63], v[188:191], v[192:195]
  v_mfma_f32_16x16x32_bf16 v[200:203], v[124:127], v[188:191], v[200:203]
  v_mfma_f32_16x16x32_bf16 v[196:199], v[92:95], v[188:191], v[196:199]
  v_mfma_f32_16x16x32_bf16 v[204:207], v[156:159], v[188:191], v[204:207]
  v_xor_b32 v12, 0x10000, v12
  v_xor_b32 v13, 0x10000, v13
  v_xor_b32 v14, 0x10000, v14
  v_xor_b32 v15, 0x10000, v15
  s_nop 7
  v_cvt_pk_bf16_f32 v236, v192, v193
  v_cvt_pk_bf16_f32 v252, v200, v201
  v_cvt_pk_bf16_f32 v237, v194, v195
  v_cvt_pk_bf16_f32 v253, v202, v203
  v_cvt_pk_bf16_f32 v238, v196, v197
  v_cvt_pk_bf16_f32 v254, v204, v205
  v_cvt_pk_bf16_f32 v239, v198, v199
  v_cvt_pk_bf16_f32 v255, v206, v207
  s_mul_i32 s40, s5, -7168
  s_add_u32 s40, s40, 65536
  v_add_u32 v12, s40, v12
  v_add_u32 v13, s40, v13
  v_add_u32 v14, s40, v14
  v_add_u32 v15, s40, v15
  ds_read_b128 v[160:163], v12 offset:0
  ds_read_b128 v[164:167], v13 offset:0
  ds_read_b128 v[168:171], v14 offset:0
  ds_read_b128 v[172:175], v15 offset:0
  ds_read_b128 v[176:179], v12 offset:256
  ds_read_b128 v[180:183], v13 offset:256
  ds_read_b128 v[184:187], v14 offset:256
  ds_read_b128 v[188:191], v15 offset:256
  s_waitcnt lgkmcnt(0)
  v_mfma_f32_16x16x32_bf16 v[200:203], v[96:99], v[160:163], v[216:219]
  v_mfma_f32_16x16x32_bf16 v[204:207], v[128:131], v[160:163], v[220:223]
  v_mfma_f32_16x16x32_bf16 v[200:203], v[100:103], v[164:167], v[200:203]
  v_mfma_f32_16x16x32_bf16 v[204:207], v[132:135], v[164:167], v[204:207]
  v_mfma_f32_16x16x32_bf16 v[200:203], v[104:107], v[168:171], v[200:203]
  v_mfma_f32_16x16x32_bf16 v[204:207], v[136:139], v[168:171], v[204:207]
  v_mfma_f32_16x16x32_bf16 v[200:203], v[108:111], v[172:175], v[200:203]
  v_mfma_f32_16x16x32_bf16 v[204:207], v[140:143], v[172:175], v[204:207]
  v_mfma_f32_16x16x32_bf16 v[200:203], v[112:115], v[176:179], v[200:203]
  v_mfma_f32_16x16x32_bf16 v[204:207], v[144:147], v[176:179], v[204:207]
  v_mfma_f32_16x16x32_bf16 v[200:203], v[116:119], v[180:183], v[200:203]
  v_mfma_f32_16x16x32_bf16 v[204:207], v[148:151], v[180:183], v[204:207]
  v_mfma_f32_16x16x32_bf16 v[200:203], v[120:123], v[184:187], v[200:203]
  v_mfma_f32_16x16x32_bf16 v[204:207], v[152:155], v[184:187], v[204:207]
  v_mfma_f32_16x16x32_bf16 v[200:203], v[124:127], v[188:191], v[200:203]
  v_mfma_f32_16x16x32_bf16 v[204:207], v[156:159], v[188:191], v[204:207]
  s_nop 7
  v_cvt_pk_bf16_f32 v28, v200, v201
  v_cvt_pk_bf16_f32 v29, v202, v203
  v_cvt_pk_bf16_f32 v30, v204, v205
  v_cvt_pk_bf16_f32 v31, v206, v207
  s_and_b32 s40, s58, 1
  s_cmp_lg_u32 s40, 0
  s_cbranch_scc1 L_noshift
  s_mov_b32 s40, 0x00010001
  s_mov_b32 s41, 0x00010001
  v_cndmask_b32 v240, v240, v244, s[40:41]
  v_cndmask_b32 v241, v241, v245, s[40:41]
  v_cndmask_b32 v242, v242, v246, s[40:41]
  v_cndmask_b32 v243, v243, v247, s[40:41]
  v_cndmask_b32 v244, v244, v248, s[40:41]
  v_cndmask_b32 v245, v245, v249, s[40:41]
  v_cndmask_b32 v246, v246, v250, s[40:41]
  v_cndmask_b32 v247, v247, v251, s[40:41]
  v_cndmask_b32 v248, v248, v252, s[40:41]
  v_cndmask_b32 v249, v249, v253, s[40:41]
  v_cndmask_b32 v250, v250, v254, s[40:41]
  v_cndmask_b32 v251, v251, v255, s[40:41]
  v_cndmask_b32 v252, v252, v28, s[40:41]
  v_cndmask_b32 v253, v253, v29, s[40:41]
  v_cndmask_b32 v254, v254, v30, s[40:41]
  v_cndmask_b32 v255, v255, v31, s[40:41]
  s_nop 1
  v_mov_b32_dpp v240, v240 row_ror:15 row_mask:0xf bank_mask:0xf
  v_mov_b32_dpp v241, v241 row_ror:15 row_mask:0xf bank_mask:0xf
  v_mov_b32_dpp v242, v242 row_ror:15 row_mask:0xf bank_mask:0xf
  v_mov_b32_dpp v243, v243 row_ror:15 row_mask:0xf bank_mask:0xf
  v_mov_b32_dpp v244, v244 row_ror:15 row_mask:0xf bank_mask:0xf
  v_mov_b32_dpp v245, v245 row_ror:15 row_mask:0xf bank_mask:0xf
  v_mov_b32_dpp v246, v246 row_ror:15 row_mask:0xf bank_mask:0xf
  v_mov_b32_dpp v247, v247 row_ror:15 row_mask:0xf bank_mask:0xf
  v_mov_b32_dpp v248, v248 row_ror:15 row_mask:0xf bank_mask:0xf
  v_mov_b32_dpp v249, v249 row_ror:15 row_mask:0xf bank_mask:0xf
  v_mov_b32_dpp v250, v250 row_ror:15 row_mask:0xf bank_mask:0xf
  v_mov_b32_dpp v251, v251 row_ror:15 row_mask:0xf bank_mask:0xf
  v_mov_b32_dpp v252, v252 row_ror:15 row_mask:0xf bank_mask:0xf
  v_mov_b32_dpp v253, v253 row_ror:15 row_mask:0xf bank_mask:0xf
  v_mov_b32_dpp v254, v254 row_ror:15 row_mask:0xf bank_mask:0xf
  v_mov_b32_dpp v255, v255 row_ror:15 row_mask:0xf bank_mask:0xf
L_noshift:
  buffer_load_dwordx4 v[140:143], v2, s[48:51], 0 offen
  buffer_load_dwordx4 v[144:147], v3, s[48:51], 0 offen
  buffer_load_dwordx4 v[148:151], v4, s[48:51], 0 offen
  buffer_load_dwordx4 v[152:155], v5, s[48:51], 0 offen
  s_mov_b32 s40, 1048576
  buffer_load_dwordx4 v[96:99], v2, s[20:23], s40 offen
  buffer_load_dwordx4 v[100:103], v3, s[20:23], s40 offen
  buffer_load_dwordx4 v[104:107], v4, s[20:23], s40 offen
  buffer_load_dwordx4 v[108:111], v5, s[20:23], s40 offen
  s_mov_b32 s40, 3145728
  buffer_load_dwordx4 v[112:115], v2, s[20:23], s40 offen
  buffer_load_dwordx4 v[116:119], v3, s[20:23], s40 offen
  buffer_load_dwordx4 v[120:123], v4, s[20:23], s40 offen
  buffer_load_dwordx4 v[124:127], v5, s[20:23], s40 offen
  s_lshl_b32 s40, s29, 11
  v_add_u32 v11, s40, v2
  s_mov_b32 s94, 0
  s_mov_b32 s95, -1
  v_mov_b32 v20, s70
  v_mov_b32 v21, s71
  v_mov_b32 v22, s72
  v_mov_b32 v23, s73
  v_cndmask_b32 v20, v20, v22, s[94:95]
  v_cndmask_b32 v21, v21, v23, s[94:95]
  v_add_co_u32 v20, vcc, v20, v11
  s_nop 1
  v_addc_co_u32 v21, vcc, 0, v21, vcc
  global_load_dwordx4 v[128:131], v[20:21], off
  global_load_dwordx4 v[132:135], v[20:21], off offset:2048
  v_permlane16_swap_b32 v224, v226
  v_permlane16_swap_b32 v225, v227
  buffer_store_dwordx4 v[224:227], v16, s[16:19], s32 offen offset:0 sc1
  v_permlane16_swap_b32 v240, v242
  v_permlane16_swap_b32 v241, v243
  buffer_store_dwordx4 v[240:243], v17, s[16:19], s33 offen offset:1536 sc1
  v_permlane16_swap_b32 v228, v230
  v_permlane16_swap_b32 v229, v231
  buffer_store_dwordx4 v[228:231], v16, s[16:19], s32 offen offset:512 sc1
  v_permlane16_swap_b32 v244, v246
  v_permlane16_swap_b32 v245, v247
  buffer_store_dwordx4 v[244:247], v17, s[16:19], s33 offen offset:1024 sc1
  v_permlane16_swap_b32 v232, v234
  v_permlane16_swap_b32 v233, v235
  buffer_store_dwordx4 v[232:235], v16, s[16:19], s32 offen offset:1024 sc1
  v_permlane16_swap_b32 v248, v250
  v_permlane16_swap_b32 v249, v251
  buffer_store_dwordx4 v[248:251], v17, s[16:19], s33 offen offset:512 sc1
  v_permlane16_swap_b32 v236, v238
  v_permlane16_swap_b32 v237, v239
  buffer_store_dwordx4 v[236:239], v16, s[16:19], s32 offen offset:1536 sc1
  v_permlane16_swap_b32 v252, v254
  v_permlane16_swap_b32 v253, v255
  buffer_store_dwordx4 v[252:255], v17, s[16:19], s33 offen offset:0 sc1
  s_waitcnt vmcnt(8)
  v_dot2_f32_bf16 v28, v96, v140, 0
  v_dot2_f32_bf16 v28, v97, v141, v28
  v_dot2_f32_bf16 v28, v98, v142, v28
  v_dot2_f32_bf16 v28, v99, v143, v28
  v_dot2_f32_bf16 v28, v100, v144, v28
  v_dot2_f32_bf16 v28, v101, v145, v28
  v_dot2_f32_bf16 v28, v102, v146, v28
  v_dot2_f32_bf16 v28, v103, v147, v28
  v_dot2_f32_bf16 v28, v104, v148, v28
  v_dot2_f32_bf16 v28, v105, v149, v28
  v_dot2_f32_bf16 v28, v106, v150, v28
  v_dot2_f32_bf16 v28, v107, v151, v28
  v_dot2_f32_bf16 v28, v108, v152, v28
  v_dot2_f32_bf16 v28, v109, v153, v28
  v_dot2_f32_bf16 v28, v110, v154, v28
  v_dot2_f32_bf16 v28, v111, v155, v28
  ds_swizzle_b32 v100, v100 offset:0x7c1f
  ds_swizzle_b32 v101, v101 offset:0x7c1f
  ds_swizzle_b32 v102, v102 offset:0x7c1f
  ds_swizzle_b32 v103, v103 offset:0x7c1f
  ds_swizzle_b32 v104, v104 offset:0x7c1f
  ds_swizzle_b32 v105, v105 offset:0x7c1f
  ds_swizzle_b32 v106, v106 offset:0x7c1f
  ds_swizzle_b32 v107, v107 offset:0x7c1f
  v_dot2_f32_bf16 v29, v112, v140, 0
  v_dot2_f32_bf16 v29, v113, v141, v29
  v_dot2_f32_bf16 v29, v114, v142, v29
  v_dot2_f32_bf16 v29, v115, v143, v29
  v_dot2_f32_bf16 v29, v116, v144, v29
  v_dot2_f32_bf16 v29, v117, v145, v29
  v_dot2_f32_bf16 v29, v118, v146, v29
  v_dot2_f32_bf16 v29, v119, v147, v29
  v_dot2_f32_bf16 v29, v120, v148, v29
  v_dot2_f32_bf16 v29, v121, v149, v29
  v_dot2_f32_bf16 v29, v122, v150, v29
  v_dot2_f32_bf16 v29, v123, v151, v29
  v_dot2_f32_bf16 v29, v124, v152, v29
  v_dot2_f32_bf16 v29, v125, v153, v29
  v_dot2_f32_bf16 v29, v126, v154, v29
  v_dot2_f32_bf16 v29, v127, v155, v29
  ds_swizzle_b32 v116, v116 offset:0x7c1f
  ds_swizzle_b32 v117, v117 offset:0x7c1f
  ds_swizzle_b32 v118, v118 offset:0x7c1f
  ds_swizzle_b32 v119, v119 offset:0x7c1f
  ds_swizzle_b32 v120, v120 offset:0x7c1f
  ds_swizzle_b32 v121, v121 offset:0x7c1f
  ds_swizzle_b32 v122, v122 offset:0x7c1f
  ds_swizzle_b32 v123, v123 offset:0x7c1f
  s_waitcnt lgkmcnt(0)
  v_mov_b32_dpp v12, v100 wave_shr:1 row_mask:0xf bank_mask:0xf bound_ctrl:0
  v_mov_b32_dpp v13, v104 wave_shr:1 row_mask:0xf bank_mask:0xf bound_ctrl:0
  v_lshlrev_b32 v136, 16, v104
  v_lshlrev_b32 v137, 16, v100
  v_and_b32 v12, v8, v12
  v_and_b32 v13, v8, v13
  v_cndmask_b32 v136, 0, v136, s[6:7]
  v_cndmask_b32 v137, 0, v137, s[6:7]
  v_mov_b32_dpp v14, v116 wave_shr:1 row_mask:0xf bank_mask:0xf bound_ctrl:0
  v_mov_b32_dpp v15, v120 wave_shr:1 row_mask:0xf bank_mask:0xf bound_ctrl:0
  v_lshlrev_b32 v138, 16, v120
  v_lshlrev_b32 v139, 16, v116
  v_and_b32 v14, v8, v14
  v_and_b32 v15, v8, v15
  v_cndmask_b32 v138, 0, v138, s[6:7]
  v_cndmask_b32 v139, 0, v139, s[6:7]
  v_mov_b32 v18, 0
  v_mov_b32 v19, 0
  v_lshlrev_b32 v32, 16, v96
  v_and_b32 v33, 0xffff0000, v96
  v_lshlrev_b32 v34, 16, v12
  v_and_b32 v35, 0xffff0000, v103
  v_lshlrev_b32 v36, 16, v13
  v_and_b32 v37, 0xffff0000, v107
  v_lshlrev_b32 v38, 16, v108
  v_and_b32 v39, 0xffff0000, v108
  v_lshlrev_b32 v40, 16, v112
  v_and_b32 v41, 0xffff0000, v112
  v_lshlrev_b32 v42, 16, v14
  v_and_b32 v43, 0xffff0000, v119
  v_lshlrev_b32 v44, 16, v15
  v_and_b32 v45, 0xffff0000, v123
  v_lshlrev_b32 v46, 16, v124
  v_and_b32 v47, 0xffff0000, v124
  v_pk_add_f32 v[48:49], v[32:33], v[40:41]
  v_pk_add_f32 v[56:57], v[32:33], v[40:41] neg_lo:[0,1] neg_hi:[0,1]
  v_pk_add_f32 v[50:51], v[34:35], v[42:43]
  v_pk_add_f32 v[58:59], v[34:35], v[42:43] neg_lo:[0,1] neg_hi:[0,1]
  v_pk_add_f32 v[52:53], v[36:37], v[44:45]
  v_pk_add_f32 v[60:61], v[36:37], v[44:45] neg_lo:[0,1] neg_hi:[0,1]
  v_pk_add_f32 v[54:55], v[38:39], v[46:47]
  v_pk_add_f32 v[62:63], v[38:39], v[46:47] neg_lo:[0,1] neg_hi:[0,1]
  v_pk_add_f32 v[32:33], v[48:49], v[50:51]
  v_pk_add_f32 v[34:35], v[52:53], v[54:55]
  v_pk_add_f32 v[36:37], v[56:57], v[58:59] neg_lo:[0,1] neg_hi:[0,1]
  v_pk_add_f32 v[38:39], v[60:61], v[62:63] neg_lo:[0,1] neg_hi:[0,1]
  v_pk_add_f32 v[40:41], v[32:33], v[34:35]
  v_pk_add_f32 v[42:43], v[32:33], v[34:35] neg_lo:[0,1] neg_hi:[0,1]
  v_pk_add_f32 v[44:45], v[36:37], v[38:39] neg_lo:[0,1] neg_hi:[0,1]
  v_pk_add_f32 v[46:47], v[36:37], v[38:39]
  v_pk_add_f32 v[18:19], v[18:19], v[40:41]
  v_cvt_pk_bf16_f32 v64, v40, v41
  v_cvt_pk_bf16_f32 v72, v42, v43
  v_cvt_pk_bf16_f32 v80, v44, v45
  v_cvt_pk_bf16_f32 v88, v46, v47
  v_lshlrev_b32 v32, 16, v97
  v_and_b32 v33, 0xffff0000, v97
  v_lshlrev_b32 v34, 16, v103
  v_and_b32 v35, 0xffff0000, v102
  v_lshlrev_b32 v36, 16, v107
  v_and_b32 v37, 0xffff0000, v106
  v_lshlrev_b32 v38, 16, v109
  v_and_b32 v39, 0xffff0000, v109
  v_lshlrev_b32 v40, 16, v113
  v_and_b32 v41, 0xffff0000, v113
  v_lshlrev_b32 v42, 16, v119
  v_and_b32 v43, 0xffff0000, v118
  v_lshlrev_b32 v44, 16, v123
  v_and_b32 v45, 0xffff0000, v122
  v_lshlrev_b32 v46, 16, v125
  v_and_b32 v47, 0xffff0000, v125
  v_pk_add_f32 v[48:49], v[32:33], v[40:41]
  v_pk_add_f32 v[56:57], v[32:33], v[40:41] neg_lo:[0,1] neg_hi:[0,1]
  v_pk_add_f32 v[50:51], v[34:35], v[42:43]
  v_pk_add_f32 v[58:59], v[34:35], v[42:43] neg_lo:[0,1] neg_hi:[0,1]
  v_pk_add_f32 v[52:53], v[36:37], v[44:45]
  v_pk_add_f32 v[60:61], v[36:37], v[44:45] neg_lo:[0,1] neg_hi:[0,1]
  v_pk_add_f32 v[54:55], v[38:39], v[46:47]
  v_pk_add_f32 v[62:63], v[38:39], v[46:47] neg_lo:[0,1] neg_hi:[0,1]
  v_pk_add_f32 v[32:33], v[48:49], v[50:51]
  v_pk_add_f32 v[34:35], v[52:53], v[54:55]
  v_pk_add_f32 v[36:37], v[56:57], v[58:59] neg_lo:[0,1] neg_hi:[0,1]
  v_pk_add_f32 v[38:39], v[60:61], v[62:63] neg_lo:[0,1] neg_hi:[0,1]
  v_pk_add_f32 v[40:41], v[32:33], v[34:35]
  v_pk_add_f32 v[42:43], v[32:33], v[34:35] neg_lo:[0,1] neg_hi:[0,1]
  v_pk_add_f32 v[44:45], v[36:37], v[38:39] neg_lo:[0,1] neg_hi:[0,1]
  v_pk_add_f32 v[46:47], v[36:37], v[38:39]
  v_pk_add_f32 v[18:19], v[18:19], v[40:41]
  v_cvt_pk_bf16_f32 v65, v40, v41
  v_cvt_pk_bf16_f32 v73, v42, v43
  v_cvt_pk_bf16_f32 v81, v44, v45
  v_cvt_pk_bf16_f32 v89, v46, v47
  v_lshlrev_b32 v32, 16, v98
  v_and_b32 v33, 0xffff0000, v98
  v_lshlrev_b32 v34, 16, v102
  v_and_b32 v35, 0xffff0000, v101
  v_lshlrev_b32 v36, 16, v106
  v_and_b32 v37, 0xffff0000, v105
  v_lshlrev_b32 v38, 16, v110
  v_and_b32 v39, 0xffff0000, v110
  v_lshlrev_b32 v40, 16, v114
  v_and_b32 v41, 0xffff0000, v114
  v_lshlrev_b32 v42, 16, v118
  v_and_b32 v43, 0xffff0000, v117
  v_lshlrev_b32 v44, 16, v122
  v_and_b32 v45, 0xffff0000, v121
  v_lshlrev_b32 v46, 16, v126
  v_and_b32 v47, 0xffff0000, v126
  v_pk_add_f32 v[48:49], v[32:33], v[40:41]
  v_pk_add_f32 v[56:57], v[32:33], v[40:41] neg_lo:[0,1] neg_hi:[0,1]
  v_pk_add_f32 v[50:51], v[34:35], v[42:43]
  v_pk_add_f32 v[58:59], v[34:35], v[42:43] neg_lo:[0,1] neg_hi:[0,1]
  v_pk_add_f32 v[52:53], v[36:37], v[44:45]
  v_pk_add_f32 v[60:61], v[36:37], v[44:45] neg_lo:[0,1] neg_hi:[0,1]
  v_pk_add_f32 v[54:55], v[38:39], v[46:47]
  v_pk_add_f32 v[62:63], v[38:39], v[46:47] neg_lo:[0,1] neg_hi:[0,1]
  v_pk_add_f32 v[32:33], v[48:49], v[50:51]
  v_pk_add_f32 v[34:35], v[52:53], v[54:55]
  v_pk_add_f32 v[36:37], v[56:57], v[58:59] neg_lo:[0,1] neg_hi:[0,1]
  v_pk_add_f32 v[38:39], v[60:61], v[62:63] neg_lo:[0,1] neg_hi:[0,1]
  v_pk_add_f32 v[40:41], v[32:33], v[34:35]
  v_pk_add_f32 v[42:43], v[32:33], v[34:35] neg_lo:[0,1] neg_hi:[0,1]
  v_pk_add_f32 v[44:45], v[36:37], v[38:39] neg_lo:[0,1] neg_hi:[0,1]
  v_pk_add_f32 v[46:47], v[36:37], v[38:39]
  v_pk_add_f32 v[18:19], v[18:19], v[40:41]
  v_cvt_pk_bf16_f32 v66, v40, v41
  v_cvt_pk_bf16_f32 v74, v42, v43
  v_cvt_pk_bf16_f32 v82, v44, v45
  v_cvt_pk_bf16_f32 v90, v46, v47
  v_lshlrev_b32 v32, 16, v99
  v_and_b32 v33, 0xffff0000, v99
  v_lshlrev_b32 v34, 16, v101
  v_and_b32 v35, 0xffff0000, v100
  v_lshlrev_b32 v36, 16, v105
  v_and_b32 v37, 0xffff0000, v104
  v_lshlrev_b32 v38, 16, v111
  v_and_b32 v39, 0xffff0000, v111
  v_lshlrev_b32 v40, 16, v115
  v_and_b32 v41, 0xffff0000, v115
  v_lshlrev_b32 v42, 16, v117
  v_and_b32 v43, 0xffff0000, v116
  v_lshlrev_b32 v44, 16, v121
  v_and_b32 v45, 0xffff0000, v120
  v_lshlrev_b32 v46, 16, v127
  v_and_b32 v47, 0xffff0000, v127
  v_pk_add_f32 v[48:49], v[32:33], v[40:41]
  v_pk_add_f32 v[56:57], v[32:33], v[40:41] neg_lo:[0,1] neg_hi:[0,1]
  v_pk_add_f32 v[50:51], v[34:35], v[42:43]
  v_pk_add_f32 v[58:59], v[34:35], v[42:43] neg_lo:[0,1] neg_hi:[0,1]
  v_pk_add_f32 v[52:53], v[36:37], v[44:45]
  v_pk_add_f32 v[60:61], v[36:37], v[44:45] neg_lo:[0,1] neg_hi:[0,1]
  v_pk_add_f32 v[54:55], v[38:39], v[46:47]
  v_pk_add_f32 v[62:63], v[38:39], v[46:47] neg_lo:[0,1] neg_hi:[0,1]
  v_pk_add_f32 v[32:33], v[48:49], v[50:51]
  v_pk_add_f32 v[34:35], v[52:53], v[54:55]
  v_pk_add_f32 v[36:37], v[56:57], v[58:59] neg_lo:[0,1] neg_hi:[0,1]
  v_pk_add_f32 v[38:39], v[60:61], v[62:63] neg_lo:[0,1] neg_hi:[0,1]
  v_pk_add_f32 v[40:41], v[32:33], v[34:35]
  v_pk_add_f32 v[42:43], v[32:33], v[34:35] neg_lo:[0,1] neg_hi:[0,1]
  v_pk_add_f32 v[44:45], v[36:37], v[38:39] neg_lo:[0,1] neg_hi:[0,1]
  v_pk_add_f32 v[46:47], v[36:37], v[38:39]
  v_pk_add_f32 v[18:19], v[18:19], v[40:41]
  v_cvt_pk_bf16_f32 v67, v40, v41
  v_cvt_pk_bf16_f32 v75, v42, v43
  v_cvt_pk_bf16_f32 v83, v44, v45
  v_cvt_pk_bf16_f32 v91, v46, v47
  v_cndmask_b32 v64, v64, v80, s[94:95]
  v_cndmask_b32 v72, v72, v88, s[94:95]
  v_cndmask_b32 v65, v65, v81, s[94:95]
  v_cndmask_b32 v73, v73, v89, s[94:95]
  v_cndmask_b32 v66, v66, v82, s[94:95]
  v_cndmask_b32 v74, v74, v90, s[94:95]
  v_cndmask_b32 v67, v67, v83, s[94:95]
  v_cndmask_b32 v75, v75, v91, s[94:95]
  v_sub_f32 v18, v18, v19
  v_dot2_f32_bf16 v32, v128, v64, 0
  v_dot2_f32_bf16 v32, v129, v65, v32
  v_dot2_f32_bf16 v32, v130, v66, v32
  v_dot2_f32_bf16 v32, v131, v67, v32
  v_dot2_f32_bf16 v33, v132, v72, 0
  v_dot2_f32_bf16 v33, v133, v73, v33
  v_dot2_f32_bf16 v33, v134, v74, v33
  v_dot2_f32_bf16 v33, v135, v75, v33
  v_add_f32 v34, v136, v137
  v_add_f32 v35, v138, v139
  v_add_f32 v34, v34, v35
  v_sub_f32 v35, v136, v137
  v_sub_f32 v36, v138, v139
  v_sub_f32 v35, v35, v36
  v_add_f32 v18, v18, v34
  s_and_b32 s40, s5, 1
  s_cmp_eq_u32 s40, 0
  s_cselect_b32 s40, 1.0, -1.0
  v_mul_f32 v34, s40, v34
  v_mul_f32 v35, s40, v35
  v_cndmask_b32 v34, v34, 0, s[94:95]
  v_cndmask_b32 v35, 0, v35, s[94:95]
  v_add_f32 v32, v32, v34
  v_sub_f32 v33, v33, v35
  s_nop 2
  v_add_f32_dpp v28, v28, v28 row_ror:8 row_mask:0xf bank_mask:0xf
  v_add_f32_dpp v29, v29, v29 row_ror:8 row_mask:0xf bank_mask:0xf
  v_add_f32_dpp v18, v18, v18 row_ror:8 row_mask:0xf bank_mask:0xf
  v_add_f32_dpp v32, v32, v32 row_ror:8 row_mask:0xf bank_mask:0xf
  v_add_f32_dpp v33, v33, v33 row_ror:8 row_mask:0xf bank_mask:0xf
  v_add_f32_dpp v28, v28, v28 row_ror:4 row_mask:0xf bank_mask:0xf
  v_add_f32_dpp v29, v29, v29 row_ror:4 row_mask:0xf bank_mask:0xf
  v_add_f32_dpp v18, v18, v18 row_ror:4 row_mask:0xf bank_mask:0xf
  v_add_f32_dpp v32, v32, v32 row_ror:4 row_mask:0xf bank_mask:0xf
  v_add_f32_dpp v33, v33, v33 row_ror:4 row_mask:0xf bank_mask:0xf
  v_add_f32_dpp v28, v28, v28 row_ror:2 row_mask:0xf bank_mask:0xf
  v_add_f32_dpp v29, v29, v29 row_ror:2 row_mask:0xf bank_mask:0xf
  v_add_f32_dpp v18, v18, v18 row_ror:2 row_mask:0xf bank_mask:0xf
  v_add_f32_dpp v32, v32, v32 row_ror:2 row_mask:0xf bank_mask:0xf
  v_add_f32_dpp v33, v33, v33 row_ror:2 row_mask:0xf bank_mask:0xf
  v_add_f32_dpp v28, v28, v28 row_ror:1 row_mask:0xf bank_mask:0xf
  v_add_f32_dpp v29, v29, v29 row_ror:1 row_mask:0xf bank_mask:0xf
  v_add_f32_dpp v18, v18, v18 row_ror:1 row_mask:0xf bank_mask:0xf
  v_add_f32_dpp v32, v32, v32 row_ror:1 row_mask:0xf bank_mask:0xf
  v_add_f32_dpp v33, v33, v33 row_ror:1 row_mask:0xf bank_mask:0xf
  v_mov_b32 v40, v28
  v_mov_b32 v41, v29
  v_mov_b32 v42, v18
  v_mov_b32 v43, v32
  v_mov_b32 v44, v33
  s_nop 1
  v_permlane16_swap_b32 v28, v40
  v_permlane16_swap_b32 v29, v41
  v_permlane16_swap_b32 v18, v42
  v_permlane16_swap_b32 v32, v43
  v_permlane16_swap_b32 v33, v44
  v_add_f32 v28, v28, v40
  v_add_f32 v29, v29, v41
  v_add_f32 v18, v18, v42
  v_add_f32 v32, v32, v43
  v_add_f32 v33, v33, v44
  v_mul_f32 v28, 0xbfb8aa3b, v28
  v_mul_f32 v29, 0xbfb8aa3b, v29
  v_exp_f32 v28, v28
  v_exp_f32 v29, v29
  s_nop 0
  v_add_f32 v28, 1.0, v28
  v_add_f32 v29, 1.0, v29
  v_rcp_f32 v28, v28
  v_rcp_f32 v29, v29
  s_nop 0
  v_lshlrev_b32 v9, 6, v7
  s_lshl_b32 s40, s5, 3
  s_add_u32 s40, s40, 148288
  v_add_u32 v9, s40, v9
  v_mov_b32 v11, 148416
  s_mov_b64 exec, s[62:63]
  ds_write_b64 v9, v[32:33]
  ds_write_b32 v11, v18
  ds_write_b64 v11, v[28:29] offset:8
  s_mov_b64 exec, -1
  s_mov_b32 s44, s88
  s_mov_b32 s45, s89
  s_mov_b32 s46, 0x100
  s_mov_b32 s47, 0x20000
  s_mov_b32 s56, 0
  v_mov_b32 v4, 0
L1_nn_16:
  buffer_load_dwordx2 v[2:3], v4, s[44:47], 0 offen sc1
L1_nn_16_c:
  s_waitcnt vmcnt(0)
  v_readfirstlane_b32 s92, v2
  v_readfirstlane_b32 s93, v3
  s_add_u32 s56, s56, 1
  s_cmp_lg_u32 s92, 0
  s_cbranch_scc1 L1_nd_17
  s_cmp_lt_u32 s56, 100000
  s_cbranch_scc1 L1_nn_16
L1_nd_17:
  s_waitcnt lgkmcnt(0)
  s_barrier
  s_cmp_lg_u32 s5, 0
  s_cbranch_scc1 L_nosmall
  v_lshlrev_b32 v2, 4, v0
  v_add_u32 v3, 147968, v2
  ds_read_b128 v[4:7], v3
  v_lshrrev_b32 v8, 2, v0
  v_and_b32 v9, 3, v0
  v_lshlrev_b32 v9, 4, v9
  s_lshl_b32 s40, s57, 6
  v_lshlrev_b32 v11, 11, v8
  v_add_u32 v11, 28323840, v11
  v_add_u32 v11, s40, v11
  s_add_u32 s41, s40, 28319744
  v_mov_b32 v12, s41
  v_cmp_eq_u32 vcc, 4, v8
  s_nop 1
  v_cndmask_b32 v11, v11, v12, vcc
  s_add_u32 s41, s40, 28311552
  v_mov_b32 v12, s41
  v_cmp_eq_u32 vcc, 5, v8
  s_nop 1
  v_cndmask_b32 v11, v11, v12, vcc
  s_add_u32 s41, s40, 28315648
  v_mov_b32 v12, s41
  v_cmp_eq_u32 vcc, 6, v8
  s_nop 1
  v_cndmask_b32 v11, v11, v12, vcc
  v_mov_b32 v12, 28332032
  v_cmp_eq_u32 vcc, 7, v8
  s_nop 1
  v_cndmask_b32 v11, v11, v12, vcc
  v_add_u32 v11, v11, v9
  s_cmp_eq_u32 s57, 0
  s_cselect_b32 s40, -1, 0x0fffffff
  s_mov_b32 exec_lo, s40
  s_mov_b32 exec_hi, 0
  s_waitcnt lgkmcnt(0)
  buffer_store_dwordx4 v[4:7], v11, s[16:19], 0 offen sc1
  s_mov_b64 exec, -1
L_nosmall:
  s_lshl_b32 s40, s57, 6
  s_add_u32 s40, s40, 32014336
  v_mov_b32 v20, s92
  v_mov_b32 v21, s93
  v_mov_b32 v22, s92
  v_mov_b32 v23, s93
  v_mov_b32 v24, 155648
  v_mov_b32 v25, 1
  s_mov_b64 exec, 1
  s_waitcnt vmcnt(0)
  ds_add_rtn_u32 v25, v24, v25
  s_mov_b64 exec, 15
  v_lshlrev_b32 v24, 4, v0
  s_waitcnt lgkmcnt(0)
  v_readfirstlane_b32 s36, v25
  s_cmp_lg_u32 s36, 7
  s_cbranch_scc1 L1_sf_18
  buffer_store_dwordx4 v[20:23], v24, s[16:19], s40 offen sc1
L1_sf_18:
  s_mov_b64 exec, -1
  s_mov_b32 s44, s78
  s_mov_b32 s45, s79
  s_mov_b32 s46, 0x800000
  s_mov_b32 s47, 0x20000
  s_lshl_b32 s29, s57, 3
  s_add_u32 s29, s29, s5
  s_lshl_b32 s29, s29, 4
  v_lshlrev_b32 v2, 4, v0
  s_lshr_b32 s37, s29, 10
  s_and_b32 s40, s29, 1
  s_add_u32 s37, s37, s40
  s_add_u32 s37, s37, 2
  s_and_b32 s37, s37, 3
  s_lshl_b32 s37, s37, 10
  s_lshr_b32 s40, s29, 1
  s_lshl_b32 s40, s40, 12
  s_add_u32 s37, s37, s40
  s_add_u32 s29, s29, 1
  buffer_load_dwordx4 v[120:123], v2, s[44:47], s37 offen
  s_lshr_b32 s37, s29, 10
  s_and_b32 s40, s29, 1
  s_add_u32 s37, s37, s40
  s_add_u32 s37, s37, 2
  s_and_b32 s37, s37, 3
  s_lshl_b32 s37, s37, 10
  s_lshr_b32 s40, s29, 1
  s_lshl_b32 s40, s40, 12
  s_add_u32 s37, s37, s40
  s_add_u32 s29, s29, 1
  buffer_load_dwordx4 v[120:123], v2, s[44:47], s37 offen
  s_lshr_b32 s37, s29, 10
  s_and_b32 s40, s29, 1
  s_add_u32 s37, s37, s40
  s_add_u32 s37, s37, 2
  s_and_b32 s37, s37, 3
  s_lshl_b32 s37, s37, 10
  s_lshr_b32 s40, s29, 1
  s_lshl_b32 s40, s40, 12
  s_add_u32 s37, s37, s40
  s_add_u32 s29, s29, 1
  buffer_load_dwordx4 v[120:123], v2, s[44:47], s37 offen
  s_lshr_b32 s37, s29, 10
  s_and_b32 s40, s29, 1
  s_add_u32 s37, s37, s40
  s_add_u32 s37, s37, 2
  s_and_b32 s37, s37, 3
  s_lshl_b32 s37, s37, 10
  s_lshr_b32 s40, s29, 1
  s_lshl_b32 s40, s40, 12
  s_add_u32 s37, s37, s40
  s_add_u32 s29, s29, 1
  buffer_load_dwordx4 v[120:123], v2, s[44:47], s37 offen
  s_lshr_b32 s37, s29, 10
  s_and_b32 s40, s29, 1
  s_add_u32 s37, s37, s40
  s_add_u32 s37, s37, 2
  s_and_b32 s37, s37, 3
  s_lshl_b32 s37, s37, 10
  s_lshr_b32 s40, s29, 1
  s_lshl_b32 s40, s40, 12
  s_add_u32 s37, s37, s40
  s_add_u32 s29, s29, 1
  buffer_load_dwordx4 v[120:123], v2, s[44:47], s37 offen
  s_lshr_b32 s37, s29, 10
  s_and_b32 s40, s29, 1
  s_add_u32 s37, s37, s40
  s_add_u32 s37, s37, 2
  s_and_b32 s37, s37, 3
  s_lshl_b32 s37, s37, 10
  s_lshr_b32 s40, s29, 1
  s_lshl_b32 s40, s40, 12
  s_add_u32 s37, s37, s40
  s_add_u32 s29, s29, 1
  buffer_load_dwordx4 v[120:123], v2, s[44:47], s37 offen
  s_lshr_b32 s37, s29, 10
  s_and_b32 s40, s29, 1
  s_add_u32 s37, s37, s40
  s_add_u32 s37, s37, 2
  s_and_b32 s37, s37, 3
  s_lshl_b32 s37, s37, 10
  s_lshr_b32 s40, s29, 1
  s_lshl_b32 s40, s40, 12
  s_add_u32 s37, s37, s40
  s_add_u32 s29, s29, 1
  buffer_load_dwordx4 v[120:123], v2, s[44:47], s37 offen
  s_lshr_b32 s37, s29, 10
  s_and_b32 s40, s29, 1
  s_add_u32 s37, s37, s40
  s_add_u32 s37, s37, 2
  s_and_b32 s37, s37, 3
  s_lshl_b32 s37, s37, 10
  s_lshr_b32 s40, s29, 1
  s_lshl_b32 s40, s40, 12
  s_add_u32 s37, s37, s40
  s_add_u32 s29, s29, 1
  buffer_load_dwordx4 v[120:123], v2, s[44:47], s37 offen
  s_lshr_b32 s37, s29, 10
  s_and_b32 s40, s29, 1
  s_add_u32 s37, s37, s40
  s_add_u32 s37, s37, 2
  s_and_b32 s37, s37, 3
  s_lshl_b32 s37, s37, 10
  s_lshr_b32 s40, s29, 1
  s_lshl_b32 s40, s40, 12
  s_add_u32 s37, s37, s40
  s_add_u32 s29, s29, 1
  buffer_load_dwordx4 v[120:123], v2, s[44:47], s37 offen
  s_lshr_b32 s37, s29, 10
  s_and_b32 s40, s29, 1
  s_add_u32 s37, s37, s40
  s_add_u32 s37, s37, 2
  s_and_b32 s37, s37, 3
  s_lshl_b32 s37, s37, 10
  s_lshr_b32 s40, s29, 1
  s_lshl_b32 s40, s40, 12
  s_add_u32 s37, s37, s40
  s_add_u32 s29, s29, 1
  buffer_load_dwordx4 v[120:123], v2, s[44:47], s37 offen
  s_lshr_b32 s37, s29, 10
  s_and_b32 s40, s29, 1
  s_add_u32 s37, s37, s40
  s_add_u32 s37, s37, 2
  s_and_b32 s37, s37, 3
  s_lshl_b32 s37, s37, 10
  s_lshr_b32 s40, s29, 1
  s_lshl_b32 s40, s40, 12
  s_add_u32 s37, s37, s40
  s_add_u32 s29, s29, 1
  buffer_load_dwordx4 v[120:123], v2, s[44:47], s37 offen
  s_lshr_b32 s37, s29, 10
  s_and_b32 s40, s29, 1
  s_add_u32 s37, s37, s40
  s_add_u32 s37, s37, 2
  s_and_b32 s37, s37, 3
  s_lshl_b32 s37, s37, 10
  s_lshr_b32 s40, s29, 1
  s_lshl_b32 s40, s40, 12
  s_add_u32 s37, s37, s40
  s_add_u32 s29, s29, 1
  buffer_load_dwordx4 v[120:123], v2, s[44:47], s37 offen
  s_lshr_b32 s37, s29, 10
  s_and_b32 s40, s29, 1
  s_add_u32 s37, s37, s40
  s_add_u32 s37, s37, 2
  s_and_b32 s37, s37, 3
  s_lshl_b32 s37, s37, 10
  s_lshr_b32 s40, s29, 1
  s_lshl_b32 s40, s40, 12
  s_add_u32 s37, s37, s40
  s_add_u32 s29, s29, 1
  buffer_load_dwordx4 v[120:123], v2, s[44:47], s37 offen
  s_lshr_b32 s37, s29, 10
  s_and_b32 s40, s29, 1
  s_add_u32 s37, s37, s40
  s_add_u32 s37, s37, 2
  s_and_b32 s37, s37, 3
  s_lshl_b32 s37, s37, 10
  s_lshr_b32 s40, s29, 1
  s_lshl_b32 s40, s40, 12
  s_add_u32 s37, s37, s40
  s_add_u32 s29, s29, 1
  buffer_load_dwordx4 v[120:123], v2, s[44:47], s37 offen
  s_lshr_b32 s37, s29, 10
  s_and_b32 s40, s29, 1
  s_add_u32 s37, s37, s40
  s_add_u32 s37, s37, 2
  s_and_b32 s37, s37, 3
  s_lshl_b32 s37, s37, 10
  s_lshr_b32 s40, s29, 1
  s_lshl_b32 s40, s40, 12
  s_add_u32 s37, s37, s40
  s_add_u32 s29, s29, 1
  buffer_load_dwordx4 v[120:123], v2, s[44:47], s37 offen
  s_lshr_b32 s37, s29, 10
  s_and_b32 s40, s29, 1
  s_add_u32 s37, s37, s40
  s_add_u32 s37, s37, 2
  s_and_b32 s37, s37, 3
  s_lshl_b32 s37, s37, 10
  s_lshr_b32 s40, s29, 1
  s_lshl_b32 s40, s40, 12
  s_add_u32 s37, s37, s40
  s_add_u32 s29, s29, 1
  buffer_load_dwordx4 v[120:123], v2, s[44:47], s37 offen
  s_and_b32 s48, s57, 1
  s_bfe_u32 s49, s57, 0x20001
  s_lshr_b32 s50, s57, 3
  s_cmp_lt_u32 s5, 4
  s_cbranch_scc1 L3_scons
  s_mov_b32 s8, s66
  s_mov_b32 s9, s67
  s_mov_b32 s10, 0x800000
  s_mov_b32 s11, 0x20000
  s_lshl_b32 s40, s49, 20
  s_lshl_b32 s41, s48, 12
  s_add_u32 s40, s40, s41
  s_lshl_b32 s37, s26, 5
  v_lshrrev_b32 v8, 3, v0
  v_and_b32 v9, 7, v0
  v_lshrrev_b32 v10, 4, v0
  v_xor_b32 v9, v9, v10
  v_lshlrev_b32 v9, 4, v9
  v_add_u32 v10, 0, v8
  v_add_u32 v10, s37, v10
  v_lshlrev_b32 v10, 13, v10
  v_add_u32 v10, s40, v10
  v_add_u32 v10, v10, v9
  v_subrev_u32 v105, 0, v10
  v_add_u32 v10, 8, v8
  v_add_u32 v10, s37, v10
  v_lshlrev_b32 v10, 13, v10
  v_add_u32 v10, s40, v10
  v_xor_b32 v16, 64, v9
  v_add_u32 v10, v10, v16
  v_subrev_u32 v106, 1024, v10
  v_add_u32 v10, 16, v8
  v_add_u32 v10, s37, v10
  v_lshlrev_b32 v10, 13, v10
  v_add_u32 v10, s40, v10
  v_add_u32 v10, v10, v9
  v_subrev_u32 v107, 2048, v10
  v_add_u32 v10, 24, v8
  v_add_u32 v10, s37, v10
  v_lshlrev_b32 v10, 13, v10
  v_add_u32 v10, s40, v10
  v_xor_b32 v16, 64, v9
  v_add_u32 v10, v10, v16
  v_subrev_u32 v108, 3072, v10
  s_lshl_b32 s31, s26, 12
  v_lshlrev_b32 v104, 4, v0
  v_add_u32 v104, s31, v104
  s_lshl_b32 s13, s48, 2
  s_add_u32 s13, s13, s50
  s_lshl_b32 s13, s13, 17
  s_add_u32 s13, s13, 26214400
  s_mov_b32 s12, 0
  s_mov_b32 s41, s12
  s_add_u32 m0, s31, 16384
  s_nop 0
  buffer_load_dwordx4 v105, s[8:11], s41 offen offset:0 lds
  buffer_load_dwordx4 v106, s[8:11], s41 offen offset:1024 lds
  buffer_load_dwordx4 v107, s[8:11], s41 offen offset:2048 lds
  buffer_load_dwordx4 v108, s[8:11], s41 offen offset:3072 lds
  s_add_u32 s41, s41, 128
  s_and_b32 s41, s41, 1023
  s_add_u32 m0, s31, 49152
  s_nop 0
  buffer_load_dwordx4 v105, s[8:11], s41 offen offset:0 lds
  buffer_load_dwordx4 v106, s[8:11], s41 offen offset:1024 lds
  buffer_load_dwordx4 v107, s[8:11], s41 offen offset:2048 lds
  buffer_load_dwordx4 v108, s[8:11], s41 offen offset:3072 lds
  s_add_u32 s41, s41, 128
  s_and_b32 s41, s41, 1023
  s_add_u32 m0, s31, 81920
  s_nop 0
  buffer_load_dwordx4 v105, s[8:11], s41 offen offset:0 lds
  buffer_load_dwordx4 v106, s[8:11], s41 offen offset:1024 lds
  buffer_load_dwordx4 v107, s[8:11], s41 offen offset:2048 lds
  buffer_load_dwordx4 v108, s[8:11], s41 offen offset:3072 lds
  s_add_u32 s41, s41, 128
  s_and_b32 s41, s41, 1023
  s_add_u32 m0, s31, 114688
  s_nop 0
  buffer_load_dwordx4 v105, s[8:11], s41 offen offset:0 lds
  buffer_load_dwordx4 v106, s[8:11], s41 offen offset:1024 lds
  buffer_load_dwordx4 v107, s[8:11], s41 offen offset:2048 lds
  buffer_load_dwordx4 v108, s[8:11], s41 offen offset:3072 lds
  s_add_u32 s41, s41, 128
  s_and_b32 s41, s41, 1023
  s_mov_b32 s40, 32014336
  s_mov_b32 s56, 0
L1_pf_19:
  v_and_b32 v26, 31, v0
  v_min_u32 v26, 31, v26
  v_lshlrev_b32 v26, 6, v26
  s_mov_b32 exec_hi, 0
  s_mov_b32 exec_lo, 0xffffffff
  buffer_load_dwordx2 v[24:25], v26, s[16:19], s40 offen sc1
  s_mov_b64 exec, -1
L1_pf_19_c:
  s_waitcnt vmcnt(0)
  v_cmp_eq_u64 vcc, s[92:93], v[24:25]
  s_and_b32 s36, vcc_lo, 0xffffffff
  s_cmp_eq_u32 s36, 0xffffffff
  s_cbranch_scc1 L1_pd_20
  s_sleep 2
  s_add_u32 s56, s56, 1
  s_cmp_lt_u32 s56, 100000
  s_cbranch_scc1 L1_pf_19
L1_pd_20:
  s_lshl_b32 s14, s12, 7
  s_add_u32 m0, s31, 0
  s_add_u32 s14, s14, s13
  buffer_load_dwordx4 v104, s[16:19], s14 offen offset:0 sc1 lds
  buffer_load_dwordx4 v104, s[16:19], s14 offen offset:1024 sc1 lds
  buffer_load_dwordx4 v104, s[16:19], s14 offen offset:2048 sc1 lds
  buffer_load_dwordx4 v104, s[16:19], s14 offen offset:3072 sc1 lds
  s_add_u32 s12, s12, 128
  s_and_b32 s12, s12, 1023
  s_lshl_b32 s14, s12, 7
  s_add_u32 m0, s31, 32768
  s_add_u32 s14, s14, s13
  buffer_load_dwordx4 v104, s[16:19], s14 offen offset:0 sc1 lds
  buffer_load_dwordx4 v104, s[16:19], s14 offen offset:1024 sc1 lds
  buffer_load_dwordx4 v104, s[16:19], s14 offen offset:2048 sc1 lds
  buffer_load_dwordx4 v104, s[16:19], s14 offen offset:3072 sc1 lds
  s_add_u32 s12, s12, 128
  s_and_b32 s12, s12, 1023
  s_waitcnt vmcnt(4)
  s_barrier
  s_lshl_b32 s14, s12, 7
  s_add_u32 m0, s31, 65536
  s_add_u32 s14, s14, s13
  buffer_load_dwordx4 v104, s[16:19], s14 offen offset:0 sc1 lds
  buffer_load_dwordx4 v104, s[16:19], s14 offen offset:1024 sc1 lds
  buffer_load_dwordx4 v104, s[16:19], s14 offen offset:2048 sc1 lds
  buffer_load_dwordx4 v104, s[16:19], s14 offen offset:3072 sc1 lds
  s_add_u32 s12, s12, 128
  s_and_b32 s12, s12, 1023
  s_lshl_b32 s14, s12, 7
  s_add_u32 m0, s31, 98304
  s_add_u32 s14, s14, s13
  buffer_load_dwordx4 v104, s[16:19], s14 offen offset:0 sc1 lds
  buffer_load_dwordx4 v104, s[16:19], s14 offen offset:1024 sc1 lds
  buffer_load_dwordx4 v104, s[16:19], s14 offen offset:2048 sc1 lds
  buffer_load_dwordx4 v104, s[16:19], s14 offen offset:3072 sc1 lds
  s_add_u32 s12, s12, 128
  s_and_b32 s12, s12, 1023
  s_waitcnt vmcnt(8)
  s_barrier
  s_lshl_b32 s14, s12, 7
  s_add_u32 m0, s31, 0
  s_add_u32 s14, s14, s13
  buffer_load_dwordx4 v104, s[16:19], s14 offen offset:0 sc1 lds
  buffer_load_dwordx4 v104, s[16:19], s14 offen offset:1024 sc1 lds
  buffer_load_dwordx4 v104, s[16:19], s14 offen offset:2048 sc1 lds
  buffer_load_dwordx4 v104, s[16:19], s14 offen offset:3072 sc1 lds
  s_add_u32 m0, s31, 16384
  s_nop 0
  buffer_load_dwordx4 v105, s[8:11], s12 offen offset:0 lds
  buffer_load_dwordx4 v106, s[8:11], s12 offen offset:1024 lds
  buffer_load_dwordx4 v107, s[8:11], s12 offen offset:2048 lds
  buffer_load_dwordx4 v108, s[8:11], s12 offen offset:3072 lds
  s_add_u32 s12, s12, 128
  s_and_b32 s12, s12, 1023
  s_waitcnt vmcnt(12)
  s_barrier
  s_lshl_b32 s14, s12, 7
  s_add_u32 m0, s31, 32768
  s_add_u32 s14, s14, s13
  buffer_load_dwordx4 v104, s[16:19], s14 offen offset:0 sc1 lds
  buffer_load_dwordx4 v104, s[16:19], s14 offen offset:1024 sc1 lds
  buffer_load_dwordx4 v104, s[16:19], s14 offen offset:2048 sc1 lds
  buffer_load_dwordx4 v104, s[16:19], s14 offen offset:3072 sc1 lds
  s_add_u32 m0, s31, 49152
  s_nop 0
  buffer_load_dwordx4 v105, s[8:11], s12 offen offset:0 lds
  buffer_load_dwordx4 v106, s[8:11], s12 offen offset:1024 lds
  buffer_load_dwordx4 v107, s[8:11], s12 offen offset:2048 lds
  buffer_load_dwordx4 v108, s[8:11], s12 offen offset:3072 lds
  s_add_u32 s12, s12, 128
  s_and_b32 s12, s12, 1023
  s_waitcnt vmcnt(16)
  s_barrier
  s_lshl_b32 s14, s12, 7
  s_add_u32 m0, s31, 65536
  s_add_u32 s14, s14, s13
  buffer_load_dwordx4 v104, s[16:19], s14 offen offset:0 sc1 lds
  buffer_load_dwordx4 v104, s[16:19], s14 offen offset:1024 sc1 lds
  buffer_load_dwordx4 v104, s[16:19], s14 offen offset:2048 sc1 lds
  buffer_load_dwordx4 v104, s[16:19], s14 offen offset:3072 sc1 lds
  s_add_u32 m0, s31, 81920
  s_nop 0
  buffer_load_dwordx4 v105, s[8:11], s12 offen offset:0 lds
  buffer_load_dwordx4 v106, s[8:11], s12 offen offset:1024 lds
  buffer_load_dwordx4 v107, s[8:11], s12 offen offset:2048 lds
  buffer_load_dwordx4 v108, s[8:11], s12 offen offset:3072 lds
  s_add_u32 s12, s12, 128
  s_and_b32 s12, s12, 1023
  s_waitcnt vmcnt(16)
  s_barrier
  s_lshl_b32 s14, s12, 7
  s_add_u32 m0, s31, 98304
  s_add_u32 s14, s14, s13
  buffer_load_dwordx4 v104, s[16:19], s14 offen offset:0 sc1 lds
  buffer_load_dwordx4 v104, s[16:19], s14 offen offset:1024 sc1 lds
  buffer_load_dwordx4 v104, s[16:19], s14 offen offset:2048 sc1 lds
  buffer_load_dwordx4 v104, s[16:19], s14 offen offset:3072 sc1 lds
  s_add_u32 m0, s31, 114688
  s_nop 0
  buffer_load_dwordx4 v105, s[8:11], s12 offen offset:0 lds
  buffer_load_dwordx4 v106, s[8:11], s12 offen offset:1024 lds
  buffer_load_dwordx4 v107, s[8:11], s12 offen offset:2048 lds
  buffer_load_dwordx4 v108, s[8:11], s12 offen offset:3072 lds
  s_add_u32 s12, s12, 128
  s_and_b32 s12, s12, 1023
  s_waitcnt vmcnt(16)
  s_barrier
  s_mov_b32 s8, s68
  s_mov_b32 s9, s69
  s_add_u32 s13, s13, 1048576
  s_lshl_b32 s14, s12, 7
  s_add_u32 m0, s31, 0
  s_add_u32 s14, s14, s13
  buffer_load_dwordx4 v104, s[16:19], s14 offen offset:0 sc1 lds
  buffer_load_dwordx4 v104, s[16:19], s14 offen offset:1024 sc1 lds
  buffer_load_dwordx4 v104, s[16:19], s14 offen offset:2048 sc1 lds
  buffer_load_dwordx4 v104, s[16:19], s14 offen offset:3072 sc1 lds
  s_add_u32 m0, s31, 16384
  s_nop 0
  buffer_load_dwordx4 v105, s[8:11], s12 offen offset:0 lds
  buffer_load_dwordx4 v106, s[8:11], s12 offen offset:1024 lds
  buffer_load_dwordx4 v107, s[8:11], s12 offen offset:2048 lds
  buffer_load_dwordx4 v108, s[8:11], s12 offen offset:3072 lds
  s_add_u32 s12, s12, 128
  s_and_b32 s12, s12, 1023
  s_waitcnt vmcnt(16)
  s_barrier
  s_lshl_b32 s14, s12, 7
  s_add_u32 m0, s31, 32768
  s_add_u32 s14, s14, s13
  buffer_load_dwordx4 v104, s[16:19], s14 offen offset:0 sc1 lds
  buffer_load_dwordx4 v104, s[16:19], s14 offen offset:1024 sc1 lds
  buffer_load_dwordx4 v104, s[16:19], s14 offen offset:2048 sc1 lds
  buffer_load_dwordx4 v104, s[16:19], s14 offen offset:3072 sc1 lds
  s_add_u32 m0, s31, 49152
  s_nop 0
  buffer_load_dwordx4 v105, s[8:11], s12 offen offset:0 lds
  buffer_load_dwordx4 v106, s[8:11], s12 offen offset:1024 lds
  buffer_load_dwordx4 v107, s[8:11], s12 offen offset:2048 lds
  buffer_load_dwordx4 v108, s[8:11], s12 offen offset:3072 lds
  s_add_u32 s12, s12, 128
  s_and_b32 s12, s12, 1023
  s_waitcnt vmcnt(16)
  s_barrier
  s_lshl_b32 s14, s12, 7
  s_add_u32 m0, s31, 65536
  s_add_u32 s14, s14, s13
  buffer_load_dwordx4 v104, s[16:19], s14 offen offset:0 sc1 lds
  buffer_load_dwordx4 v104, s[16:19], s14 offen offset:1024 sc1 lds
  buffer_load_dwordx4 v104, s[16:19], s14 offen offset:2048 sc1 lds
  buffer_load_dwordx4 v104, s[16:19], s14 offen offset:3072 sc1 lds
  s_add_u32 m0, s31, 81920
  s_nop 0
  buffer_load_dwordx4 v105, s[8:11], s12 offen offset:0 lds
  buffer_load_dwordx4 v106, s[8:11], s12 offen offset:1024 lds
  buffer_load_dwordx4 v107, s[8:11], s12 offen offset:2048 lds
  buffer_load_dwordx4 v108, s[8:11], s12 offen offset:3072 lds
  s_add_u32 s12, s12, 128
  s_and_b32 s12, s12, 1023
  s_waitcnt vmcnt(16)
  s_barrier
  s_lshl_b32 s14, s12, 7
  s_add_u32 m0, s31, 98304
  s_add_u32 s14, s14, s13
  buffer_load_dwordx4 v104, s[16:19], s14 offen offset:0 sc1 lds
  buffer_load_dwordx4 v104, s[16:19], s14 offen offset:1024 sc1 lds
  buffer_load_dwordx4 v104, s[16:19], s14 offen offset:2048 sc1 lds
  buffer_load_dwordx4 v104, s[16:19], s14 offen offset:3072 sc1 lds
  s_add_u32 m0, s31, 114688
  s_nop 0
  buffer_load_dwordx4 v105, s[8:11], s12 offen offset:0 lds
  buffer_load_dwordx4 v106, s[8:11], s12 offen offset:1024 lds
  buffer_load_dwordx4 v107, s[8:11], s12 offen offset:2048 lds
  buffer_load_dwordx4 v108, s[8:11], s12 offen offset:3072 lds
  s_add_u32 s12, s12, 128
  s_and_b32 s12, s12, 1023
  s_waitcnt vmcnt(16)
  s_barrier
  s_lshl_b32 s14, s12, 7
  s_add_u32 m0, s31, 0
  s_add_u32 s14, s14, s13
  buffer_load_dwordx4 v104, s[16:19], s14 offen offset:0 sc1 lds
  buffer_load_dwordx4 v104, s[16:19], s14 offen offset:1024 sc1 lds
  buffer_load_dwordx4 v104, s[16:19], s14 offen offset:2048 sc1 lds
  buffer_load_dwordx4 v104, s[16:19], s14 offen offset:3072 sc1 lds
  s_add_u32 m0, s31, 16384
  s_nop 0
  buffer_load_dwordx4 v105, s[8:11], s12 offen offset:0 lds
  buffer_load_dwordx4 v106, s[8:11], s12 offen offset:1024 lds
  buffer_load_dwordx4 v107, s[8:11], s12 offen offset:2048 lds
  buffer_load_dwordx4 v108, s[8:11], s12 offen offset:3072 lds
  s_add_u32 s12, s12, 128
  s_and_b32 s12, s12, 1023
  s_waitcnt vmcnt(16)
  s_barrier
  s_lshl_b32 s14, s12, 7
  s_add_u32 m0, s31, 32768
  s_add_u32 s14, s14, s13
  buffer_load_dwordx4 v104, s[16:19], s14 offen offset:0 sc1 lds
  buffer_load_dwordx4 v104, s[16:19], s14 offen offset:1024 sc1 lds
  buffer_load_dwordx4 v104, s[16:19], s14 offen offset:2048 sc1 lds
  buffer_load_dwordx4 v104, s[16:19], s14 offen offset:3072 sc1 lds
  s_add_u32 m0, s31, 49152
  s_nop 0
  buffer_load_dwordx4 v105, s[8:11], s12 offen offset:0 lds
  buffer_load_dwordx4 v106, s[8:11], s12 offen offset:1024 lds
  buffer_load_dwordx4 v107, s[8:11], s12 offen offset:2048 lds
  buffer_load_dwordx4 v108, s[8:11], s12 offen offset:3072 lds
  s_add_u32 s12, s12, 128
  s_and_b32 s12, s12, 1023
  s_waitcnt vmcnt(16)
  s_barrier
  s_lshl_b32 s14, s12, 7
  s_add_u32 m0, s31, 65536
  s_add_u32 s14, s14, s13
  buffer_load_dwordx4 v104, s[16:19], s14 offen offset:0 sc1 lds
  buffer_load_dwordx4 v104, s[16:19], s14 offen offset:1024 sc1 lds
  buffer_load_dwordx4 v104, s[16:19], s14 offen offset:2048 sc1 lds
  buffer_load_dwordx4 v104, s[16:19], s14 offen offset:3072 sc1 lds
  s_add_u32 m0, s31, 81920
  s_nop 0
  buffer_load_dwordx4 v105, s[8:11], s12 offen offset:0 lds
  buffer_load_dwordx4 v106, s[8:11], s12 offen offset:1024 lds
  buffer_load_dwordx4 v107, s[8:11], s12 offen offset:2048 lds
  buffer_load_dwordx4 v108, s[8:11], s12 offen offset:3072 lds
  s_add_u32 s12, s12, 128
  s_and_b32 s12, s12, 1023
  s_waitcnt vmcnt(16)
  s_barrier
  s_lshl_b32 s14, s12, 7
  s_add_u32 m0, s31, 98304
  s_add_u32 s14, s14, s13
  buffer_load_dwordx4 v104, s[16:19], s14 offen offset:0 sc1 lds
  buffer_load_dwordx4 v104, s[16:19], s14 offen offset:1024 sc1 lds
  buffer_load_dwordx4 v104, s[16:19], s14 offen offset:2048 sc1 lds
  buffer_load_dwordx4 v104, s[16:19], s14 offen offset:3072 sc1 lds
  s_add_u32 m0, s31, 114688
  s_nop 0
  buffer_load_dwordx4 v105, s[8:11], s12 offen offset:0 lds
  buffer_load_dwordx4 v106, s[8:11], s12 offen offset:1024 lds
  buffer_load_dwordx4 v107, s[8:11], s12 offen offset:2048 lds
  buffer_load_dwordx4 v108, s[8:11], s12 offen offset:3072 lds
  s_add_u32 s12, s12, 128
  s_and_b32 s12, s12, 1023
  s_waitcnt vmcnt(16)
  s_barrier
  s_waitcnt vmcnt(8)
  s_barrier
  s_waitcnt vmcnt(0)
  s_barrier
  s_barrier
  s_mov_b32 s8, s82
  s_mov_b32 s9, s83
  s_mov_b32 s10, 0x0
  s_mov_b32 s11, 0x20000
  s_lshl_b32 s40, s57, 2
  s_add_u32 s40, s40, s26
  s_mul_i32 s40, s40, 28672
  v_lshlrev_b32 v2, 4, v0
  s_lshr_b32 s6, s3, 1
  s_lshl_b32 s6, s6, 2
  s_lshr_b32 s37, s4, 3
  s_add_u32 s6, s6, s37
  s_and_b32 s7, s3, 1
  s_lshl_b32 s7, s7, 3
  s_and_b32 s37, s4, 7
  s_add_u32 s7, s7, s37
  s_mov_b32 s20, s82
  s_mov_b32 s21, s83
  s_mov_b32 s22, 0x380000
  s_mov_b32 s23, 0x20000
  v_lshlrev_b32 v8, 4, v0
  s_lshl_b32 s41, s26, 11
  v_add_u32 v16, s41, v8
  v_add_u32 v17, 57344, v16
  v_lshrrev_b32 v10, 3, v0
  v_and_b32 v11, 7, v0
  v_bfe_u32 v12, v0, 4, 1
  v_lshlrev_b32 v12, 1, v12
  v_xor_b32 v11, v11, v12
  v_lshlrev_b32 v11, 4, v11
  s_lshl_b32 s37, s26, 4
  v_add_u32 v10, s37, v10
  v_lshlrev_b32 v10, 11, v10
  s_lshl_b32 s37, s7, 7
  v_add_u32 v10, s37, v10
  v_add_u32 v14, v10, v11
  v_xor_b32 v11, 64, v11
  v_add_u32 v10, 15360, v10
  v_add_u32 v15, v10, v11
  s_and_b32 s32, s3, 1
  s_mul_i32 s32, s32, 14
  s_add_u32 s43, s32, 14
  s_sub_u32 s37, s43, 28
  s_cmp_ge_u32 s43, 28
  s_cselect_b32 s43, s37, s43
  s_lshl_b32 s40, s43, 17
  s_add_u32 s43, s43, 1
  s_cmp_eq_u32 s43, 28
  s_cselect_b32 s43, 0, s43
  buffer_load_dwordx4 v[128:131], v14, s[20:23], s40 offen offset:0
  buffer_load_dwordx4 v[132:135], v15, s[20:23], s40 offen offset:1024
  s_lshl_b32 s40, s43, 17
  s_add_u32 s43, s43, 1
  s_cmp_eq_u32 s43, 28
  s_cselect_b32 s43, 0, s43
  buffer_load_dwordx4 v[136:139], v14, s[20:23], s40 offen offset:0
  buffer_load_dwordx4 v[140:143], v15, s[20:23], s40 offen offset:1024
  s_lshl_b32 s40, s43, 17
  s_add_u32 s43, s43, 1
  s_cmp_eq_u32 s43, 28
  s_cselect_b32 s43, 0, s43
  buffer_load_dwordx4 v[144:147], v14, s[20:23], s40 offen offset:0
  buffer_load_dwordx4 v[148:151], v15, s[20:23], s40 offen offset:1024
  s_lshl_b32 s40, s43, 17
  s_add_u32 s43, s43, 1
  s_cmp_eq_u32 s43, 28
  s_cselect_b32 s43, 0, s43
  buffer_load_dwordx4 v[152:155], v14, s[20:23], s40 offen offset:0
  buffer_load_dwordx4 v[156:159], v15, s[20:23], s40 offen offset:1024
  s_lshl_b32 s40, s43, 17
  s_add_u32 s43, s43, 1
  s_cmp_eq_u32 s43, 28
  s_cselect_b32 s43, 0, s43
  buffer_load_dwordx4 v[160:163], v14, s[20:23], s40 offen offset:0
  buffer_load_dwordx4 v[164:167], v15, s[20:23], s40 offen offset:1024
  s_lshl_b32 s40, s43, 17
  s_add_u32 s43, s43, 1
  s_cmp_eq_u32 s43, 28
  s_cselect_b32 s43, 0, s43
  buffer_load_dwordx4 v[168:171], v14, s[20:23], s40 offen offset:0
  buffer_load_dwordx4 v[172:175], v15, s[20:23], s40 offen offset:1024
  s_lshl_b32 s40, s43, 17
  s_add_u32 s43, s43, 1
  s_cmp_eq_u32 s43, 28
  s_cselect_b32 s43, 0, s43
  buffer_load_dwordx4 v[176:179], v14, s[20:23], s40 offen offset:0
  buffer_load_dwordx4 v[180:183], v15, s[20:23], s40 offen offset:1024
  s_lshl_b32 s40, s43, 17
  s_add_u32 s43, s43, 1
  s_cmp_eq_u32 s43, 28
  s_cselect_b32 s43, 0, s43
  buffer_load_dwordx4 v[184:187], v14, s[20:23], s40 offen offset:0
  buffer_load_dwordx4 v[188:191], v15, s[20:23], s40 offen offset:1024
  s_lshl_b32 s40, s43, 17
  s_add_u32 s43, s43, 1
  s_cmp_eq_u32 s43, 28
  s_cselect_b32 s43, 0, s43
  buffer_load_dwordx4 v[192:195], v14, s[20:23], s40 offen offset:0
  buffer_load_dwordx4 v[196:199], v15, s[20:23], s40 offen offset:1024
  s_lshl_b32 s40, s43, 17
  s_add_u32 s43, s43, 1
  s_cmp_eq_u32 s43, 28
  s_cselect_b32 s43, 0, s43
  buffer_load_dwordx4 v[200:203], v14, s[20:23], s40 offen offset:0
  buffer_load_dwordx4 v[204:207], v15, s[20:23], s40 offen offset:1024
  s_lshl_b32 s40, s43, 17
  s_add_u32 s43, s43, 1
  s_cmp_eq_u32 s43, 28
  s_cselect_b32 s43, 0, s43
  buffer_load_dwordx4 v[208:211], v14, s[20:23], s40 offen offset:0
  buffer_load_dwordx4 v[212:215], v15, s[20:23], s40 offen offset:1024
  s_lshl_b32 s40, s43, 17
  s_add_u32 s43, s43, 1
  s_cmp_eq_u32 s43, 28
  s_cselect_b32 s43, 0, s43
  buffer_load_dwordx4 v[216:219], v14, s[20:23], s40 offen offset:0
  buffer_load_dwordx4 v[220:223], v15, s[20:23], s40 offen offset:1024
  s_lshl_b32 s40, s43, 17
  s_add_u32 s43, s43, 1
  s_cmp_eq_u32 s43, 28
  s_cselect_b32 s43, 0, s43
  buffer_load_dwordx4 v[224:227], v14, s[20:23], s40 offen offset:0
  buffer_load_dwordx4 v[228:231], v15, s[20:23], s40 offen offset:1024
  s_lshl_b32 s40, s43, 17
  s_add_u32 s43, s43, 1
  s_cmp_eq_u32 s43, 28
  s_cselect_b32 s43, 0, s43
  buffer_load_dwordx4 v[232:235], v14, s[20:23], s40 offen offset:0
  buffer_load_dwordx4 v[236:239], v15, s[20:23], s40 offen offset:1024
  s_branch L4_load
L3_scons:
  v_and_b32 v14, 15, v0
  v_lshrrev_b32 v15, 4, v0
  v_lshrrev_b32 v16, 1, v14
  v_xor_b32 v15, v15, v16
  v_lshlrev_b32 v15, 4, v15
  v_lshl_add_u32 v12, v14, 7, v15
  v_xor_b32 v13, 64, v12
  v_lshrrev_b32 v15, 4, v0
  v_bfe_u32 v11, v0, 2, 2
  v_lshlrev_b32 v11, 3, v11
  v_and_b32 v16, 3, v0
  v_add_u32 v11, v11, v16
  s_lshl_b32 s37, s28, 13
  s_add_u32 s37, s37, 16384
  v_add_u32 v4, s37, v12
  v_add_u32 v5, s37, v13
  v_and_b32 v16, 1, v0
  v_bfe_u32 v17, v0, 2, 2
  v_lshlrev_b32 v17, 2, v17
  v_bfe_u32 v18, v0, 1, 1
  v_add_u32 v17, v17, v18
  v_lshl_add_u32 v17, v16, 1, v17
  v_lshlrev_b32 v17, 5, v17
  v_lshl_add_u32 v17, v16, 11, v17
  v_lshrrev_b32 v18, 1, v15
  v_lshl_add_u32 v17, v18, 12, v17
  v_and_b32 v18, 1, v15
  v_lshl_add_u32 v17, v18, 4, v17
  s_lshl_b32 s37, s27, 10
  v_add_u32 v2, s37, v17
  v_xor_b32 v3, 64, v2
  v_add_u32 v6, 0x10000, v2
  v_add_u32 v7, 0x10000, v3
  v_add_u32 v8, 0x10000, v4
  v_add_u32 v9, 0x10000, v5
  v_mov_b32 v128, 0
  v_mov_b32 v129, 0
  v_mov_b32 v130, 0
  v_mov_b32 v131, 0
  v_mov_b32 v132, 0
  v_mov_b32 v133, 0
  v_mov_b32 v134, 0
  v_mov_b32 v135, 0
  v_mov_b32 v136, 0
  v_mov_b32 v137, 0
  v_mov_b32 v138, 0
  v_mov_b32 v139, 0
  v_mov_b32 v140, 0
  v_mov_b32 v141, 0
  v_mov_b32 v142, 0
  v_mov_b32 v143, 0
  v_mov_b32 v144, 0
  v_mov_b32 v145, 0
  v_mov_b32 v146, 0
  v_mov_b32 v147, 0
  v_mov_b32 v148, 0
  v_mov_b32 v149, 0
  v_mov_b32 v150, 0
  v_mov_b32 v151, 0
  v_mov_b32 v152, 0
  v_mov_b32 v153, 0
  v_mov_b32 v154, 0
  v_mov_b32 v155, 0
  v_mov_b32 v156, 0
  v_mov_b32 v157, 0
  v_mov_b32 v158, 0
  v_mov_b32 v159, 0
  v_mov_b32 v160, 0
  v_mov_b32 v161, 0
  v_mov_b32 v162, 0
  v_mov_b32 v163, 0
  v_mov_b32 v164, 0
  v_mov_b32 v165, 0
  v_mov_b32 v166, 0
  v_mov_b32 v167, 0
  v_mov_b32 v168, 0
  v_mov_b32 v169, 0
  v_mov_b32 v170, 0
  v_mov_b32 v171, 0
  v_mov_b32 v172, 0
  v_mov_b32 v173, 0
  v_mov_b32 v174, 0
  v_mov_b32 v175, 0
  v_mov_b32 v176, 0
  v_mov_b32 v177, 0
  v_mov_b32 v178, 0
  v_mov_b32 v179, 0
  v_mov_b32 v180, 0
  v_mov_b32 v181, 0
  v_mov_b32 v182, 0
  v_mov_b32 v183, 0
  v_mov_b32 v184, 0
  v_mov_b32 v185, 0
  v_mov_b32 v186, 0
  v_mov_b32 v187, 0
  v_mov_b32 v188, 0
  v_mov_b32 v189, 0
  v_mov_b32 v190, 0
  v_mov_b32 v191, 0
  s_lshl_b32 s37, s50, 9
  s_lshl_b32 s40, s27, 8
  s_add_u32 s37, s37, s40
  s_lshl_b32 s40, s48, 12
  s_add_u32 s37, s37, s40
  s_add_u32 s37, s37, 28311552
  v_lshlrev_b32 v16, 5, v15
  s_mov_b32 s38, 0
  s_setprio 1
  s_barrier
  buffer_load_dwordx4 v[96:99], v16, s[16:19], s37 offen offset:0 sc1
  buffer_load_dwordx4 v[100:103], v16, s[16:19], s37 offen offset:16 sc1
  buffer_load_dwordx4 v[104:107], v16, s[16:19], s37 offen offset:128 sc1
  buffer_load_dwordx4 v[108:111], v16, s[16:19], s37 offen offset:144 sc1
  v_lshrrev_b32 v17, 1, v0
  v_lshlrev_b32 v17, 6, v17
  v_and_b32 v18, 1, v0
  v_lshl_add_u32 v17, v18, 4, v17
  s_lshl_b32 s40, s48, 5
  s_add_u32 s40, s40, 28319744
  buffer_load_dwordx4 v[24:27], v17, s[16:19], s40 offen sc1
  v_mov_b32 v18, 0
  s_mov_b32 s40, 28332032
  buffer_load_dword v22, v18, s[16:19], s40 offen sc1
  s_lshl_b32 s40, s26, 10
  s_add_u32 s40, s40, 148480
  v_lshlrev_b32 v17, 4, v0
  v_add_u32 v17, s40, v17
  v_lshlrev_b32 v10, 4, v15
  v_add_u32 v10, s40, v10
  v_mov_b32 v192, 0
  v_mov_b32 v193, 0
  v_mov_b32 v194, 0
  v_mov_b32 v195, 0
  v_mov_b32 v196, 0
  v_mov_b32 v197, 0
  v_mov_b32 v198, 0
  v_mov_b32 v199, 0
  v_mov_b32 v200, 0
  v_mov_b32 v201, 0
  v_mov_b32 v202, 0
  v_mov_b32 v203, 0
  v_mov_b32 v204, 0
  v_mov_b32 v205, 0
  v_mov_b32 v206, 0
  v_mov_b32 v207, 0
  v_mov_b32 v208, 0
  v_mov_b32 v209, 0
  v_mov_b32 v210, 0
  v_mov_b32 v211, 0
  v_mov_b32 v212, 0
  v_mov_b32 v213, 0
  v_mov_b32 v214, 0
  v_mov_b32 v215, 0
  v_mov_b32 v216, 0
  v_mov_b32 v217, 0
  v_mov_b32 v218, 0
  v_mov_b32 v219, 0
  v_mov_b32 v220, 0
  v_mov_b32 v221, 0
  v_mov_b32 v222, 0
  v_mov_b32 v223, 0
  v_mov_b32 v224, 0
  v_mov_b32 v225, 0
  v_mov_b32 v226, 0
  v_mov_b32 v227, 0
  v_mov_b32 v228, 0xbf803f80
  v_mov_b32 v229, 0xbf803f80
  v_mov_b32 v230, 0xbf803f80
  v_mov_b32 v231, 0xbf803f80
  s_waitcnt vmcnt(1)
  ds_write_b128 v17, v[24:27]
  ds_read_b128 v[32:35], v2 offset:0
  ds_read_b128 v[48:51], v4 offset:0
  ds_read_b128 v[52:55], v4 offset:2048
  ds_read_b128 v[56:59], v4 offset:4096
  ds_read_b128 v[60:63], v4 offset:6144
  ds_read_b128 v[36:39], v3 offset:0
  ds_read_b128 v[40:43], v2 offset:512
  ds_read_b128 v[44:47], v3 offset:512
  ds_read_b128 v[232:235], v10 offset:0
  s_mov_b32 s35, 2
  .p2align 6
L1_k_21:
  s_waitcnt lgkmcnt(0)
  v_mfma_f32_16x16x32_bf16 v[128:131], v[32:35], v[48:51], v[128:131]
  ds_read_b128 v[64:67], v2 offset:8192
  v_mfma_f32_16x16x32_bf16 v[132:135], v[32:35], v[52:55], v[132:135]
  ds_read_b128 v[80:83], v5 offset:0
  v_mfma_f32_16x16x32_bf16 v[136:139], v[32:35], v[56:59], v[136:139]
  ds_read_b128 v[84:87], v5 offset:2048
  v_mfma_f32_16x16x32_bf16 v[140:143], v[32:35], v[60:63], v[140:143]
  v_mfma_f32_16x16x32_bf16 v[144:147], v[36:39], v[48:51], v[144:147]
  ds_read_b128 v[88:91], v5 offset:4096
  v_mfma_f32_16x16x32_bf16 v[148:151], v[36:39], v[52:55], v[148:151]
  ds_read_b128 v[92:95], v5 offset:6144
  v_mfma_f32_16x16x32_bf16 v[152:155], v[36:39], v[56:59], v[152:155]
  ds_read_b128 v[68:71], v3 offset:8192
  v_mfma_f32_16x16x32_bf16 v[156:159], v[36:39], v[60:63], v[156:159]
  v_mfma_f32_16x16x32_bf16 v[160:163], v[40:43], v[48:51], v[160:163]
  ds_read_b128 v[72:75], v2 offset:8704
  v_mfma_f32_16x16x32_bf16 v[164:167], v[40:43], v[52:55], v[164:167]
  ds_read_b128 v[76:79], v3 offset:8704
  v_mfma_f32_16x16x32_bf16 v[168:171], v[40:43], v[56:59], v[168:171]
  ds_read_b128 v[236:239], v10 offset:64
  v_mfma_f32_16x16x32_bf16 v[172:175], v[40:43], v[60:63], v[172:175]
  v_mfma_f32_16x16x32_bf16 v[176:179], v[44:47], v[48:51], v[176:179]
  v_mfma_f32_16x16x32_bf16 v[180:183], v[44:47], v[52:55], v[180:183]
  v_mfma_f32_16x16x32_bf16 v[184:187], v[44:47], v[56:59], v[184:187]
  v_mfma_f32_16x16x32_bf16 v[188:191], v[44:47], v[60:63], v[188:191]
  v_mfma_f32_16x16x32_bf16 v[192:195], v[32:35], v[228:231], v[192:195]
  v_mfma_f32_16x16x32_bf16 v[196:199], v[36:39], v[228:231], v[196:199]
  v_mfma_f32_16x16x32_bf16 v[200:203], v[40:43], v[228:231], v[200:203]
  v_mfma_f32_16x16x32_bf16 v[204:207], v[44:47], v[228:231], v[204:207]
  v_mfma_f32_16x16x32_bf16 v[208:211], v[232:235], v[48:51], v[208:211]
  v_mfma_f32_16x16x32_bf16 v[212:215], v[232:235], v[52:55], v[212:215]
  v_mfma_f32_16x16x32_bf16 v[216:219], v[232:235], v[56:59], v[216:219]
  v_mfma_f32_16x16x32_bf16 v[220:223], v[232:235], v[60:63], v[220:223]
  v_mfma_f32_16x16x32_bf16 v[224:227], v[232:235], v[228:231], v[224:227]
  s_waitcnt lgkmcnt(0)
  s_barrier
  v_mfma_f32_16x16x32_bf16 v[128:131], v[64:67], v[80:83], v[128:131]
  ds_read_b128 v[32:35], v2 offset:32768
  v_mfma_f32_16x16x32_bf16 v[132:135], v[64:67], v[84:87], v[132:135]
  ds_read_b128 v[48:51], v4 offset:32768
  v_mfma_f32_16x16x32_bf16 v[136:139], v[64:67], v[88:91], v[136:139]
  ds_read_b128 v[52:55], v4 offset:34816
  v_mfma_f32_16x16x32_bf16 v[140:143], v[64:67], v[92:95], v[140:143]
  v_mfma_f32_16x16x32_bf16 v[144:147], v[68:71], v[80:83], v[144:147]
  ds_read_b128 v[56:59], v4 offset:36864
  v_mfma_f32_16x16x32_bf16 v[148:151], v[68:71], v[84:87], v[148:151]
  ds_read_b128 v[60:63], v4 offset:38912
  v_mfma_f32_16x16x32_bf16 v[152:155], v[68:71], v[88:91], v[152:155]
  ds_read_b128 v[36:39], v3 offset:32768
  v_mfma_f32_16x16x32_bf16 v[156:159], v[68:71], v[92:95], v[156:159]
  v_mfma_f32_16x16x32_bf16 v[160:163], v[72:75], v[80:83], v[160:163]
  ds_read_b128 v[40:43], v2 offset:33280
  v_mfma_f32_16x16x32_bf16 v[164:167], v[72:75], v[84:87], v[164:167]
  ds_read_b128 v[44:47], v3 offset:33280
  v_mfma_f32_16x16x32_bf16 v[168:171], v[72:75], v[88:91], v[168:171]
  ds_read_b128 v[232:235], v10 offset:128
  v_mfma_f32_16x16x32_bf16 v[172:175], v[72:75], v[92:95], v[172:175]
  v_mfma_f32_16x16x32_bf16 v[176:179], v[76:79], v[80:83], v[176:179]
  v_mfma_f32_16x16x32_bf16 v[180:183], v[76:79], v[84:87], v[180:183]
  v_mfma_f32_16x16x32_bf16 v[184:187], v[76:79], v[88:91], v[184:187]
  v_mfma_f32_16x16x32_bf16 v[188:191], v[76:79], v[92:95], v[188:191]
  v_mfma_f32_16x16x32_bf16 v[192:195], v[64:67], v[228:231], v[192:195]
  v_mfma_f32_16x16x32_bf16 v[196:199], v[68:71], v[228:231], v[196:199]
  v_mfma_f32_16x16x32_bf16 v[200:203], v[72:75], v[228:231], v[200:203]
  v_mfma_f32_16x16x32_bf16 v[204:207], v[76:79], v[228:231], v[204:207]
  v_mfma_f32_16x16x32_bf16 v[208:211], v[236:239], v[80:83], v[208:211]
  v_mfma_f32_16x16x32_bf16 v[212:215], v[236:239], v[84:87], v[212:215]
  v_mfma_f32_16x16x32_bf16 v[216:219], v[236:239], v[88:91], v[216:219]
  v_mfma_f32_16x16x32_bf16 v[220:223], v[236:239], v[92:95], v[220:223]
  v_mfma_f32_16x16x32_bf16 v[224:227], v[236:239], v[228:231], v[224:227]
  s_waitcnt lgkmcnt(0)
  v_mfma_f32_16x16x32_bf16 v[128:131], v[32:35], v[48:51], v[128:131]
  ds_read_b128 v[64:67], v2 offset:40960
  v_mfma_f32_16x16x32_bf16 v[132:135], v[32:35], v[52:55], v[132:135]
  ds_read_b128 v[80:83], v5 offset:32768
  v_mfma_f32_16x16x32_bf16 v[136:139], v[32:35], v[56:59], v[136:139]
  ds_read_b128 v[84:87], v5 offset:34816
  v_mfma_f32_16x16x32_bf16 v[140:143], v[32:35], v[60:63], v[140:143]
  v_mfma_f32_16x16x32_bf16 v[144:147], v[36:39], v[48:51], v[144:147]
  ds_read_b128 v[88:91], v5 offset:36864
  v_mfma_f32_16x16x32_bf16 v[148:151], v[36:39], v[52:55], v[148:151]
  ds_read_b128 v[92:95], v5 offset:38912
  v_mfma_f32_16x16x32_bf16 v[152:155], v[36:39], v[56:59], v[152:155]
  ds_read_b128 v[68:71], v3 offset:40960
  v_mfma_f32_16x16x32_bf16 v[156:159], v[36:39], v[60:63], v[156:159]
  v_mfma_f32_16x16x32_bf16 v[160:163], v[40:43], v[48:51], v[160:163]
  ds_read_b128 v[72:75], v2 offset:41472
  v_mfma_f32_16x16x32_bf16 v[164:167], v[40:43], v[52:55], v[164:167]
  ds_read_b128 v[76:79], v3 offset:41472
  v_mfma_f32_16x16x32_bf16 v[168:171], v[40:43], v[56:59], v[168:171]
  ds_read_b128 v[236:239], v10 offset:192
  v_mfma_f32_16x16x32_bf16 v[172:175], v[40:43], v[60:63], v[172:175]
  v_mfma_f32_16x16x32_bf16 v[176:179], v[44:47], v[48:51], v[176:179]
  v_mfma_f32_16x16x32_bf16 v[180:183], v[44:47], v[52:55], v[180:183]
  v_mfma_f32_16x16x32_bf16 v[184:187], v[44:47], v[56:59], v[184:187]
  v_mfma_f32_16x16x32_bf16 v[188:191], v[44:47], v[60:63], v[188:191]
  v_mfma_f32_16x16x32_bf16 v[192:195], v[32:35], v[228:231], v[192:195]
  v_mfma_f32_16x16x32_bf16 v[196:199], v[36:39], v[228:231], v[196:199]
  v_mfma_f32_16x16x32_bf16 v[200:203], v[40:43], v[228:231], v[200:203]
  v_mfma_f32_16x16x32_bf16 v[204:207], v[44:47], v[228:231], v[204:207]
  v_mfma_f32_16x16x32_bf16 v[208:211], v[232:235], v[48:51], v[208:211]
  v_mfma_f32_16x16x32_bf16 v[212:215], v[232:235], v[52:55], v[212:215]
  v_mfma_f32_16x16x32_bf16 v[216:219], v[232:235], v[56:59], v[216:219]
  v_mfma_f32_16x16x32_bf16 v[220:223], v[232:235], v[60:63], v[220:223]
  v_mfma_f32_16x16x32_bf16 v[224:227], v[232:235], v[228:231], v[224:227]
  s_waitcnt lgkmcnt(0)
  s_barrier
  v_mfma_f32_16x16x32_bf16 v[128:131], v[64:67], v[80:83], v[128:131]
  ds_read_b128 v[32:35], v6 offset:0
  v_mfma_f32_16x16x32_bf16 v[132:135], v[64:67], v[84:87], v[132:135]
  ds_read_b128 v[48:51], v8 offset:0
  v_mfma_f32_16x16x32_bf16 v[136:139], v[64:67], v[88:91], v[136:139]
  ds_read_b128 v[52:55], v8 offset:2048
  v_mfma_f32_16x16x32_bf16 v[140:143], v[64:67], v[92:95], v[140:143]
  v_mfma_f32_16x16x32_bf16 v[144:147], v[68:71], v[80:83], v[144:147]
  ds_read_b128 v[56:59], v8 offset:4096
  v_mfma_f32_16x16x32_bf16 v[148:151], v[68:71], v[84:87], v[148:151]
  ds_read_b128 v[60:63], v8 offset:6144
  v_mfma_f32_16x16x32_bf16 v[152:155], v[68:71], v[88:91], v[152:155]
  ds_read_b128 v[36:39], v7 offset:0
  v_mfma_f32_16x16x32_bf16 v[156:159], v[68:71], v[92:95], v[156:159]
  v_mfma_f32_16x16x32_bf16 v[160:163], v[72:75], v[80:83], v[160:163]
  ds_read_b128 v[40:43], v6 offset:512
  v_mfma_f32_16x16x32_bf16 v[164:167], v[72:75], v[84:87], v[164:167]
  ds_read_b128 v[44:47], v7 offset:512
  v_mfma_f32_16x16x32_bf16 v[168:171], v[72:75], v[88:91], v[168:171]
  ds_read_b128 v[232:235], v10 offset:256
  v_mfma_f32_16x16x32_bf16 v[172:175], v[72:75], v[92:95], v[172:175]
  v_mfma_f32_16x16x32_bf16 v[176:179], v[76:79], v[80:83], v[176:179]
  v_mfma_f32_16x16x32_bf16 v[180:183], v[76:79], v[84:87], v[180:183]
  v_mfma_f32_16x16x32_bf16 v[184:187], v[76:79], v[88:91], v[184:187]
  v_mfma_f32_16x16x32_bf16 v[188:191], v[76:79], v[92:95], v[188:191]
  v_mfma_f32_16x16x32_bf16 v[192:195], v[64:67], v[228:231], v[192:195]
  v_mfma_f32_16x16x32_bf16 v[196:199], v[68:71], v[228:231], v[196:199]
  v_mfma_f32_16x16x32_bf16 v[200:203], v[72:75], v[228:231], v[200:203]
  v_mfma_f32_16x16x32_bf16 v[204:207], v[76:79], v[228:231], v[204:207]
  v_mfma_f32_16x16x32_bf16 v[208:211], v[236:239], v[80:83], v[208:211]
  v_mfma_f32_16x16x32_bf16 v[212:215], v[236:239], v[84:87], v[212:215]
  v_mfma_f32_16x16x32_bf16 v[216:219], v[236:239], v[88:91], v[216:219]
  v_mfma_f32_16x16x32_bf16 v[220:223], v[236:239], v[92:95], v[220:223]
  v_mfma_f32_16x16x32_bf16 v[224:227], v[236:239], v[228:231], v[224:227]
  s_waitcnt lgkmcnt(0)
  v_mfma_f32_16x16x32_bf16 v[128:131], v[32:35], v[48:51], v[128:131]
  ds_read_b128 v[64:67], v6 offset:8192
  v_mfma_f32_16x16x32_bf16 v[132:135], v[32:35], v[52:55], v[132:135]
  ds_read_b128 v[80:83], v9 offset:0
  v_mfma_f32_16x16x32_bf16 v[136:139], v[32:35], v[56:59], v[136:139]
  ds_read_b128 v[84:87], v9 offset:2048
  v_mfma_f32_16x16x32_bf16 v[140:143], v[32:35], v[60:63], v[140:143]
  v_mfma_f32_16x16x32_bf16 v[144:147], v[36:39], v[48:51], v[144:147]
  ds_read_b128 v[88:91], v9 offset:4096
  v_mfma_f32_16x16x32_bf16 v[148:151], v[36:39], v[52:55], v[148:151]
  ds_read_b128 v[92:95], v9 offset:6144
  v_mfma_f32_16x16x32_bf16 v[152:155], v[36:39], v[56:59], v[152:155]
  ds_read_b128 v[68:71], v7 offset:8192
  v_mfma_f32_16x16x32_bf16 v[156:159], v[36:39], v[60:63], v[156:159]
  v_mfma_f32_16x16x32_bf16 v[160:163], v[40:43], v[48:51], v[160:163]
  ds_read_b128 v[72:75], v6 offset:8704
  v_mfma_f32_16x16x32_bf16 v[164:167], v[40:43], v[52:55], v[164:167]
  ds_read_b128 v[76:79], v7 offset:8704
  v_mfma_f32_16x16x32_bf16 v[168:171], v[40:43], v[56:59], v[168:171]
  ds_read_b128 v[236:239], v10 offset:320
  v_mfma_f32_16x16x32_bf16 v[172:175], v[40:43], v[60:63], v[172:175]
  v_mfma_f32_16x16x32_bf16 v[176:179], v[44:47], v[48:51], v[176:179]
  v_mfma_f32_16x16x32_bf16 v[180:183], v[44:47], v[52:55], v[180:183]
  v_mfma_f32_16x16x32_bf16 v[184:187], v[44:47], v[56:59], v[184:187]
  v_mfma_f32_16x16x32_bf16 v[188:191], v[44:47], v[60:63], v[188:191]
  v_mfma_f32_16x16x32_bf16 v[192:195], v[32:35], v[228:231], v[192:195]
  v_mfma_f32_16x16x32_bf16 v[196:199], v[36:39], v[228:231], v[196:199]
  v_mfma_f32_16x16x32_bf16 v[200:203], v[40:43], v[228:231], v[200:203]
  v_mfma_f32_16x16x32_bf16 v[204:207], v[44:47], v[228:231], v[204:207]
  v_mfma_f32_16x16x32_bf16 v[208:211], v[232:235], v[48:51], v[208:211]
  v_mfma_f32_16x16x32_bf16 v[212:215], v[232:235], v[52:55], v[212:215]
  v_mfma_f32_16x16x32_bf16 v[216:219], v[232:235], v[56:59], v[216:219]
  v_mfma_f32_16x16x32_bf16 v[220:223], v[232:235], v[60:63], v[220:223]
  v_mfma_f32_16x16x32_bf16 v[224:227], v[232:235], v[228:231], v[224:227]
  s_waitcnt lgkmcnt(0)
  s_barrier
  v_mfma_f32_16x16x32_bf16 v[128:131], v[64:67], v[80:83], v[128:131]
  ds_read_b128 v[32:35], v6 offset:32768
  v_mfma_f32_16x16x32_bf16 v[132:135], v[64:67], v[84:87], v[132:135]
  ds_read_b128 v[48:51], v8 offset:32768
  v_mfma_f32_16x16x32_bf16 v[136:139], v[64:67], v[88:91], v[136:139]
  ds_read_b128 v[52:55], v8 offset:34816
  v_mfma_f32_16x16x32_bf16 v[140:143], v[64:67], v[92:95], v[140:143]
  v_mfma_f32_16x16x32_bf16 v[144:147], v[68:71], v[80:83], v[144:147]
  ds_read_b128 v[56:59], v8 offset:36864
  v_mfma_f32_16x16x32_bf16 v[148:151], v[68:71], v[84:87], v[148:151]
  ds_read_b128 v[60:63], v8 offset:38912
  v_mfma_f32_16x16x32_bf16 v[152:155], v[68:71], v[88:91], v[152:155]
  ds_read_b128 v[36:39], v7 offset:32768
  v_mfma_f32_16x16x32_bf16 v[156:159], v[68:71], v[92:95], v[156:159]
  v_mfma_f32_16x16x32_bf16 v[160:163], v[72:75], v[80:83], v[160:163]
  ds_read_b128 v[40:43], v6 offset:33280
  v_mfma_f32_16x16x32_bf16 v[164:167], v[72:75], v[84:87], v[164:167]
  ds_read_b128 v[44:47], v7 offset:33280
  v_mfma_f32_16x16x32_bf16 v[168:171], v[72:75], v[88:91], v[168:171]
  ds_read_b128 v[232:235], v10 offset:384
  v_mfma_f32_16x16x32_bf16 v[172:175], v[72:75], v[92:95], v[172:175]
  v_mfma_f32_16x16x32_bf16 v[176:179], v[76:79], v[80:83], v[176:179]
  v_mfma_f32_16x16x32_bf16 v[180:183], v[76:79], v[84:87], v[180:183]
  v_mfma_f32_16x16x32_bf16 v[184:187], v[76:79], v[88:91], v[184:187]
  v_mfma_f32_16x16x32_bf16 v[188:191], v[76:79], v[92:95], v[188:191]
  v_mfma_f32_16x16x32_bf16 v[192:195], v[64:67], v[228:231], v[192:195]
  v_mfma_f32_16x16x32_bf16 v[196:199], v[68:71], v[228:231], v[196:199]
  v_mfma_f32_16x16x32_bf16 v[200:203], v[72:75], v[228:231], v[200:203]
  v_mfma_f32_16x16x32_bf16 v[204:207], v[76:79], v[228:231], v[204:207]
  v_mfma_f32_16x16x32_bf16 v[208:211], v[236:239], v[80:83], v[208:211]
  v_mfma_f32_16x16x32_bf16 v[212:215], v[236:239], v[84:87], v[212:215]
  v_mfma_f32_16x16x32_bf16 v[216:219], v[236:239], v[88:91], v[216:219]
  v_mfma_f32_16x16x32_bf16 v[220:223], v[236:239], v[92:95], v[220:223]
  v_mfma_f32_16x16x32_bf16 v[224:227], v[236:239], v[228:231], v[224:227]
  s_waitcnt lgkmcnt(0)
  v_mfma_f32_16x16x32_bf16 v[128:131], v[32:35], v[48:51], v[128:131]
  ds_read_b128 v[64:67], v6 offset:40960
  v_mfma_f32_16x16x32_bf16 v[132:135], v[32:35], v[52:55], v[132:135]
  ds_read_b128 v[80:83], v9 offset:32768
  v_mfma_f32_16x16x32_bf16 v[136:139], v[32:35], v[56:59], v[136:139]
  ds_read_b128 v[84:87], v9 offset:34816
  v_mfma_f32_16x16x32_bf16 v[140:143], v[32:35], v[60:63], v[140:143]
  v_mfma_f32_16x16x32_bf16 v[144:147], v[36:39], v[48:51], v[144:147]
  ds_read_b128 v[88:91], v9 offset:36864
  v_mfma_f32_16x16x32_bf16 v[148:151], v[36:39], v[52:55], v[148:151]
  ds_read_b128 v[92:95], v9 offset:38912
  v_mfma_f32_16x16x32_bf16 v[152:155], v[36:39], v[56:59], v[152:155]
  ds_read_b128 v[68:71], v7 offset:40960
  v_mfma_f32_16x16x32_bf16 v[156:159], v[36:39], v[60:63], v[156:159]
  v_mfma_f32_16x16x32_bf16 v[160:163], v[40:43], v[48:51], v[160:163]
  ds_read_b128 v[72:75], v6 offset:41472
  v_mfma_f32_16x16x32_bf16 v[164:167], v[40:43], v[52:55], v[164:167]
  ds_read_b128 v[76:79], v7 offset:41472
  v_mfma_f32_16x16x32_bf16 v[168:171], v[40:43], v[56:59], v[168:171]
  ds_read_b128 v[236:239], v10 offset:448
  v_mfma_f32_16x16x32_bf16 v[172:175], v[40:43], v[60:63], v[172:175]
  v_mfma_f32_16x16x32_bf16 v[176:179], v[44:47], v[48:51], v[176:179]
  v_mfma_f32_16x16x32_bf16 v[180:183], v[44:47], v[52:55], v[180:183]
  v_mfma_f32_16x16x32_bf16 v[184:187], v[44:47], v[56:59], v[184:187]
  v_mfma_f32_16x16x32_bf16 v[188:191], v[44:47], v[60:63], v[188:191]
  v_mfma_f32_16x16x32_bf16 v[192:195], v[32:35], v[228:231], v[192:195]
  v_mfma_f32_16x16x32_bf16 v[196:199], v[36:39], v[228:231], v[196:199]
  v_mfma_f32_16x16x32_bf16 v[200:203], v[40:43], v[228:231], v[200:203]
  v_mfma_f32_16x16x32_bf16 v[204:207], v[44:47], v[228:231], v[204:207]
  v_mfma_f32_16x16x32_bf16 v[208:211], v[232:235], v[48:51], v[208:211]
  v_add_u32 v10, 512, v10
  v_mfma_f32_16x16x32_bf16 v[212:215], v[232:235], v[52:55], v[212:215]
  v_mfma_f32_16x16x32_bf16 v[216:219], v[232:235], v[56:59], v[216:219]
  v_mfma_f32_16x16x32_bf16 v[220:223], v[232:235], v[60:63], v[220:223]
  v_mfma_f32_16x16x32_bf16 v[224:227], v[232:235], v[228:231], v[224:227]
  s_waitcnt lgkmcnt(0)
  s_barrier
  v_mfma_f32_16x16x32_bf16 v[128:131], v[64:67], v[80:83], v[128:131]
  ds_read_b128 v[32:35], v2 offset:0
  v_mfma_f32_16x16x32_bf16 v[132:135], v[64:67], v[84:87], v[132:135]
  ds_read_b128 v[48:51], v4 offset:0
  v_mfma_f32_16x16x32_bf16 v[136:139], v[64:67], v[88:91], v[136:139]
  ds_read_b128 v[52:55], v4 offset:2048
  v_mfma_f32_16x16x32_bf16 v[140:143], v[64:67], v[92:95], v[140:143]
  v_mfma_f32_16x16x32_bf16 v[144:147], v[68:71], v[80:83], v[144:147]
  ds_read_b128 v[56:59], v4 offset:4096
  v_mfma_f32_16x16x32_bf16 v[148:151], v[68:71], v[84:87], v[148:151]
  ds_read_b128 v[60:63], v4 offset:6144
  v_mfma_f32_16x16x32_bf16 v[152:155], v[68:71], v[88:91], v[152:155]
  ds_read_b128 v[36:39], v3 offset:0
  v_mfma_f32_16x16x32_bf16 v[156:159], v[68:71], v[92:95], v[156:159]
  v_mfma_f32_16x16x32_bf16 v[160:163], v[72:75], v[80:83], v[160:163]
  ds_read_b128 v[40:43], v2 offset:512
  v_mfma_f32_16x16x32_bf16 v[164:167], v[72:75], v[84:87], v[164:167]
  ds_read_b128 v[44:47], v3 offset:512
  v_mfma_f32_16x16x32_bf16 v[168:171], v[72:75], v[88:91], v[168:171]
  ds_read_b128 v[232:235], v10 offset:0
  v_mfma_f32_16x16x32_bf16 v[172:175], v[72:75], v[92:95], v[172:175]
  v_mfma_f32_16x16x32_bf16 v[176:179], v[76:79], v[80:83], v[176:179]
  v_mfma_f32_16x16x32_bf16 v[180:183], v[76:79], v[84:87], v[180:183]
  v_mfma_f32_16x16x32_bf16 v[184:187], v[76:79], v[88:91], v[184:187]
  v_mfma_f32_16x16x32_bf16 v[188:191], v[76:79], v[92:95], v[188:191]
  v_mfma_f32_16x16x32_bf16 v[192:195], v[64:67], v[228:231], v[192:195]
  v_mfma_f32_16x16x32_bf16 v[196:199], v[68:71], v[228:231], v[196:199]
  v_mfma_f32_16x16x32_bf16 v[200:203], v[72:75], v[228:231], v[200:203]
  v_mfma_f32_16x16x32_bf16 v[204:207], v[76:79], v[228:231], v[204:207]
  v_mfma_f32_16x16x32_bf16 v[208:211], v[236:239], v[80:83], v[208:211]
  v_mfma_f32_16x16x32_bf16 v[212:215], v[236:239], v[84:87], v[212:215]
  v_mfma_f32_16x16x32_bf16 v[216:219], v[236:239], v[88:91], v[216:219]
  v_mfma_f32_16x16x32_bf16 v[220:223], v[236:239], v[92:95], v[220:223]
  s_sub_u32 s35, s35, 1
  s_cmp_lg_u32 s35, 0
  v_mfma_f32_16x16x32_bf16 v[224:227], v[236:239], v[228:231], v[224:227]
  s_cbranch_scc1 L1_k_21
  s_nop 7
  v_and_b32 v17, 1, v0
  v_lshlrev_b32 v17, 31, v17
  v_or_b32 v17, 0x3f800000, v17
  s_waitcnt vmcnt(0)
  s_cmp_eq_u32 s48, 0
  s_cselect_b32 s40, 1.0, 0
  v_mul_f32 v18, s40, v17
  v_mul_f32 v18, v18, v22
  s_or_b32 s40, s50, s27
  s_cmp_lg_u32 s40, 0
  s_cbranch_scc1 L3_nocol
  s_lshl_b32 s37, s49, 8
  s_lshl_b32 s40, s28, 7
  s_add_u32 s37, s37, s40
  s_add_u32 s37, s37, s48
  s_mul_i32 s37, s37, 1152
  s_add_u32 s37, s37, 29361152
  v_and_b32 v14, 15, v0
  v_mul_u32_u24 v14, 2304, v14
  v_lshl_add_u32 v14, v15, 4, v14
  v_add_u32 v16, 1245184, v14
  v_add_f32 v208, v208, v18
  v_cvt_pk_bf16_f32 v208, v208, v208
  buffer_store_dwordx4 v[208:211], v14, s[16:19], s37 offen sc1
  buffer_store_dwordx4 v[208:211], v16, s[16:19], s37 offen sc1
  s_add_u32 s37, s37, 36864
  v_add_f32 v212, v212, v18
  v_cvt_pk_bf16_f32 v212, v212, v212
  buffer_store_dwordx4 v[212:215], v14, s[16:19], s37 offen sc1
  buffer_store_dwordx4 v[212:215], v16, s[16:19], s37 offen sc1
  s_add_u32 s37, s37, 36864
  v_add_f32 v216, v216, v18
  v_cvt_pk_bf16_f32 v216, v216, v216
  buffer_store_dwordx4 v[216:219], v14, s[16:19], s37 offen sc1
  buffer_store_dwordx4 v[216:219], v16, s[16:19], s37 offen sc1
  s_add_u32 s37, s37, 36864
  v_add_f32 v220, v220, v18
  v_cvt_pk_bf16_f32 v220, v220, v220
  buffer_store_dwordx4 v[220:223], v14, s[16:19], s37 offen sc1
  buffer_store_dwordx4 v[220:223], v16, s[16:19], s37 offen sc1
  s_add_u32 s37, s37, 36864
L3_nocol:
  s_or_b32 s40, s48, s49
  s_or_b32 s40, s40, s28
  s_cmp_lg_u32 s40, 0
  s_cbranch_scc1 L3_norow
  s_lshl_b32 s37, s50, 8
  s_lshl_b32 s40, s27, 7
  s_add_u32 s37, s37, s40
  s_add_u32 s37, s37, 30539776
  v_lshlrev_b32 v14, 4, v15
  v_add_u32 v16, 1245184, v14
  v_add_f32 v192, v192, v96
  v_add_f32 v193, v193, v97
  v_add_f32 v194, v194, v98
  v_add_f32 v195, v195, v99
  v_add_f32 v196, v196, v100
  v_add_f32 v197, v197, v101
  v_add_f32 v198, v198, v102
  v_add_f32 v199, v199, v103
  v_add_f32 v200, v200, v104
  v_add_f32 v201, v201, v105
  v_add_f32 v202, v202, v106
  v_add_f32 v203, v203, v107
  v_add_f32 v204, v204, v108
  v_add_f32 v205, v205, v109
  v_add_f32 v206, v206, v110
  v_add_f32 v207, v207, v111
  v_cvt_pk_bf16_f32 v192, v192, v193
  v_cvt_pk_bf16_f32 v193, v194, v195
  v_cvt_pk_bf16_f32 v194, v196, v197
  v_cvt_pk_bf16_f32 v195, v198, v199
  v_cvt_pk_bf16_f32 v196, v200, v201
  v_cvt_pk_bf16_f32 v197, v202, v203
  v_cvt_pk_bf16_f32 v198, v204, v205
  v_cvt_pk_bf16_f32 v199, v206, v207
  v_add_f32 v224, v224, v22
  v_cvt_pk_bf16_f32 v224, v224, v224
  s_mov_b32 s40, 0x00010001
  s_mov_b32 exec_lo, s40
  s_mov_b32 exec_hi, s40
  buffer_store_dwordx4 v[192:195], v14, s[16:19], s37 offen offset:0 sc1
  buffer_store_dwordx4 v[192:195], v16, s[16:19], s37 offen offset:0 sc1
  buffer_store_dwordx4 v[196:199], v14, s[16:19], s37 offen offset:64 sc1
  buffer_store_dwordx4 v[196:199], v16, s[16:19], s37 offen offset:64 sc1
  s_mov_b32 s37, 30540800
  buffer_store_dwordx4 v[224:227], v14, s[16:19], s37 offen sc1
  buffer_store_dwordx4 v[224:227], v16, s[16:19], s37 offen sc1
  s_mov_b64 exec, -1
L3_norow:
  s_nop 1
  v_mov_b32 v192, v128
  v_mov_b32 v128, 0
  v_mov_b32 v193, v129
  v_mov_b32 v129, 0
  v_mov_b32 v194, v130
  v_mov_b32 v130, 0
  v_mov_b32 v195, v131
  v_mov_b32 v131, 0
  v_mov_b32 v196, v132
  v_mov_b32 v132, 0
  v_mov_b32 v197, v133
  v_mov_b32 v133, 0
  v_mov_b32 v198, v134
  v_mov_b32 v134, 0
  v_mov_b32 v199, v135
  v_mov_b32 v135, 0
  v_mov_b32 v200, v136
  v_mov_b32 v136, 0
  v_mov_b32 v201, v137
  v_mov_b32 v137, 0
  v_mov_b32 v202, v138
  v_mov_b32 v138, 0
  v_mov_b32 v203, v139
  v_mov_b32 v139, 0
  v_mov_b32 v204, v140
  v_mov_b32 v140, 0
  v_mov_b32 v205, v141
  v_mov_b32 v141, 0
  v_mov_b32 v206, v142
  v_mov_b32 v142, 0
  v_mov_b32 v207, v143
  v_mov_b32 v143, 0
  v_mov_b32 v208, v144
  v_mov_b32 v144, 0
  v_mov_b32 v209, v145
  v_mov_b32 v145, 0
  v_mov_b32 v210, v146
  v_mov_b32 v146, 0
  v_mov_b32 v211, v147
  v_mov_b32 v147, 0
  v_mov_b32 v212, v148
  v_mov_b32 v148, 0
  v_mov_b32 v213, v149
  v_mov_b32 v149, 0
  v_mov_b32 v214, v150
  v_mov_b32 v150, 0
  v_mov_b32 v215, v151
  v_mov_b32 v151, 0
  v_mov_b32 v216, v152
  v_mov_b32 v152, 0
  v_mov_b32 v217, v153
  v_mov_b32 v153, 0
  v_mov_b32 v218, v154
  v_mov_b32 v154, 0
  v_mov_b32 v219, v155
  v_mov_b32 v155, 0
  v_mov_b32 v220, v156
  v_mov_b32 v156, 0
  v_mov_b32 v221, v157
  v_mov_b32 v157, 0
  v_mov_b32 v222, v158
  v_mov_b32 v158, 0
  v_mov_b32 v223, v159
  v_mov_b32 v159, 0
  v_mov_b32 v224, v160
  v_mov_b32 v160, 0
  v_mov_b32 v225, v161
  v_mov_b32 v161, 0
  v_mov_b32 v226, v162
  v_mov_b32 v162, 0
  v_mov_b32 v227, v163
  v_mov_b32 v163, 0
  v_mov_b32 v228, v164
  v_mov_b32 v164, 0
  v_mov_b32 v229, v165
  v_mov_b32 v165, 0
  v_mov_b32 v230, v166
  v_mov_b32 v166, 0
  v_mov_b32 v231, v167
  v_mov_b32 v167, 0
  v_mov_b32 v232, v168
  v_mov_b32 v168, 0
  v_mov_b32 v233, v169
  v_mov_b32 v169, 0
  v_mov_b32 v234, v170
  v_mov_b32 v170, 0
  v_mov_b32 v235, v171
  v_mov_b32 v171, 0
  v_mov_b32 v236, v172
  v_mov_b32 v172, 0
  v_mov_b32 v237, v173
  v_mov_b32 v173, 0
  v_mov_b32 v238, v174
  v_mov_b32 v174, 0
  v_mov_b32 v239, v175
  v_mov_b32 v175, 0
  v_mov_b32 v240, v176
  v_mov_b32 v176, 0
  v_mov_b32 v241, v177
  v_mov_b32 v177, 0
  v_mov_b32 v242, v178
  v_mov_b32 v178, 0
  v_mov_b32 v243, v179
  v_mov_b32 v179, 0
  v_mov_b32 v244, v180
  v_mov_b32 v180, 0
  v_mov_b32 v245, v181
  v_mov_b32 v181, 0
  v_mov_b32 v246, v182
  v_mov_b32 v182, 0
  v_mov_b32 v247, v183
  v_mov_b32 v183, 0
  v_mov_b32 v248, v184
  v_mov_b32 v184, 0
  v_mov_b32 v249, v185
  v_mov_b32 v185, 0
  v_mov_b32 v250, v186
  v_mov_b32 v186, 0
  v_mov_b32 v251, v187
  v_mov_b32 v187, 0
  v_mov_b32 v252, v188
  v_mov_b32 v188, 0
  v_mov_b32 v253, v189
  v_mov_b32 v189, 0
  v_mov_b32 v254, v190
  v_mov_b32 v190, 0
  v_mov_b32 v255, v191
  v_mov_b32 v191, 0
  s_nop 1
  s_mov_b32 s35, 2
  .p2align 6
L1_k_22:
  s_waitcnt lgkmcnt(0)
  v_mfma_f32_16x16x32_bf16 v[128:131], v[32:35], v[48:51], v[128:131]
  ds_read_b128 v[64:67], v2 offset:8192
  v_mfma_f32_16x16x32_bf16 v[132:135], v[32:35], v[52:55], v[132:135]
  ds_read_b128 v[80:83], v5 offset:0
  v_mfma_f32_16x16x32_bf16 v[136:139], v[32:35], v[56:59], v[136:139]
  ds_read_b128 v[84:87], v5 offset:2048
  v_mfma_f32_16x16x32_bf16 v[140:143], v[32:35], v[60:63], v[140:143]
  ds_read_b128 v[88:91], v5 offset:4096
  v_mfma_f32_16x16x32_bf16 v[144:147], v[36:39], v[48:51], v[144:147]
  ds_read_b128 v[92:95], v5 offset:6144
  v_mfma_f32_16x16x32_bf16 v[148:151], v[36:39], v[52:55], v[148:151]
  ds_read_b128 v[68:71], v3 offset:8192
  v_mfma_f32_16x16x32_bf16 v[152:155], v[36:39], v[56:59], v[152:155]
  ds_read_b128 v[72:75], v2 offset:8704
  v_mfma_f32_16x16x32_bf16 v[156:159], v[36:39], v[60:63], v[156:159]
  ds_read_b128 v[76:79], v3 offset:8704
  v_mfma_f32_16x16x32_bf16 v[160:163], v[40:43], v[48:51], v[160:163]
  v_mfma_f32_16x16x32_bf16 v[164:167], v[40:43], v[52:55], v[164:167]
  v_mfma_f32_16x16x32_bf16 v[168:171], v[40:43], v[56:59], v[168:171]
  v_mfma_f32_16x16x32_bf16 v[172:175], v[40:43], v[60:63], v[172:175]
  v_mfma_f32_16x16x32_bf16 v[176:179], v[44:47], v[48:51], v[176:179]
  v_mfma_f32_16x16x32_bf16 v[180:183], v[44:47], v[52:55], v[180:183]
  v_mfma_f32_16x16x32_bf16 v[184:187], v[44:47], v[56:59], v[184:187]
  v_mfma_f32_16x16x32_bf16 v[188:191], v[44:47], v[60:63], v[188:191]
  s_waitcnt lgkmcnt(0)
  s_barrier
  v_mfma_f32_16x16x32_bf16 v[128:131], v[64:67], v[80:83], v[128:131]
  ds_read_b128 v[32:35], v2 offset:32768
  v_mfma_f32_16x16x32_bf16 v[132:135], v[64:67], v[84:87], v[132:135]
  ds_read_b128 v[48:51], v4 offset:32768
  v_mfma_f32_16x16x32_bf16 v[136:139], v[64:67], v[88:91], v[136:139]
  ds_read_b128 v[52:55], v4 offset:34816
  v_mfma_f32_16x16x32_bf16 v[140:143], v[64:67], v[92:95], v[140:143]
  ds_read_b128 v[56:59], v4 offset:36864
  v_mfma_f32_16x16x32_bf16 v[144:147], v[68:71], v[80:83], v[144:147]
  ds_read_b128 v[60:63], v4 offset:38912
  v_mfma_f32_16x16x32_bf16 v[148:151], v[68:71], v[84:87], v[148:151]
  ds_read_b128 v[36:39], v3 offset:32768
  v_mfma_f32_16x16x32_bf16 v[152:155], v[68:71], v[88:91], v[152:155]
  ds_read_b128 v[40:43], v2 offset:33280
  v_mfma_f32_16x16x32_bf16 v[156:159], v[68:71], v[92:95], v[156:159]
  ds_read_b128 v[44:47], v3 offset:33280
  v_mfma_f32_16x16x32_bf16 v[160:163], v[72:75], v[80:83], v[160:163]
  v_mfma_f32_16x16x32_bf16 v[164:167], v[72:75], v[84:87], v[164:167]
  v_mfma_f32_16x16x32_bf16 v[168:171], v[72:75], v[88:91], v[168:171]
  v_mfma_f32_16x16x32_bf16 v[172:175], v[72:75], v[92:95], v[172:175]
  v_mfma_f32_16x16x32_bf16 v[176:179], v[76:79], v[80:83], v[176:179]
  v_mfma_f32_16x16x32_bf16 v[180:183], v[76:79], v[84:87], v[180:183]
  v_mfma_f32_16x16x32_bf16 v[184:187], v[76:79], v[88:91], v[184:187]
  v_mfma_f32_16x16x32_bf16 v[188:191], v[76:79], v[92:95], v[188:191]
  s_waitcnt lgkmcnt(0)
  v_mfma_f32_16x16x32_bf16 v[128:131], v[32:35], v[48:51], v[128:131]
  ds_read_b128 v[64:67], v2 offset:40960
  v_mfma_f32_16x16x32_bf16 v[132:135], v[32:35], v[52:55], v[132:135]
  ds_read_b128 v[80:83], v5 offset:32768
  v_mfma_f32_16x16x32_bf16 v[136:139], v[32:35], v[56:59], v[136:139]
  ds_read_b128 v[84:87], v5 offset:34816
  v_mfma_f32_16x16x32_bf16 v[140:143], v[32:35], v[60:63], v[140:143]
  ds_read_b128 v[88:91], v5 offset:36864
  v_mfma_f32_16x16x32_bf16 v[144:147], v[36:39], v[48:51], v[144:147]
  ds_read_b128 v[92:95], v5 offset:38912
  v_mfma_f32_16x16x32_bf16 v[148:151], v[36:39], v[52:55], v[148:151]
  ds_read_b128 v[68:71], v3 offset:40960
  v_mfma_f32_16x16x32_bf16 v[152:155], v[36:39], v[56:59], v[152:155]
  ds_read_b128 v[72:75], v2 offset:41472
  v_mfma_f32_16x16x32_bf16 v[156:159], v[36:39], v[60:63], v[156:159]
  ds_read_b128 v[76:79], v3 offset:41472
  v_mfma_f32_16x16x32_bf16 v[160:163], v[40:43], v[48:51], v[160:163]
  v_mfma_f32_16x16x32_bf16 v[164:167], v[40:43], v[52:55], v[164:167]
  v_mfma_f32_16x16x32_bf16 v[168:171], v[40:43], v[56:59], v[168:171]
  v_mfma_f32_16x16x32_bf16 v[172:175], v[40:43], v[60:63], v[172:175]
  v_mfma_f32_16x16x32_bf16 v[176:179], v[44:47], v[48:51], v[176:179]
  v_mfma_f32_16x16x32_bf16 v[180:183], v[44:47], v[52:55], v[180:183]
  v_mfma_f32_16x16x32_bf16 v[184:187], v[44:47], v[56:59], v[184:187]
  v_mfma_f32_16x16x32_bf16 v[188:191], v[44:47], v[60:63], v[188:191]
  s_waitcnt lgkmcnt(0)
  s_barrier
  v_mfma_f32_16x16x32_bf16 v[128:131], v[64:67], v[80:83], v[128:131]
  ds_read_b128 v[32:35], v6 offset:0
  v_mfma_f32_16x16x32_bf16 v[132:135], v[64:67], v[84:87], v[132:135]
  ds_read_b128 v[48:51], v8 offset:0
  v_mfma_f32_16x16x32_bf16 v[136:139], v[64:67], v[88:91], v[136:139]
  ds_read_b128 v[52:55], v8 offset:2048
  v_mfma_f32_16x16x32_bf16 v[140:143], v[64:67], v[92:95], v[140:143]
  ds_read_b128 v[56:59], v8 offset:4096
  v_mfma_f32_16x16x32_bf16 v[144:147], v[68:71], v[80:83], v[144:147]
  ds_read_b128 v[60:63], v8 offset:6144
  v_mfma_f32_16x16x32_bf16 v[148:151], v[68:71], v[84:87], v[148:151]
  ds_read_b128 v[36:39], v7 offset:0
  v_mfma_f32_16x16x32_bf16 v[152:155], v[68:71], v[88:91], v[152:155]
  ds_read_b128 v[40:43], v6 offset:512
  v_mfma_f32_16x16x32_bf16 v[156:159], v[68:71], v[92:95], v[156:159]
  ds_read_b128 v[44:47], v7 offset:512
  v_mfma_f32_16x16x32_bf16 v[160:163], v[72:75], v[80:83], v[160:163]
  v_mfma_f32_16x16x32_bf16 v[164:167], v[72:75], v[84:87], v[164:167]
  v_mfma_f32_16x16x32_bf16 v[168:171], v[72:75], v[88:91], v[168:171]
  v_mfma_f32_16x16x32_bf16 v[172:175], v[72:75], v[92:95], v[172:175]
  v_mfma_f32_16x16x32_bf16 v[176:179], v[76:79], v[80:83], v[176:179]
  v_mfma_f32_16x16x32_bf16 v[180:183], v[76:79], v[84:87], v[180:183]
  v_mfma_f32_16x16x32_bf16 v[184:187], v[76:79], v[88:91], v[184:187]
  v_mfma_f32_16x16x32_bf16 v[188:191], v[76:79], v[92:95], v[188:191]
  s_waitcnt lgkmcnt(0)
  v_mfma_f32_16x16x32_bf16 v[128:131], v[32:35], v[48:51], v[128:131]
  ds_read_b128 v[64:67], v6 offset:8192
  v_mfma_f32_16x16x32_bf16 v[132:135], v[32:35], v[52:55], v[132:135]
  ds_read_b128 v[80:83], v9 offset:0
  v_mfma_f32_16x16x32_bf16 v[136:139], v[32:35], v[56:59], v[136:139]
  ds_read_b128 v[84:87], v9 offset:2048
  v_mfma_f32_16x16x32_bf16 v[140:143], v[32:35], v[60:63], v[140:143]
  ds_read_b128 v[88:91], v9 offset:4096
  v_mfma_f32_16x16x32_bf16 v[144:147], v[36:39], v[48:51], v[144:147]
  ds_read_b128 v[92:95], v9 offset:6144
  v_mfma_f32_16x16x32_bf16 v[148:151], v[36:39], v[52:55], v[148:151]
  ds_read_b128 v[68:71], v7 offset:8192
  v_mfma_f32_16x16x32_bf16 v[152:155], v[36:39], v[56:59], v[152:155]
  ds_read_b128 v[72:75], v6 offset:8704
  v_mfma_f32_16x16x32_bf16 v[156:159], v[36:39], v[60:63], v[156:159]
  ds_read_b128 v[76:79], v7 offset:8704
  v_mfma_f32_16x16x32_bf16 v[160:163], v[40:43], v[48:51], v[160:163]
  v_mfma_f32_16x16x32_bf16 v[164:167], v[40:43], v[52:55], v[164:167]
  v_mfma_f32_16x16x32_bf16 v[168:171], v[40:43], v[56:59], v[168:171]
  v_mfma_f32_16x16x32_bf16 v[172:175], v[40:43], v[60:63], v[172:175]
  v_mfma_f32_16x16x32_bf16 v[176:179], v[44:47], v[48:51], v[176:179]
  v_mfma_f32_16x16x32_bf16 v[180:183], v[44:47], v[52:55], v[180:183]
  v_mfma_f32_16x16x32_bf16 v[184:187], v[44:47], v[56:59], v[184:187]
  v_mfma_f32_16x16x32_bf16 v[188:191], v[44:47], v[60:63], v[188:191]
  s_waitcnt lgkmcnt(0)
  s_barrier
  v_mfma_f32_16x16x32_bf16 v[128:131], v[64:67], v[80:83], v[128:131]
  ds_read_b128 v[32:35], v6 offset:32768
  v_mfma_f32_16x16x32_bf16 v[132:135], v[64:67], v[84:87], v[132:135]
  ds_read_b128 v[48:51], v8 offset:32768
  v_mfma_f32_16x16x32_bf16 v[136:139], v[64:67], v[88:91], v[136:139]
  ds_read_b128 v[52:55], v8 offset:34816
  v_mfma_f32_16x16x32_bf16 v[140:143], v[64:67], v[92:95], v[140:143]
  ds_read_b128 v[56:59], v8 offset:36864
  v_mfma_f32_16x16x32_bf16 v[144:147], v[68:71], v[80:83], v[144:147]
  ds_read_b128 v[60:63], v8 offset:38912
  v_mfma_f32_16x16x32_bf16 v[148:151], v[68:71], v[84:87], v[148:151]
  ds_read_b128 v[36:39], v7 offset:32768
  v_mfma_f32_16x16x32_bf16 v[152:155], v[68:71], v[88:91], v[152:155]
  ds_read_b128 v[40:43], v6 offset:33280
  v_mfma_f32_16x16x32_bf16 v[156:159], v[68:71], v[92:95], v[156:159]
  ds_read_b128 v[44:47], v7 offset:33280
  v_mfma_f32_16x16x32_bf16 v[160:163], v[72:75], v[80:83], v[160:163]
  v_mfma_f32_16x16x32_bf16 v[164:167], v[72:75], v[84:87], v[164:167]
  v_mfma_f32_16x16x32_bf16 v[168:171], v[72:75], v[88:91], v[168:171]
  v_mfma_f32_16x16x32_bf16 v[172:175], v[72:75], v[92:95], v[172:175]
  v_mfma_f32_16x16x32_bf16 v[176:179], v[76:79], v[80:83], v[176:179]
  v_mfma_f32_16x16x32_bf16 v[180:183], v[76:79], v[84:87], v[180:183]
  v_mfma_f32_16x16x32_bf16 v[184:187], v[76:79], v[88:91], v[184:187]
  v_mfma_f32_16x16x32_bf16 v[188:191], v[76:79], v[92:95], v[188:191]
  s_waitcnt lgkmcnt(0)
  v_mfma_f32_16x16x32_bf16 v[128:131], v[32:35], v[48:51], v[128:131]
  ds_read_b128 v[64:67], v6 offset:40960
  v_mfma_f32_16x16x32_bf16 v[132:135], v[32:35], v[52:55], v[132:135]
  ds_read_b128 v[80:83], v9 offset:32768
  v_mfma_f32_16x16x32_bf16 v[136:139], v[32:35], v[56:59], v[136:139]
  ds_read_b128 v[84:87], v9 offset:34816
  v_mfma_f32_16x16x32_bf16 v[140:143], v[32:35], v[60:63], v[140:143]
  ds_read_b128 v[88:91], v9 offset:36864
  v_mfma_f32_16x16x32_bf16 v[144:147], v[36:39], v[48:51], v[144:147]
  ds_read_b128 v[92:95], v9 offset:38912
  v_mfma_f32_16x16x32_bf16 v[148:151], v[36:39], v[52:55], v[148:151]
  ds_read_b128 v[68:71], v7 offset:40960
  v_mfma_f32_16x16x32_bf16 v[152:155], v[36:39], v[56:59], v[152:155]
  ds_read_b128 v[72:75], v6 offset:41472
  v_mfma_f32_16x16x32_bf16 v[156:159], v[36:39], v[60:63], v[156:159]
  ds_read_b128 v[76:79], v7 offset:41472
  v_mfma_f32_16x16x32_bf16 v[160:163], v[40:43], v[48:51], v[160:163]
  v_mfma_f32_16x16x32_bf16 v[164:167], v[40:43], v[52:55], v[164:167]
  v_mfma_f32_16x16x32_bf16 v[168:171], v[40:43], v[56:59], v[168:171]
  v_mfma_f32_16x16x32_bf16 v[172:175], v[40:43], v[60:63], v[172:175]
  v_mfma_f32_16x16x32_bf16 v[176:179], v[44:47], v[48:51], v[176:179]
  v_mfma_f32_16x16x32_bf16 v[180:183], v[44:47], v[52:55], v[180:183]
  v_mfma_f32_16x16x32_bf16 v[184:187], v[44:47], v[56:59], v[184:187]
  v_mfma_f32_16x16x32_bf16 v[188:191], v[44:47], v[60:63], v[188:191]
  s_waitcnt lgkmcnt(0)
  s_barrier
  v_mfma_f32_16x16x32_bf16 v[128:131], v[64:67], v[80:83], v[128:131]
  ds_read_b128 v[32:35], v2 offset:0
  v_mfma_f32_16x16x32_bf16 v[132:135], v[64:67], v[84:87], v[132:135]
  ds_read_b128 v[48:51], v4 offset:0
  v_mfma_f32_16x16x32_bf16 v[136:139], v[64:67], v[88:91], v[136:139]
  ds_read_b128 v[52:55], v4 offset:2048
  v_mfma_f32_16x16x32_bf16 v[140:143], v[64:67], v[92:95], v[140:143]
  ds_read_b128 v[56:59], v4 offset:4096
  v_mfma_f32_16x16x32_bf16 v[144:147], v[68:71], v[80:83], v[144:147]
  ds_read_b128 v[60:63], v4 offset:6144
  v_mfma_f32_16x16x32_bf16 v[148:151], v[68:71], v[84:87], v[148:151]
  ds_read_b128 v[36:39], v3 offset:0
  v_mfma_f32_16x16x32_bf16 v[152:155], v[68:71], v[88:91], v[152:155]
  ds_read_b128 v[40:43], v2 offset:512
  v_mfma_f32_16x16x32_bf16 v[156:159], v[68:71], v[92:95], v[156:159]
  ds_read_b128 v[44:47], v3 offset:512
  v_mfma_f32_16x16x32_bf16 v[160:163], v[72:75], v[80:83], v[160:163]
  v_mfma_f32_16x16x32_bf16 v[164:167], v[72:75], v[84:87], v[164:167]
  v_mfma_f32_16x16x32_bf16 v[168:171], v[72:75], v[88:91], v[168:171]
  v_mfma_f32_16x16x32_bf16 v[172:175], v[72:75], v[92:95], v[172:175]
  v_mfma_f32_16x16x32_bf16 v[176:179], v[76:79], v[80:83], v[176:179]
  v_mfma_f32_16x16x32_bf16 v[180:183], v[76:79], v[84:87], v[180:183]
  v_mfma_f32_16x16x32_bf16 v[184:187], v[76:79], v[88:91], v[184:187]
  s_sub_u32 s35, s35, 1
  s_cmp_lg_u32 s35, 0
  v_mfma_f32_16x16x32_bf16 v[188:191], v[76:79], v[92:95], v[188:191]
  s_cbranch_scc1 L1_k_22
  v_and_b32 v17, 1, v0
  v_lshlrev_b32 v17, 31, v17
  v_or_b32 v17, 0x3f800000, v17
  v_mov_b32 v18, v17
  s_cmp_eq_u32 s48, 0
  s_cselect_b32 s40, 1.0, -1.0
  v_mul_f32 v20, s40, v17
  v_mul_f32 v21, s40, v17
  v_mov_b32 v19, v17
  s_lshl_b32 s37, s49, 8
  s_lshl_b32 s40, s28, 7
  s_add_u32 s37, s37, s40
  s_add_u32 s37, s37, s48
  s_mul_i32 s37, s37, 1152
  s_lshl_b32 s40, s50, 8
  s_add_u32 s37, s37, s40
  s_lshl_b32 s40, s27, 7
  s_add_u32 s37, s37, s40
  s_add_u32 s37, s37, 29360128
  v_and_b32 v14, 15, v0
  v_mul_u32_u24 v14, 2304, v14
  v_lshl_add_u32 v14, v15, 4, v14
  v_add_u32 v16, 1245184, v14
  s_waitcnt vmcnt(0) lgkmcnt(0)
  s_nop 4
  v_pk_add_f32 v[32:33], v[192:193], v[128:129] neg_lo:[0,1] neg_hi:[0,1]
  v_pk_add_f32 v[40:41], v[192:193], v[128:129]
  v_pk_add_f32 v[34:35], v[194:195], v[130:131] neg_lo:[0,1] neg_hi:[0,1]
  v_pk_add_f32 v[42:43], v[194:195], v[130:131]
  v_pk_add_f32 v[36:37], v[208:209], v[144:145] neg_lo:[0,1] neg_hi:[0,1]
  v_pk_add_f32 v[44:45], v[208:209], v[144:145]
  v_pk_add_f32 v[38:39], v[210:211], v[146:147] neg_lo:[0,1] neg_hi:[0,1]
  v_pk_add_f32 v[46:47], v[210:211], v[146:147]
  v_pk_fma_f32 v[32:33], v[96:97], v[18:19], v[32:33]
  v_pk_fma_f32 v[40:41], v[96:97], v[20:21], v[40:41]
  v_pk_fma_f32 v[34:35], v[98:99], v[18:19], v[34:35]
  v_pk_fma_f32 v[42:43], v[98:99], v[20:21], v[42:43]
  v_pk_fma_f32 v[36:37], v[100:101], v[18:19], v[36:37]
  v_pk_fma_f32 v[44:45], v[100:101], v[20:21], v[44:45]
  v_pk_fma_f32 v[38:39], v[102:103], v[18:19], v[38:39]
  v_pk_fma_f32 v[46:47], v[102:103], v[20:21], v[46:47]
  v_cvt_pk_bf16_f32 v48, v32, v33
  v_cvt_pk_bf16_f32 v52, v40, v41
  v_cvt_pk_bf16_f32 v49, v34, v35
  v_cvt_pk_bf16_f32 v53, v42, v43
  v_cvt_pk_bf16_f32 v50, v36, v37
  v_cvt_pk_bf16_f32 v54, v44, v45
  v_cvt_pk_bf16_f32 v51, v38, v39
  v_cvt_pk_bf16_f32 v55, v46, v47
  buffer_store_dwordx4 v[48:51], v14, s[16:19], s37 offen offset:0 sc1
  buffer_store_dwordx4 v[52:55], v16, s[16:19], s37 offen offset:0 sc1
  v_pk_add_f32 v[56:57], v[224:225], v[160:161] neg_lo:[0,1] neg_hi:[0,1]
  v_pk_add_f32 v[64:65], v[224:225], v[160:161]
  v_pk_add_f32 v[58:59], v[226:227], v[162:163] neg_lo:[0,1] neg_hi:[0,1]
  v_pk_add_f32 v[66:67], v[226:227], v[162:163]
  v_pk_add_f32 v[60:61], v[240:241], v[176:177] neg_lo:[0,1] neg_hi:[0,1]
  v_pk_add_f32 v[68:69], v[240:241], v[176:177]
  v_pk_add_f32 v[62:63], v[242:243], v[178:179] neg_lo:[0,1] neg_hi:[0,1]
  v_pk_add_f32 v[70:71], v[242:243], v[178:179]
  v_pk_fma_f32 v[56:57], v[104:105], v[18:19], v[56:57]
  v_pk_fma_f32 v[64:65], v[104:105], v[20:21], v[64:65]
  v_pk_fma_f32 v[58:59], v[106:107], v[18:19], v[58:59]
  v_pk_fma_f32 v[66:67], v[106:107], v[20:21], v[66:67]
  v_pk_fma_f32 v[60:61], v[108:109], v[18:19], v[60:61]
  v_pk_fma_f32 v[68:69], v[108:109], v[20:21], v[68:69]
  v_pk_fma_f32 v[62:63], v[110:111], v[18:19], v[62:63]
  v_pk_fma_f32 v[70:71], v[110:111], v[20:21], v[70:71]
  v_cvt_pk_bf16_f32 v72, v56, v57
  v_cvt_pk_bf16_f32 v76, v64, v65
  v_cvt_pk_bf16_f32 v73, v58, v59
  v_cvt_pk_bf16_f32 v77, v66, v67
  v_cvt_pk_bf16_f32 v74, v60, v61
  v_cvt_pk_bf16_f32 v78, v68, v69
  v_cvt_pk_bf16_f32 v75, v62, v63
  v_cvt_pk_bf16_f32 v79, v70, v71
  buffer_store_dwordx4 v[72:75], v14, s[16:19], s37 offen offset:64 sc1
  buffer_store_dwordx4 v[76:79], v16, s[16:19], s37 offen offset:64 sc1
  s_add_u32 s37, s37, 36864
  v_pk_add_f32 v[32:33], v[196:197], v[132:133] neg_lo:[0,1] neg_hi:[0,1]
  v_pk_add_f32 v[40:41], v[196:197], v[132:133]
  v_pk_add_f32 v[34:35], v[198:199], v[134:135] neg_lo:[0,1] neg_hi:[0,1]
  v_pk_add_f32 v[42:43], v[198:199], v[134:135]
  v_pk_add_f32 v[36:37], v[212:213], v[148:149] neg_lo:[0,1] neg_hi:[0,1]
  v_pk_add_f32 v[44:45], v[212:213], v[148:149]
  v_pk_add_f32 v[38:39], v[214:215], v[150:151] neg_lo:[0,1] neg_hi:[0,1]
  v_pk_add_f32 v[46:47], v[214:215], v[150:151]
  v_pk_fma_f32 v[32:33], v[96:97], v[18:19], v[32:33]
  v_pk_fma_f32 v[40:41], v[96:97], v[20:21], v[40:41]
  v_pk_fma_f32 v[34:35], v[98:99], v[18:19], v[34:35]
  v_pk_fma_f32 v[42:43], v[98:99], v[20:21], v[42:43]
  v_pk_fma_f32 v[36:37], v[100:101], v[18:19], v[36:37]
  v_pk_fma_f32 v[44:45], v[100:101], v[20:21], v[44:45]
  v_pk_fma_f32 v[38:39], v[102:103], v[18:19], v[38:39]
  v_pk_fma_f32 v[46:47], v[102:103], v[20:21], v[46:47]
  v_cvt_pk_bf16_f32 v48, v32, v33
  v_cvt_pk_bf16_f32 v52, v40, v41
  v_cvt_pk_bf16_f32 v49, v34, v35
  v_cvt_pk_bf16_f32 v53, v42, v43
  v_cvt_pk_bf16_f32 v50, v36, v37
  v_cvt_pk_bf16_f32 v54, v44, v45
  v_cvt_pk_bf16_f32 v51, v38, v39
  v_cvt_pk_bf16_f32 v55, v46, v47
  buffer_store_dwordx4 v[48:51], v14, s[16:19], s37 offen offset:0 sc1
  buffer_store_dwordx4 v[52:55], v16, s[16:19], s37 offen offset:0 sc1
  v_pk_add_f32 v[56:57], v[228:229], v[164:165] neg_lo:[0,1] neg_hi:[0,1]
  v_pk_add_f32 v[64:65], v[228:229], v[164:165]
  v_pk_add_f32 v[58:59], v[230:231], v[166:167] neg_lo:[0,1] neg_hi:[0,1]
  v_pk_add_f32 v[66:67], v[230:231], v[166:167]
  v_pk_add_f32 v[60:61], v[244:245], v[180:181] neg_lo:[0,1] neg_hi:[0,1]
  v_pk_add_f32 v[68:69], v[244:245], v[180:181]
  v_pk_add_f32 v[62:63], v[246:247], v[182:183] neg_lo:[0,1] neg_hi:[0,1]
  v_pk_add_f32 v[70:71], v[246:247], v[182:183]
  v_pk_fma_f32 v[56:57], v[104:105], v[18:19], v[56:57]
  v_pk_fma_f32 v[64:65], v[104:105], v[20:21], v[64:65]
  v_pk_fma_f32 v[58:59], v[106:107], v[18:19], v[58:59]
  v_pk_fma_f32 v[66:67], v[106:107], v[20:21], v[66:67]
  v_pk_fma_f32 v[60:61], v[108:109], v[18:19], v[60:61]
  v_pk_fma_f32 v[68:69], v[108:109], v[20:21], v[68:69]
  v_pk_fma_f32 v[62:63], v[110:111], v[18:19], v[62:63]
  v_pk_fma_f32 v[70:71], v[110:111], v[20:21], v[70:71]
  v_cvt_pk_bf16_f32 v72, v56, v57
  v_cvt_pk_bf16_f32 v76, v64, v65
  v_cvt_pk_bf16_f32 v73, v58, v59
  v_cvt_pk_bf16_f32 v77, v66, v67
  v_cvt_pk_bf16_f32 v74, v60, v61
  v_cvt_pk_bf16_f32 v78, v68, v69
  v_cvt_pk_bf16_f32 v75, v62, v63
  v_cvt_pk_bf16_f32 v79, v70, v71
  buffer_store_dwordx4 v[72:75], v14, s[16:19], s37 offen offset:64 sc1
  buffer_store_dwordx4 v[76:79], v16, s[16:19], s37 offen offset:64 sc1
  s_add_u32 s37, s37, 36864
  v_pk_add_f32 v[32:33], v[200:201], v[136:137] neg_lo:[0,1] neg_hi:[0,1]
  v_pk_add_f32 v[40:41], v[200:201], v[136:137]
  v_pk_add_f32 v[34:35], v[202:203], v[138:139] neg_lo:[0,1] neg_hi:[0,1]
  v_pk_add_f32 v[42:43], v[202:203], v[138:139]
  v_pk_add_f32 v[36:37], v[216:217], v[152:153] neg_lo:[0,1] neg_hi:[0,1]
  v_pk_add_f32 v[44:45], v[216:217], v[152:153]
  v_pk_add_f32 v[38:39], v[218:219], v[154:155] neg_lo:[0,1] neg_hi:[0,1]
  v_pk_add_f32 v[46:47], v[218:219], v[154:155]
  v_pk_fma_f32 v[32:33], v[96:97], v[18:19], v[32:33]
  v_pk_fma_f32 v[40:41], v[96:97], v[20:21], v[40:41]
  v_pk_fma_f32 v[34:35], v[98:99], v[18:19], v[34:35]
  v_pk_fma_f32 v[42:43], v[98:99], v[20:21], v[42:43]
  v_pk_fma_f32 v[36:37], v[100:101], v[18:19], v[36:37]
  v_pk_fma_f32 v[44:45], v[100:101], v[20:21], v[44:45]
  v_pk_fma_f32 v[38:39], v[102:103], v[18:19], v[38:39]
  v_pk_fma_f32 v[46:47], v[102:103], v[20:21], v[46:47]
  v_cvt_pk_bf16_f32 v48, v32, v33
  v_cvt_pk_bf16_f32 v52, v40, v41
  v_cvt_pk_bf16_f32 v49, v34, v35
  v_cvt_pk_bf16_f32 v53, v42, v43
  v_cvt_pk_bf16_f32 v50, v36, v37
  v_cvt_pk_bf16_f32 v54, v44, v45
  v_cvt_pk_bf16_f32 v51, v38, v39
  v_cvt_pk_bf16_f32 v55, v46, v47
  buffer_store_dwordx4 v[48:51], v14, s[16:19], s37 offen offset:0 sc1
  buffer_store_dwordx4 v[52:55], v16, s[16:19], s37 offen offset:0 sc1
  v_pk_add_f32 v[56:57], v[232:233], v[168:169] neg_lo:[0,1] neg_hi:[0,1]
  v_pk_add_f32 v[64:65], v[232:233], v[168:169]
  v_pk_add_f32 v[58:59], v[234:235], v[170:171] neg_lo:[0,1] neg_hi:[0,1]
  v_pk_add_f32 v[66:67], v[234:235], v[170:171]
  v_pk_add_f32 v[60:61], v[248:249], v[184:185] neg_lo:[0,1] neg_hi:[0,1]
  v_pk_add_f32 v[68:69], v[248:249], v[184:185]
  v_pk_add_f32 v[62:63], v[250:251], v[186:187] neg_lo:[0,1] neg_hi:[0,1]
  v_pk_add_f32 v[70:71], v[250:251], v[186:187]
  v_pk_fma_f32 v[56:57], v[104:105], v[18:19], v[56:57]
  v_pk_fma_f32 v[64:65], v[104:105], v[20:21], v[64:65]
  v_pk_fma_f32 v[58:59], v[106:107], v[18:19], v[58:59]
  v_pk_fma_f32 v[66:67], v[106:107], v[20:21], v[66:67]
  v_pk_fma_f32 v[60:61], v[108:109], v[18:19], v[60:61]
  v_pk_fma_f32 v[68:69], v[108:109], v[20:21], v[68:69]
  v_pk_fma_f32 v[62:63], v[110:111], v[18:19], v[62:63]
  v_pk_fma_f32 v[70:71], v[110:111], v[20:21], v[70:71]
  v_cvt_pk_bf16_f32 v72, v56, v57
  v_cvt_pk_bf16_f32 v76, v64, v65
  v_cvt_pk_bf16_f32 v73, v58, v59
  v_cvt_pk_bf16_f32 v77, v66, v67
  v_cvt_pk_bf16_f32 v74, v60, v61
  v_cvt_pk_bf16_f32 v78, v68, v69
  v_cvt_pk_bf16_f32 v75, v62, v63
  v_cvt_pk_bf16_f32 v79, v70, v71
  buffer_store_dwordx4 v[72:75], v14, s[16:19], s37 offen offset:64 sc1
  buffer_store_dwordx4 v[76:79], v16, s[16:19], s37 offen offset:64 sc1
  s_add_u32 s37, s37, 36864
  v_pk_add_f32 v[32:33], v[204:205], v[140:141] neg_lo:[0,1] neg_hi:[0,1]
  v_pk_add_f32 v[40:41], v[204:205], v[140:141]
  v_pk_add_f32 v[34:35], v[206:207], v[142:143] neg_lo:[0,1] neg_hi:[0,1]
  v_pk_add_f32 v[42:43], v[206:207], v[142:143]
  v_pk_add_f32 v[36:37], v[220:221], v[156:157] neg_lo:[0,1] neg_hi:[0,1]
  v_pk_add_f32 v[44:45], v[220:221], v[156:157]
  v_pk_add_f32 v[38:39], v[222:223], v[158:159] neg_lo:[0,1] neg_hi:[0,1]
  v_pk_add_f32 v[46:47], v[222:223], v[158:159]
  v_pk_fma_f32 v[32:33], v[96:97], v[18:19], v[32:33]
  v_pk_fma_f32 v[40:41], v[96:97], v[20:21], v[40:41]
  v_pk_fma_f32 v[34:35], v[98:99], v[18:19], v[34:35]
  v_pk_fma_f32 v[42:43], v[98:99], v[20:21], v[42:43]
  v_pk_fma_f32 v[36:37], v[100:101], v[18:19], v[36:37]
  v_pk_fma_f32 v[44:45], v[100:101], v[20:21], v[44:45]
  v_pk_fma_f32 v[38:39], v[102:103], v[18:19], v[38:39]
  v_pk_fma_f32 v[46:47], v[102:103], v[20:21], v[46:47]
  v_cvt_pk_bf16_f32 v48, v32, v33
  v_cvt_pk_bf16_f32 v52, v40, v41
  v_cvt_pk_bf16_f32 v49, v34, v35
  v_cvt_pk_bf16_f32 v53, v42, v43
  v_cvt_pk_bf16_f32 v50, v36, v37
  v_cvt_pk_bf16_f32 v54, v44, v45
  v_cvt_pk_bf16_f32 v51, v38, v39
  v_cvt_pk_bf16_f32 v55, v46, v47
  buffer_store_dwordx4 v[48:51], v14, s[16:19], s37 offen offset:0 sc1
  buffer_store_dwordx4 v[52:55], v16, s[16:19], s37 offen offset:0 sc1
  v_pk_add_f32 v[56:57], v[236:237], v[172:173] neg_lo:[0,1] neg_hi:[0,1]
  v_pk_add_f32 v[64:65], v[236:237], v[172:173]
  v_pk_add_f32 v[58:59], v[238:239], v[174:175] neg_lo:[0,1] neg_hi:[0,1]
  v_pk_add_f32 v[66:67], v[238:239], v[174:175]
  v_pk_add_f32 v[60:61], v[252:253], v[188:189] neg_lo:[0,1] neg_hi:[0,1]
  v_pk_add_f32 v[68:69], v[252:253], v[188:189]
  v_pk_add_f32 v[62:63], v[254:255], v[190:191] neg_lo:[0,1] neg_hi:[0,1]
  v_pk_add_f32 v[70:71], v[254:255], v[190:191]
  v_pk_fma_f32 v[56:57], v[104:105], v[18:19], v[56:57]
  v_pk_fma_f32 v[64:65], v[104:105], v[20:21], v[64:65]
  v_pk_fma_f32 v[58:59], v[106:107], v[18:19], v[58:59]
  v_pk_fma_f32 v[66:67], v[106:107], v[20:21], v[66:67]
  v_pk_fma_f32 v[60:61], v[108:109], v[18:19], v[60:61]
  v_pk_fma_f32 v[68:69], v[108:109], v[20:21], v[68:69]
  v_pk_fma_f32 v[62:63], v[110:111], v[18:19], v[62:63]
  v_pk_fma_f32 v[70:71], v[110:111], v[20:21], v[70:71]
  v_cvt_pk_bf16_f32 v72, v56, v57
  v_cvt_pk_bf16_f32 v76, v64, v65
  v_cvt_pk_bf16_f32 v73, v58, v59
  v_cvt_pk_bf16_f32 v77, v66, v67
  v_cvt_pk_bf16_f32 v74, v60, v61
  v_cvt_pk_bf16_f32 v78, v68, v69
  v_cvt_pk_bf16_f32 v75, v62, v63
  v_cvt_pk_bf16_f32 v79, v70, v71
  buffer_store_dwordx4 v[72:75], v14, s[16:19], s37 offen offset:64 sc1
  buffer_store_dwordx4 v[76:79], v16, s[16:19], s37 offen offset:64 sc1
  s_add_u32 s37, s37, 36864
  s_lshl_b32 s40, s57, 6
  s_add_u32 s40, s40, 32018432
  v_mov_b32 v96, s92
  v_mov_b32 v97, s93
  v_mov_b32 v98, s92
  v_mov_b32 v99, s93
  v_mov_b32 v100, 155652
  v_mov_b32 v101, 1
  s_mov_b64 exec, 1
  s_waitcnt vmcnt(0)
  ds_add_rtn_u32 v101, v100, v101
  s_mov_b64 exec, 15
  v_lshlrev_b32 v100, 4, v0
  s_waitcnt lgkmcnt(0)
  v_readfirstlane_b32 s36, v101
  s_cmp_lg_u32 s36, 3
  s_cbranch_scc1 L1_sf_23
  buffer_store_dwordx4 v[96:99], v100, s[16:19], s40 offen sc1
L1_sf_23:
  s_mov_b64 exec, -1
  s_branch L4_cons
L_end:
  s_endpgm
.section .rodata,"a"
.p2align 6
.amdhsa_kernel gated_mix__spectral_fnet__mixer_gmlp__prompt_kernel
  .amdhsa_next_free_vgpr 256
  .amdhsa_next_free_sgpr 100
  .amdhsa_accum_offset 256
  .amdhsa_group_segment_fixed_size 0
  .amdhsa_kernarg_size 112
  .amdhsa_user_sgpr_count 2
  .amdhsa_user_sgpr_kernarg_segment_ptr 1
  .amdhsa_system_sgpr_workgroup_id_x 1
  .amdhsa_float_denorm_mode_32 3
.end_amdhsa_kernel
```
